```python
import torch

def _softmax(x, axis=-1):
    return torch.softmax(x, dim=axis)
def _gelu(x):
    return torch.nn.functional.gelu(x, approximate="tanh")
def _silu(x):
    return torch.nn.functional.silu(x)
def _sigmoid(x):
    return torch.sigmoid(x)
def _layernorm(x, axis=-1, eps=1e-5):
    m = x.mean(dim=axis, keepdim=True)
    v = x.var(dim=axis, keepdim=True, unbiased=False)
    return (x - m) / torch.sqrt(v + eps)
def _scatter_add(tgt, idx, src, axis=0):
    return tgt.clone().index_add_(axis, idx, src)
def _segment_sum(src, seg, n):
    out = torch.zeros((n,) + src.shape[1:], dtype=src.dtype)
    return out.index_add_(0, seg, src)
def _pad(x, pw):
    flat = tuple(v for pair in reversed(pw) for v in pair)
    return torch.nn.functional.pad(x, flat)

kernel_name = 'concat_heads__grouped_kv_mqa__ssm_conv_s4__prompt'

def setup_inputs():

    _w = (lambda a: (lambda t: t.to(torch.bfloat16) if t.is_floating_point() else t)(torch.as_tensor(a)))
    def _A_setup():
        B, S, D, H = 1, 2048, 640, 32
        Dh = D // H
        return {
            "x": _w((lambda *s: torch.randn(*s, dtype=torch.bfloat16) * 0.05)(B, S, D)),
            "wq": _w((lambda *s: torch.randn(*s, dtype=torch.bfloat16) * 0.8)(D, H * Dh)),
            "wk": _w((lambda *s: torch.randn(*s, dtype=torch.bfloat16) * 0.8)(D, Dh)),
            "wv": _w((lambda *s: torch.randn(*s, dtype=torch.bfloat16) * 0.05)(D, Dh)),
            "wo": _w((lambda *s: torch.randn(*s, dtype=torch.bfloat16) * 0.05)(H * Dh, D)),
        }
    _A_in = _A_setup()

    def _B_setup():
        B, L, D, N = 1, 2048, 640, 128
        A_re = -(lambda _x: torch.exp(torch.as_tensor(_x)))((lambda *s: torch.randn(*s, dtype=torch.bfloat16) * 6.4)(D, N))
        A_im = torch.pi * (lambda *s: torch.randn(*s, dtype=torch.bfloat16) * 0.1)(D, N)
        B_re = (lambda *s: torch.randn(*s, dtype=torch.bfloat16) * 0.1)(D, N)
        B_im = (lambda *s: torch.randn(*s, dtype=torch.bfloat16) * 0.1)(D, N)
        C_re = (lambda *s: torch.randn(*s, dtype=torch.bfloat16) * 0.1)(D, N)
        C_im = (lambda *s: torch.randn(*s, dtype=torch.bfloat16) * 0.1)(D, N)
        log_dt = (lambda *s: torch.randn(*s, dtype=torch.bfloat16) * 0.1)(D) * 0.5 - 4.0
        Dskip = (lambda *s: torch.randn(*s, dtype=torch.bfloat16) * 0.05)(D)
        return {
            "u": _w((lambda *s: torch.randn(*s, dtype=torch.bfloat16) * 0.05)(B, L, D)),
            "A_re": _w(A_re),
            "A_im": _w(A_im),
            "B_re": _w(B_re),
            "B_im": _w(B_im),
            "C_re": _w(C_re),
            "C_im": _w(C_im),
            "log_dt": _w(log_dt),
            "Dskip": _w(Dskip),
        }
    _B_in = _B_setup()

    return {
        "A_x": _A_in["x"],
        "A_wq": _A_in["wq"],
        "A_wk": _A_in["wk"],
        "A_wv": _A_in["wv"],
        "A_wo": _A_in["wo"],
        "B_u": _B_in["u"],
        "B_A_re": _B_in["A_re"],
        "B_A_im": _B_in["A_im"],
        "B_B_re": _B_in["B_re"],
        "B_B_im": _B_in["B_im"],
        "B_C_re": _B_in["C_re"],
        "B_C_im": _B_in["C_im"],
        "B_log_dt": _B_in["log_dt"],
        "B_Dskip": _B_in["Dskip"],
    }

def reference(A_x, A_wq, A_wk, A_wv, A_wo, B_u, B_A_re, B_A_im, B_B_re, B_B_im, B_C_re, B_C_im, B_log_dt, B_Dskip):
    def _A_ref(x, wq, wk, wv, wo):
        B, S, D = x.shape
        H = 32
        Dh = D // H
        q = (lambda x, *d: x.permute(*d))((x @ wq).reshape(B, S, H, Dh), 0, 2, 1, 3)
        k = x @ wk
        v = x @ wv
        scores = torch.einsum("bhqd,bkd->bhqk", q, k) * (Dh ** -0.5)
        p = _softmax(scores, axis=-1)
        o = torch.einsum("bhqk,bkd->bhqd", p, v)
        return (lambda x, *d: x.permute(*d))(o, 0, 2, 1, 3).reshape(B, S, H * Dh) @ wo

    def _B_ref(u, A_re, A_im, B_re, B_im, C_re, C_im, log_dt, Dskip):
        Bsz, L, D = u.shape
        dt = torch.exp(log_dt)[:, None]
        A = A_re + 1j * A_im
        Bc = B_re + 1j * B_im
        Cc = C_re + 1j * C_im
        logdA = dt * A
        dB = dt * Bc
        l = (lambda x, dt: x.to(dt))(torch.arange(L), A_re.dtype)
        P = torch.exp(logdA[:, :, None] * l[None, None, :])
        K = torch.einsum("dn,dnl,dn->dl", Cc, P, dB).real
        L2 = 2 * L
        Kp = _pad(K, ((0, 0), (0, L)))
        up = (lambda x, *d: x.permute(*d))(u, 0, 2, 1)
        up = _pad(up, ((0, 0), (0, 0), (0, L)))
        Kf = (lambda x, axes=(-2,-1): torch.fft.rfft2(x.float(), dim=axes))(Kp[:, None, :], axes=(-2, -1))
        Uf = (lambda x, axes=(-2,-1): torch.fft.rfft2(x.float(), dim=axes))(up[:, :, None, :], axes=(-2, -1))
        Yf = Uf * Kf[None, :, :, :]
        y = (lambda x, s, axes=(-2,-1): torch.fft.irfft2(x, s=s, dim=axes).to(torch.bfloat16))(Yf, (1, L2), axes=(-2, -1))[:, :, 0, :L]
        y = (lambda x, *d: x.permute(*d))(y, 0, 2, 1) + u * Dskip[None, None, :]
        return y

    a = _A_ref(A_x, A_wq, A_wk, A_wv, A_wo)
    b = _B_ref(B_u, B_A_re, B_A_im, B_B_re, B_B_im, B_C_re, B_C_im, B_log_dt, B_Dskip)
    return torch.concatenate([a, b], axis=-1)
```

```asm
; @launch grid=(256,1,1) block=(512,1,1) lds=163840
.amdgcn_target "amdgcn-amd-amdhsa--gfx950"
.text
.globl concat_heads__grouped_kv_mqa__ssm_conv_s4__prompt_kernel
.p2align 8
.type concat_heads__grouped_kv_mqa__ssm_conv_s4__prompt_kernel,@function
concat_heads__grouped_kv_mqa__ssm_conv_s4__prompt_kernel:
    s_cmp_ge_u32 s2, 256
    s_cbranch_scc1 L_end
    s_load_dwordx16 s[16:31], s[0:1], 0
    s_load_dwordx16 s[32:47], s[0:1], 64
    s_load_dwordx2 s[48:49], s[0:1], 128
    v_lshrrev_b32 v2, 6, v0
    v_and_b32 v1, 63, v0
    v_readfirstlane_b32 s3, v2
    s_getpc_b64 s[50:51]
    s_lshr_b32 s4, s2, 3
    s_lshl_b32 s4, s4, 7
    v_lshl_add_u32 v3, v2, 12, s4
    v_lshl_add_u32 v3, v1, 15, v3
    v_min_u32 v3, (L_code_end-concat_heads__grouped_kv_mqa__ssm_conv_s4__prompt_kernel-64)&0xfffffffc, v3
    s_mov_b64 exec, 3
    global_load_dword v4, v3, s[50:51]
    s_mov_b64 exec, -1
    s_and_b32 s4, s2, 31
    s_lshr_b32 s5, s2, 5
    v_mov_b32 v5, 0
    v_lshlrev_b32 v6, 2, v0
    v_and_b32 v6, 127, v6
    v_add_u32 v6, 103424, v6
    ds_write_b32 v6, v5
    s_cmp_ge_u32 s3, 4
    s_cbranch_scc0 L_att
    s_sub_u32 s67, s3, 4
    s_and_b32 s65, s2, 7
    s_lshl_b32 s7, s65, 3
    s_mov_b32 s50, 0x40301800
    s_mov_b32 s51, 0x90806850
    s_lshr_b64 s[50:51], s[50:51], s7
    s_and_b32 s66, s50, 0xff
    s_lshr_b32 s51, s2, 3
    s_add_u32 s66, s66, s51
    s_sub_u32 s66, s66, 16
    s_bitcmp1_b32 0x66, s65
    s_cselect_b32 s7, 8, 16
    s_cmp_lt_u32 s51, s7
    s_cselect_b32 s66, -1, s66
    s_lshl_b32 s65, s66, 2
    s_add_u32 s65, s65, s67
    s_lshl_b32 s7, s65, 8
    v_lshlrev_b32 v10, 2, v1
    v_add_u32 v8, s7, v10
    s_lshl_b32 s7, s65, 1
    v_mov_b32 v9, s7
    s_mul_i32 s7, s51, 200
    s_mul_i32 s50, s67, 50
    s_add_u32 s7, s7, s50
    v_add_u32 v2, s7, v1
    v_lshlrev_b32 v2, 7, v2
    v_lshlrev_b32 v16, 4, v1
    s_cmp_lt_i32 s66, 0
    s_waitcnt lgkmcnt(0)
    s_cbranch_scc1 L_h_pre_tr
    global_load_ushort v30, v9, s[40:41]
    global_load_dword v24, v8, s[28:29]
    global_load_dword v25, v8, s[30:31]
    global_load_dword v26, v8, s[32:33]
    global_load_dword v27, v8, s[34:35]
    global_load_dword v28, v8, s[36:37]
    global_load_dword v29, v8, s[38:39]
    global_load_ushort v31, v9, s[42:43]
    s_branch L_h_bar
L_h_pre_tr:
    s_cmp_ge_u32 s5, 2
    s_cbranch_scc1 L_h_bar
    s_mul_i32 s7, s67, 7168
    s_add_u32 m0, s7, 103552
    s_cmp_eq_u32 s5, 0
    s_cselect_b32 s56, s20, s22
    s_cselect_b32 s57, s21, s23
    s_and_b32 s57, s57, 0xffff
    s_mov_b32 s58, 25600
    s_mov_b32 s59, 0x20000
    buffer_load_dwordx4 v16, s[56:59], s7 offen offset:0 lds
    buffer_load_dwordx4 v16, s[56:59], s7 offen offset:1024 lds
    buffer_load_dwordx4 v16, s[56:59], s7 offen offset:2048 lds
    buffer_load_dwordx4 v16, s[56:59], s7 offen offset:3072 lds
    s_add_u32 m0, m0, 4096
    s_add_u32 s7, s7, 4096
    buffer_load_dwordx4 v16, s[56:59], s7 offen offset:0 lds
    buffer_load_dwordx4 v16, s[56:59], s7 offen offset:1024 lds
    buffer_load_dwordx4 v16, s[56:59], s7 offen offset:2048 lds
L_h_bar:
    s_barrier
    s_branch L_h_go
L_att:
    v_lshrrev_b32 v8, 3, v1
    v_lshrrev_b32 v9, 4, v1
    v_xor_b32 v9, v9, v1
    v_and_b32 v9, 7, v9
    v_mul_u32_u24 v8, 80, v8
    v_add_u32 v8, v8, v9
    v_lshlrev_b32 v17, 4, v8
    v_xor_b32 v18, 64, v17
    v_add_u32 v18, 10240, v18
    s_lshl_b32 s7, s4, 2
    s_add_u32 s7, s7, s3
    s_mul_i32 s50, s7, 20480
    s_mul_i32 s51, s3, 20480
    s_add_u32 s51, s51, 21504
    v_lshlrev_b32 v12, 4, v1
    s_lshr_b32 s65, s4, 3
    s_add_u32 s65, s65, s5
    s_sub_u32 s60, s65, 5
    s_cselect_b32 s65, s65, s60
    s_sub_u32 s60, s65, 5
    s_cselect_b32 s65, s65, s60
    s_mul_i32 s68, s5, 160
    s_lshl_b32 s66, s65, 8
    s_add_u32 s66, s66, s50
    s_add_u32 s60, s50, 1280
    s_mul_i32 s61, s3, 6144
    s_add_u32 s61, s61, 137344
    v_add_u32 v8, 0, v1
    v_mul_u32_u24 v9, 205, v8
    v_lshrrev_b32 v9, 11, v9
    v_mul_u32_u24 v10, 10, v9
    v_sub_u32 v8, v8, v10
    v_lshrrev_b32 v10, 1, v9
    v_and_b32 v10, 4, v10
    v_xor_b32 v9, v9, v10
    v_mul_u32_u24 v9, 80, v9
    v_add_u32 v8, v8, v9
    v_lshlrev_b32 v20, 4, v8
    v_add_u32 v8, 64, v1
    v_mul_u32_u24 v9, 205, v8
    v_lshrrev_b32 v9, 11, v9
    v_mul_u32_u24 v10, 10, v9
    v_sub_u32 v8, v8, v10
    v_lshrrev_b32 v10, 1, v9
    v_and_b32 v10, 4, v10
    v_xor_b32 v9, v9, v10
    v_mul_u32_u24 v9, 80, v9
    v_add_u32 v8, v8, v9
    v_subrev_u32 v8, 64, v8
    v_lshlrev_b32 v21, 4, v8
    v_add_u32 v8, 128, v1
    v_mul_u32_u24 v9, 205, v8
    v_lshrrev_b32 v9, 11, v9
    v_mul_u32_u24 v10, 10, v9
    v_sub_u32 v8, v8, v10
    v_lshrrev_b32 v10, 1, v9
    v_and_b32 v10, 4, v10
    v_xor_b32 v9, v9, v10
    v_mul_u32_u24 v9, 80, v9
    v_add_u32 v8, v8, v9
    v_subrev_u32 v8, 128, v8
    v_lshlrev_b32 v22, 4, v8
    v_add_u32 v8, 192, v1
    v_mul_u32_u24 v9, 205, v8
    v_lshrrev_b32 v9, 11, v9
    v_mul_u32_u24 v10, 10, v9
    v_sub_u32 v8, v8, v10
    v_lshrrev_b32 v10, 1, v9
    v_and_b32 v10, 4, v10
    v_xor_b32 v9, v9, v10
    v_mul_u32_u24 v9, 80, v9
    v_add_u32 v8, v8, v9
    v_subrev_u32 v8, 192, v8
    v_lshlrev_b32 v23, 4, v8
    v_add_u32 v8, 256, v1
    v_mul_u32_u24 v9, 205, v8
    v_lshrrev_b32 v9, 11, v9
    v_mul_u32_u24 v10, 10, v9
    v_sub_u32 v8, v8, v10
    v_lshrrev_b32 v10, 1, v9
    v_and_b32 v10, 4, v10
    v_xor_b32 v9, v9, v10
    v_mul_u32_u24 v9, 80, v9
    v_add_u32 v8, v8, v9
    v_lshlrev_b32 v24, 4, v8
    s_waitcnt lgkmcnt(0)
    s_mov_b32 s8, s16
    s_and_b32 s9, s17, 0xffff
    s_mov_b32 s10, 0x280000
    s_mov_b32 s11, 0x20000
    s_mov_b32 s12, s18
    s_and_b32 s13, s19, 0xffff
    s_mov_b32 s14, 0xc8000
    s_mov_b32 s15, 0x20000
    s_cmp_ge_u32 s5, 2
    s_barrier
    s_cbranch_scc1 nokv_1
    s_mov_b32 m0, s51
    s_nop 0
    buffer_load_dwordx4 v17, s[8:11], s50 offen offset:0 lds
    s_add_u32 m0, m0, 1024
    s_nop 0
    buffer_load_dwordx4 v18, s[8:11], s50 offen offset:0 lds
    s_add_u32 m0, m0, 896
    s_nop 0
    buffer_load_dwordx4 v17, s[8:11], s50 offen offset:128 lds
    s_add_u32 m0, m0, 1024
    s_nop 0
    buffer_load_dwordx4 v18, s[8:11], s50 offen offset:128 lds
    s_add_u32 m0, m0, 896
    s_nop 0
    buffer_load_dwordx4 v17, s[8:11], s50 offen offset:256 lds
    s_add_u32 m0, m0, 1024
    s_nop 0
    buffer_load_dwordx4 v18, s[8:11], s50 offen offset:256 lds
    s_mov_b32 s61, s51
    s_branch w1_2
nokv_1:
    s_add_u32 m0, s61, 0
    s_nop 0
    buffer_load_dwordx4 v17, s[8:11], s66 offen offset:0 lds
    s_add_u32 m0, m0, 1024
    s_nop 0
    buffer_load_dwordx4 v18, s[8:11], s66 offen offset:0 lds
    s_add_u32 s66, s66, 128
    s_cmp_eq_u32 s66, s60
    s_cselect_b32 s66, s50, s66
    s_add_u32 m0, s61, 2048
    s_nop 0
    buffer_load_dwordx4 v17, s[8:11], s66 offen offset:0 lds
    s_add_u32 m0, m0, 1024
    s_nop 0
    buffer_load_dwordx4 v18, s[8:11], s66 offen offset:0 lds
    s_add_u32 s66, s66, 128
    s_cmp_eq_u32 s66, s60
    s_cselect_b32 s66, s50, s66
    s_add_u32 m0, s61, 4096
    s_nop 0
    buffer_load_dwordx4 v17, s[8:11], s66 offen offset:0 lds
    s_add_u32 m0, m0, 1024
    s_nop 0
    buffer_load_dwordx4 v18, s[8:11], s66 offen offset:0 lds
    s_add_u32 s66, s66, 128
    s_cmp_eq_u32 s66, s60
    s_cselect_b32 s66, s50, s66
w1_2:
    s_load_dword s6, s[48:49], 0
    s_mov_b32 s52, s48
    s_and_b32 s53, s49, 0xffff
    s_mov_b32 s54, 0x1000000
    s_mov_b32 s55, 0x20000
    v_and_b32 v8, 15, v1
    v_lshrrev_b32 v9, 4, v1
    v_lshrrev_b32 v10, 1, v8
    v_xor_b32 v10, v10, v9
    v_lshlrev_b32 v10, 4, v10
    v_lshlrev_b32 v8, 7, v8
    v_add3_u32 v26, v8, v10, s61
    v_xor_b32 v27, 64, v26
    v_bfe_u32 v8, v1, 2, 2
    v_lshl_add_u32 v8, v9, 3, v8
    v_mul_u32_u24 v10, 40, v8
    v_add_u32 v25, 103584, v10
    v_and_b32 v11, 3, v1
    v_lshl_add_u32 v10, v11, 3, v10
    v_add_u32 v19, 103552, v10
    v_and_b32 v10, 1, v9
    v_lshl_add_u32 v8, v10, 2, v8
    v_xor_b32 v10, 4, v8
    v_mul_u32_u24 v8, 160, v8
    v_mul_u32_u24 v10, 160, v10
    v_mul_u32_u24 v11, 40, v11
    v_add3_u32 v34, v8, v11, 32
    v_add3_u32 v35, v10, v11, 32
    v_and_b32 v11, 1, v1
    v_mul_u32_u24 v11, 40, v11
    v_and_b32 v9, 2, v1
    v_lshl_add_u32 v11, v9, 3, v11
    v_add_u32 v32, v8, v11
    v_add_u32 v33, v10, v11
    v_add_u32 v28, 51200, v32
    v_add_u32 v29, 51200, v33
    v_add_u32 v30, 51200, v34
    v_add_u32 v31, 51200, v35
    v_mov_b32 v13, 103424
    v_mov_b32 v14, 1
    v_min_u32 v7, 1, v1
    v_mul_u32_u24 v7, 60416, v7
    v_add_u32 v7, 103424, v7
    s_and_b32 s7, s4, 28
    s_add_u32 s7, s7, s3
    v_mov_b32 v9, s7
    v_and_b32 v10, 4, v1
    v_lshl_add_u32 v9, v10, 3, v9
    v_lshlrev_b32 v9, 5, v9
    v_and_b32 v10, 3, v1
    v_add_u32 v9, v9, v10
    v_lshlrev_b32 v15, 2, v9
    v_add_u32 v15, 4096, v15
    v_mov_b32 v245, 0x30800000
    v_mov_b32 v244, 0xdddd
    v_mov_b32 v240, v12
    v_and_b32 v10, 31, v1
    v_min_u32 v10, 20, v10
    v_lshlrev_b32 v10, 4, v10
    v_lshrrev_b32 v11, 5, v1
    v_mul_u32_u24 v11, 336, v11
    v_add_u32 v241, v10, v11
    v_add_u32 v241, 5120, v241
    s_mov_b32 exec_lo, 0xeef00000
    s_mov_b32 exec_hi, 0xeef00000
    v_mov_b32 v241, 163840
    s_mov_b64 exec, -1
    v_mov_b32 v242, v240
    v_mov_b32 v243, v241
    v_mov_b32 v196, 0
    v_mov_b32 v197, 0
    v_mov_b32 v198, 0
    v_mov_b32 v199, 0
    v_mov_b32 v200, 0
    v_mov_b32 v201, 0
    v_mov_b32 v202, 0
    v_mov_b32 v203, 0
    v_mov_b32 v204, 0
    v_mov_b32 v205, 0
    v_mov_b32 v206, 0
    v_mov_b32 v207, 0
    v_mov_b32 v208, 0
    v_mov_b32 v209, 0
    v_mov_b32 v210, 0
    v_mov_b32 v211, 0
    v_mov_b32 v212, 0
    v_mov_b32 v213, 0
    v_mov_b32 v214, 0
    v_mov_b32 v215, 0
    v_mov_b32 v216, 0
    v_mov_b32 v217, 0
    v_mov_b32 v218, 0
    v_mov_b32 v219, 0
    v_mov_b32 v220, 0
    v_mov_b32 v221, 0
    v_mov_b32 v222, 0
    v_mov_b32 v223, 0
    v_mov_b32 v224, 0
    v_mov_b32 v225, 0
    v_mov_b32 v226, 0
    v_mov_b32 v227, 0
    v_mov_b32 v228, 0
    v_mov_b32 v229, 0
    v_mov_b32 v230, 0
    v_mov_b32 v231, 0
    v_mov_b32 v232, 0
    v_mov_b32 v233, 0
    v_mov_b32 v234, 0
    v_mov_b32 v235, 0
    v_mov_b32 v236, 0
    v_mov_b32 v237, 0
    v_mov_b32 v238, 0
    v_mov_b32 v239, 0
    s_setprio 2
    s_mov_b32 s63, 0
    s_cmp_ge_u32 s5, 2
    s_cbranch_scc1 qonly_3
    s_mov_b32 s66, s50
    s_add_u32 m0, s51, 5760
    s_nop 0
    buffer_load_dwordx4 v17, s[8:11], s66 offen offset:384 lds
    s_add_u32 m0, m0, 1024
    s_nop 0
    buffer_load_dwordx4 v18, s[8:11], s66 offen offset:384 lds
    s_add_u32 m0, m0, 896
    s_nop 0
    buffer_load_dwordx4 v17, s[8:11], s66 offen offset:512 lds
    s_add_u32 m0, m0, 1024
    s_nop 0
    buffer_load_dwordx4 v18, s[8:11], s66 offen offset:512 lds
    s_add_u32 m0, m0, 896
    s_nop 0
    buffer_load_dwordx4 v17, s[8:11], s66 offen offset:640 lds
    s_add_u32 m0, m0, 1024
    s_nop 0
    buffer_load_dwordx4 v18, s[8:11], s66 offen offset:640 lds
    s_lshr_b32 s7, s4, 2
    s_mul_i32 s7, s7, 21504
    s_bfe_u32 s50, s4, 0x10001
    s_mul_i32 s50, s50, 10496
    s_add_u32 s7, s7, s50
    s_add_u32 s62, s7, 131072
    s_and_b32 s7, s4, 1
    s_lshl_b32 s7, s7, 1
    s_lshr_b32 s50, s3, 1
    s_add_u32 s60, s7, s50
    s_and_b32 s69, s3, 1
    v_bfe_u32 v8, v1, 2, 2
    v_bfe_u32 v9, v1, 4, 1
    v_mul_u32_u24 v9, 20, v9
    v_add_u32 v8, v8, v9
    v_lshrrev_b32 v9, 5, v1
    v_mul_u32_u24 v10, 40, v9
    v_add3_u32 v10, v10, v8, 16
    v_lshl_add_u32 v8, v9, 2, v8
    v_and_b32 v9, 3, v1
    v_mul_u32_u24 v9, 40, v9
    v_add_u32 v9, 53248, v9
    v_mul_u32_u24 v8, 160, v8
    v_add_u32 v247, v8, v9
    v_mul_u32_u24 v10, 160, v10
    v_add_u32 v248, v10, v9
    v_lshlrev_b32 v246, 3, v1
    s_mov_b32 s64, 800000
ls_5:
    ds_read_b32 v8, v13 offset:0
    s_sub_u32 s64, s64, 1
    s_cbranch_scc1 lsd_6
    s_waitcnt lgkmcnt(0)
    v_cmp_gt_u32 vcc, 4, v8
    s_cbranch_vccnz ls_5
lsd_6:
    s_mul_i32 s6, s6, 1664525
    s_add_u32 s6, s6, 1013904223
    ds_read_b64_tr_b16 v[128:129], v19 offset:0
    ds_read_b64_tr_b16 v[130:131], v19 offset:160
    ds_read_b64_tr_b16 v[132:133], v25 offset:0
    ds_read_b64_tr_b16 v[134:135], v25 offset:160
    ds_read_b64_tr_b16 v[136:137], v19 offset:1280
    ds_read_b64_tr_b16 v[138:139], v19 offset:1440
    ds_read_b64_tr_b16 v[140:141], v25 offset:1280
    ds_read_b64_tr_b16 v[142:143], v25 offset:1440
    ds_read_b64_tr_b16 v[144:145], v19 offset:2560
    ds_read_b64_tr_b16 v[146:147], v19 offset:2720
    ds_read_b64_tr_b16 v[148:149], v25 offset:2560
    ds_read_b64_tr_b16 v[150:151], v25 offset:2720
    ds_read_b64_tr_b16 v[152:153], v19 offset:3840
    ds_read_b64_tr_b16 v[154:155], v19 offset:4000
    ds_read_b64_tr_b16 v[156:157], v25 offset:3840
    ds_read_b64_tr_b16 v[158:159], v25 offset:4000
    s_cmp_eq_u32 s5, 1
    s_cbranch_scc1 isv_7
    v_and_b32 v10, 15, v1
    v_lshlrev_b32 v10, 4, v10
    v_and_b32 v11, 32, v1
    v_lshl_add_u32 v11, v11, 4, v10
    s_lshl_b32 s69, s69, 8
    s_add_u32 s62, s62, s69
    s_lshl_b32 s7, s60, 10
    s_add_u32 s7, s7, s62
    s_lshr_b32 s50, s60, 1
    s_lshl_b32 s50, s50, 9
    s_add_u32 s50, s50, s62
    s_and_b32 s69, s60, 1
    s_lshl_b32 s69, s69, 3
    s_add_u32 s50, s50, s69
    s_add_u32 s50, s50, 4096
    s_waitcnt vmcnt(10)
    ds_read_b128 v[36:39], v26 offset:0
    ds_read_b128 v[40:43], v27 offset:0
    s_add_u32 m0, s51, 11520
    s_nop 0
    buffer_load_dwordx4 v17, s[8:11], s66 offen offset:768 lds
    s_add_u32 m0, m0, 1024
    s_nop 0
    buffer_load_dwordx4 v18, s[8:11], s66 offen offset:768 lds
    s_waitcnt vmcnt(10)
    ds_read_b128 v[44:47], v26 offset:2048
    ds_read_b128 v[48:51], v27 offset:2048
    s_add_u32 m0, s51, 13440
    s_nop 0
    buffer_load_dwordx4 v17, s[8:11], s66 offen offset:896 lds
    s_add_u32 m0, m0, 1024
    s_nop 0
    buffer_load_dwordx4 v18, s[8:11], s66 offen offset:896 lds
    s_waitcnt lgkmcnt(2)
    v_mfma_f32_16x16x32_bf16 v[116:119], v[128:131], v[36:39], 0
    ds_read_b64_tr_b16 v[160:161], v19 offset:5120
    ds_read_b64_tr_b16 v[162:163], v19 offset:5280
    v_mfma_f32_16x16x32_bf16 v[120:123], v[132:135], v[36:39], 0
    ds_read_b64_tr_b16 v[164:165], v25 offset:5120
    ds_read_b64_tr_b16 v[166:167], v25 offset:5280
    v_mfma_f32_16x16x32_bf16 v[116:119], v[136:139], v[40:43], v[116:119]
    ds_read_b64_tr_b16 v[168:169], v19 offset:6400
    ds_read_b64_tr_b16 v[170:171], v19 offset:6560
    v_mfma_f32_16x16x32_bf16 v[120:123], v[140:143], v[40:43], v[120:123]
    ds_read_b64_tr_b16 v[172:173], v25 offset:6400
    ds_read_b64_tr_b16 v[174:175], v25 offset:6560
    s_waitcnt vmcnt(10)
    ds_read_b128 v[52:55], v26 offset:4096
    ds_read_b128 v[56:59], v27 offset:4096
    s_add_u32 m0, s51, 15360
    s_nop 0
    buffer_load_dwordx4 v17, s[8:11], s66 offen offset:1024 lds
    s_add_u32 m0, m0, 1024
    s_nop 0
    buffer_load_dwordx4 v18, s[8:11], s66 offen offset:1024 lds
    s_waitcnt lgkmcnt(10)
    v_mfma_f32_16x16x32_bf16 v[116:119], v[144:147], v[44:47], v[116:119]
    ds_read_b64_tr_b16 v[176:177], v19 offset:7680
    ds_read_b64_tr_b16 v[178:179], v19 offset:7840
    v_mfma_f32_16x16x32_bf16 v[120:123], v[148:151], v[44:47], v[120:123]
    ds_read_b64_tr_b16 v[180:181], v25 offset:7680
    ds_read_b64_tr_b16 v[182:183], v25 offset:7840
    v_mfma_f32_16x16x32_bf16 v[116:119], v[152:155], v[48:51], v[116:119]
    ds_read_b64_tr_b16 v[184:185], v19 offset:8960
    ds_read_b64_tr_b16 v[186:187], v19 offset:9120
    v_mfma_f32_16x16x32_bf16 v[120:123], v[156:159], v[48:51], v[120:123]
    ds_read_b64_tr_b16 v[188:189], v25 offset:8960
    ds_read_b64_tr_b16 v[190:191], v25 offset:9120
    s_waitcnt vmcnt(10)
    ds_read_b128 v[60:63], v26 offset:6144
    ds_read_b128 v[64:67], v27 offset:6144
    s_add_u32 m0, s51, 17280
    s_nop 0
    buffer_load_dwordx4 v17, s[8:11], s66 offen offset:1152 lds
    s_add_u32 m0, m0, 1024
    s_nop 0
    buffer_load_dwordx4 v18, s[8:11], s66 offen offset:1152 lds
    s_waitcnt lgkmcnt(10)
    v_mfma_f32_16x16x32_bf16 v[116:119], v[160:163], v[52:55], v[116:119]
    ds_read_b64_tr_b16 v[128:129], v19 offset:10240
    ds_read_b64_tr_b16 v[130:131], v19 offset:10400
    v_mfma_f32_16x16x32_bf16 v[120:123], v[164:167], v[52:55], v[120:123]
    ds_read_b64_tr_b16 v[132:133], v25 offset:10240
    ds_read_b64_tr_b16 v[134:135], v25 offset:10400
    v_mfma_f32_16x16x32_bf16 v[116:119], v[168:171], v[56:59], v[116:119]
    ds_read_b64_tr_b16 v[136:137], v19 offset:11520
    ds_read_b64_tr_b16 v[138:139], v19 offset:11680
    v_mfma_f32_16x16x32_bf16 v[120:123], v[172:175], v[56:59], v[120:123]
    ds_read_b64_tr_b16 v[140:141], v25 offset:11520
    ds_read_b64_tr_b16 v[142:143], v25 offset:11680
    s_waitcnt vmcnt(10)
    ds_read_b128 v[68:71], v26 offset:8192
    ds_read_b128 v[72:75], v27 offset:8192
    s_waitcnt lgkmcnt(10)
    v_mfma_f32_16x16x32_bf16 v[116:119], v[176:179], v[60:63], v[116:119]
    ds_read_b64_tr_b16 v[144:145], v19 offset:12800
    ds_read_b64_tr_b16 v[146:147], v19 offset:12960
    v_mfma_f32_16x16x32_bf16 v[120:123], v[180:183], v[60:63], v[120:123]
    ds_read_b64_tr_b16 v[148:149], v25 offset:12800
    ds_read_b64_tr_b16 v[150:151], v25 offset:12960
    v_mfma_f32_16x16x32_bf16 v[116:119], v[184:187], v[64:67], v[116:119]
    ds_read_b64_tr_b16 v[152:153], v19 offset:14080
    ds_read_b64_tr_b16 v[154:155], v19 offset:14240
    v_mfma_f32_16x16x32_bf16 v[120:123], v[188:191], v[64:67], v[120:123]
    ds_read_b64_tr_b16 v[156:157], v25 offset:14080
    ds_read_b64_tr_b16 v[158:159], v25 offset:14240
    s_waitcnt vmcnt(8)
    ds_read_b128 v[76:79], v26 offset:10240
    ds_read_b128 v[80:83], v27 offset:10240
    s_waitcnt lgkmcnt(10)
    v_mfma_f32_16x16x32_bf16 v[116:119], v[128:131], v[68:71], v[116:119]
    ds_read_b64_tr_b16 v[160:161], v19 offset:15360
    ds_read_b64_tr_b16 v[162:163], v19 offset:15520
    v_mfma_f32_16x16x32_bf16 v[120:123], v[132:135], v[68:71], v[120:123]
    ds_read_b64_tr_b16 v[164:165], v25 offset:15360
    ds_read_b64_tr_b16 v[166:167], v25 offset:15520
    v_mfma_f32_16x16x32_bf16 v[116:119], v[136:139], v[72:75], v[116:119]
    ds_read_b64_tr_b16 v[168:169], v19 offset:16640
    ds_read_b64_tr_b16 v[170:171], v19 offset:16800
    v_mfma_f32_16x16x32_bf16 v[120:123], v[140:143], v[72:75], v[120:123]
    ds_read_b64_tr_b16 v[172:173], v25 offset:16640
    ds_read_b64_tr_b16 v[174:175], v25 offset:16800
    s_waitcnt vmcnt(6)
    ds_read_b128 v[84:87], v26 offset:12288
    ds_read_b128 v[88:91], v27 offset:12288
    s_waitcnt lgkmcnt(10)
    v_mfma_f32_16x16x32_bf16 v[116:119], v[144:147], v[76:79], v[116:119]
    ds_read_b64_tr_b16 v[176:177], v19 offset:17920
    ds_read_b64_tr_b16 v[178:179], v19 offset:18080
    v_mfma_f32_16x16x32_bf16 v[120:123], v[148:151], v[76:79], v[120:123]
    ds_read_b64_tr_b16 v[180:181], v25 offset:17920
    ds_read_b64_tr_b16 v[182:183], v25 offset:18080
    v_mfma_f32_16x16x32_bf16 v[116:119], v[152:155], v[80:83], v[116:119]
    ds_read_b64_tr_b16 v[184:185], v19 offset:19200
    ds_read_b64_tr_b16 v[186:187], v19 offset:19360
    v_mfma_f32_16x16x32_bf16 v[120:123], v[156:159], v[80:83], v[120:123]
    ds_read_b64_tr_b16 v[188:189], v25 offset:19200
    ds_read_b64_tr_b16 v[190:191], v25 offset:19360
    s_waitcnt vmcnt(4)
    ds_read_b128 v[92:95], v26 offset:14336
    ds_read_b128 v[96:99], v27 offset:14336
    s_waitcnt lgkmcnt(10)
    v_mfma_f32_16x16x32_bf16 v[116:119], v[160:163], v[84:87], v[116:119]
    ds_read_b64_tr_b16 v[128:129], v19 offset:20480
    ds_read_b64_tr_b16 v[130:131], v19 offset:20640
    v_mfma_f32_16x16x32_bf16 v[120:123], v[164:167], v[84:87], v[120:123]
    ds_read_b64_tr_b16 v[132:133], v25 offset:20480
    ds_read_b64_tr_b16 v[134:135], v25 offset:20640
    v_mfma_f32_16x16x32_bf16 v[116:119], v[168:171], v[88:91], v[116:119]
    ds_read_b64_tr_b16 v[136:137], v19 offset:21760
    ds_read_b64_tr_b16 v[138:139], v19 offset:21920
    v_mfma_f32_16x16x32_bf16 v[120:123], v[172:175], v[88:91], v[120:123]
    ds_read_b64_tr_b16 v[140:141], v25 offset:21760
    ds_read_b64_tr_b16 v[142:143], v25 offset:21920
    s_waitcnt vmcnt(2)
    ds_read_b128 v[100:103], v26 offset:16384
    ds_read_b128 v[104:107], v27 offset:16384
    s_waitcnt lgkmcnt(10)
    v_mfma_f32_16x16x32_bf16 v[116:119], v[176:179], v[92:95], v[116:119]
    ds_read_b64_tr_b16 v[144:145], v19 offset:23040
    ds_read_b64_tr_b16 v[146:147], v19 offset:23200
    v_mfma_f32_16x16x32_bf16 v[120:123], v[180:183], v[92:95], v[120:123]
    ds_read_b64_tr_b16 v[148:149], v25 offset:23040
    ds_read_b64_tr_b16 v[150:151], v25 offset:23200
    v_mfma_f32_16x16x32_bf16 v[116:119], v[184:187], v[96:99], v[116:119]
    ds_read_b64_tr_b16 v[152:153], v19 offset:24320
    ds_read_b64_tr_b16 v[154:155], v19 offset:24480
    v_mfma_f32_16x16x32_bf16 v[120:123], v[188:191], v[96:99], v[120:123]
    ds_read_b64_tr_b16 v[156:157], v25 offset:24320
    ds_read_b64_tr_b16 v[158:159], v25 offset:24480
    s_waitcnt vmcnt(0)
    ds_read_b128 v[108:111], v26 offset:18432
    ds_read_b128 v[112:115], v27 offset:18432
    s_waitcnt lgkmcnt(10)
    v_mfma_f32_16x16x32_bf16 v[116:119], v[128:131], v[100:103], v[116:119]
    v_mfma_f32_16x16x32_bf16 v[120:123], v[132:135], v[100:103], v[120:123]
    v_mfma_f32_16x16x32_bf16 v[116:119], v[136:139], v[104:107], v[116:119]
    v_mfma_f32_16x16x32_bf16 v[120:123], v[140:143], v[104:107], v[120:123]
    s_waitcnt lgkmcnt(0)
    v_mfma_f32_16x16x32_bf16 v[116:119], v[144:147], v[108:111], v[116:119]
    v_mfma_f32_16x16x32_bf16 v[120:123], v[148:151], v[108:111], v[120:123]
    v_mfma_f32_16x16x32_bf16 v[116:119], v[152:155], v[112:115], v[116:119]
    v_mfma_f32_16x16x32_bf16 v[120:123], v[156:159], v[112:115], v[120:123]
    s_nop 6
    v_mul_f32 v116, 0x3ea52b5c, v116
    v_mul_f32 v117, 0x3ea52b5c, v117
    v_mul_f32 v118, 0x3ea52b5c, v118
    v_mul_f32 v119, 0x3ea52b5c, v119
    v_mul_f32 v120, 0x3ea52b5c, v120
    v_mul_f32 v121, 0x3ea52b5c, v121
    v_mul_f32 v122, 0x3ea52b5c, v122
    v_mul_f32 v123, 0x3ea52b5c, v123
    v_cvt_pk_bf16_f32 v124, v116, v117
    v_cvt_pk_bf16_f32 v125, v118, v119
    v_cvt_pk_bf16_f32 v126, v120, v121
    v_cvt_pk_bf16_f32 v127, v122, v123
    s_nop 0
    v_permlane16_swap_b32 v124, v126
    v_permlane16_swap_b32 v125, v127
    s_mov_b32 exec_lo, 0xffff
    s_mov_b32 exec_hi, 0xffff
    buffer_store_dwordx4 v[124:127], v11, s[52:55], s7 offen sc1
    s_mov_b32 exec_lo, 0xffff0000
    s_mov_b32 exec_hi, 0
    buffer_store_dwordx2 v[124:125], v10, s[52:55], s50 offen sc1
    s_branch kvdone_8
isv_7:
    v_and_b32 v10, 31, v1
    v_lshlrev_b32 v10, 4, v10
    v_lshrrev_b32 v11, 5, v1
    v_mul_u32_u24 v11, 336, v11
    v_add_u32 v11, v11, v10
    s_mul_i32 s69, s69, 672
    s_mul_i32 s7, s60, 1344
    s_add_u32 s7, s7, s69
    s_add_u32 s7, s7, s62
    s_add_u32 s7, s7, 5120
    s_waitcnt vmcnt(10)
    ds_read_b128 v[36:39], v26 offset:0
    ds_read_b128 v[40:43], v27 offset:0
    s_add_u32 m0, s51, 11520
    s_nop 0
    buffer_load_dwordx4 v17, s[8:11], s66 offen offset:768 lds
    s_add_u32 m0, m0, 1024
    s_nop 0
    buffer_load_dwordx4 v18, s[8:11], s66 offen offset:768 lds
    s_waitcnt vmcnt(10)
    ds_read_b128 v[44:47], v26 offset:2048
    ds_read_b128 v[48:51], v27 offset:2048
    s_add_u32 m0, s51, 13440
    s_nop 0
    buffer_load_dwordx4 v17, s[8:11], s66 offen offset:896 lds
    s_add_u32 m0, m0, 1024
    s_nop 0
    buffer_load_dwordx4 v18, s[8:11], s66 offen offset:896 lds
    s_waitcnt lgkmcnt(2)
    v_mfma_f32_16x16x32_bf16 v[116:119], v[36:39], v[128:131], 0
    ds_read_b64_tr_b16 v[160:161], v19 offset:5120
    ds_read_b64_tr_b16 v[162:163], v19 offset:5280
    v_mfma_f32_16x16x32_bf16 v[120:123], v[36:39], v[132:135], 0
    ds_read_b64_tr_b16 v[164:165], v25 offset:5120
    ds_read_b64_tr_b16 v[166:167], v25 offset:5280
    v_mfma_f32_16x16x32_bf16 v[116:119], v[40:43], v[136:139], v[116:119]
    ds_read_b64_tr_b16 v[168:169], v19 offset:6400
    ds_read_b64_tr_b16 v[170:171], v19 offset:6560
    v_mfma_f32_16x16x32_bf16 v[120:123], v[40:43], v[140:143], v[120:123]
    ds_read_b64_tr_b16 v[172:173], v25 offset:6400
    ds_read_b64_tr_b16 v[174:175], v25 offset:6560
    s_waitcnt vmcnt(10)
    ds_read_b128 v[52:55], v26 offset:4096
    ds_read_b128 v[56:59], v27 offset:4096
    s_add_u32 m0, s51, 15360
    s_nop 0
    buffer_load_dwordx4 v17, s[8:11], s66 offen offset:1024 lds
    s_add_u32 m0, m0, 1024
    s_nop 0
    buffer_load_dwordx4 v18, s[8:11], s66 offen offset:1024 lds
    s_waitcnt lgkmcnt(10)
    v_mfma_f32_16x16x32_bf16 v[116:119], v[44:47], v[144:147], v[116:119]
    ds_read_b64_tr_b16 v[176:177], v19 offset:7680
    ds_read_b64_tr_b16 v[178:179], v19 offset:7840
    v_mfma_f32_16x16x32_bf16 v[120:123], v[44:47], v[148:151], v[120:123]
    ds_read_b64_tr_b16 v[180:181], v25 offset:7680
    ds_read_b64_tr_b16 v[182:183], v25 offset:7840
    v_mfma_f32_16x16x32_bf16 v[116:119], v[48:51], v[152:155], v[116:119]
    ds_read_b64_tr_b16 v[184:185], v19 offset:8960
    ds_read_b64_tr_b16 v[186:187], v19 offset:9120
    v_mfma_f32_16x16x32_bf16 v[120:123], v[48:51], v[156:159], v[120:123]
    ds_read_b64_tr_b16 v[188:189], v25 offset:8960
    ds_read_b64_tr_b16 v[190:191], v25 offset:9120
    s_waitcnt vmcnt(10)
    ds_read_b128 v[60:63], v26 offset:6144
    ds_read_b128 v[64:67], v27 offset:6144
    s_add_u32 m0, s51, 17280
    s_nop 0
    buffer_load_dwordx4 v17, s[8:11], s66 offen offset:1152 lds
    s_add_u32 m0, m0, 1024
    s_nop 0
    buffer_load_dwordx4 v18, s[8:11], s66 offen offset:1152 lds
    s_waitcnt lgkmcnt(10)
    v_mfma_f32_16x16x32_bf16 v[116:119], v[52:55], v[160:163], v[116:119]
    ds_read_b64_tr_b16 v[128:129], v19 offset:10240
    ds_read_b64_tr_b16 v[130:131], v19 offset:10400
    v_mfma_f32_16x16x32_bf16 v[120:123], v[52:55], v[164:167], v[120:123]
    ds_read_b64_tr_b16 v[132:133], v25 offset:10240
    ds_read_b64_tr_b16 v[134:135], v25 offset:10400
    v_mfma_f32_16x16x32_bf16 v[116:119], v[56:59], v[168:171], v[116:119]
    ds_read_b64_tr_b16 v[136:137], v19 offset:11520
    ds_read_b64_tr_b16 v[138:139], v19 offset:11680
    v_mfma_f32_16x16x32_bf16 v[120:123], v[56:59], v[172:175], v[120:123]
    ds_read_b64_tr_b16 v[140:141], v25 offset:11520
    ds_read_b64_tr_b16 v[142:143], v25 offset:11680
    s_waitcnt vmcnt(10)
    ds_read_b128 v[68:71], v26 offset:8192
    ds_read_b128 v[72:75], v27 offset:8192
    s_waitcnt lgkmcnt(10)
    v_mfma_f32_16x16x32_bf16 v[116:119], v[60:63], v[176:179], v[116:119]
    ds_read_b64_tr_b16 v[144:145], v19 offset:12800
    ds_read_b64_tr_b16 v[146:147], v19 offset:12960
    v_mfma_f32_16x16x32_bf16 v[120:123], v[60:63], v[180:183], v[120:123]
    ds_read_b64_tr_b16 v[148:149], v25 offset:12800
    ds_read_b64_tr_b16 v[150:151], v25 offset:12960
    v_mfma_f32_16x16x32_bf16 v[116:119], v[64:67], v[184:187], v[116:119]
    ds_read_b64_tr_b16 v[152:153], v19 offset:14080
    ds_read_b64_tr_b16 v[154:155], v19 offset:14240
    v_mfma_f32_16x16x32_bf16 v[120:123], v[64:67], v[188:191], v[120:123]
    ds_read_b64_tr_b16 v[156:157], v25 offset:14080
    ds_read_b64_tr_b16 v[158:159], v25 offset:14240
    s_waitcnt vmcnt(8)
    ds_read_b128 v[76:79], v26 offset:10240
    ds_read_b128 v[80:83], v27 offset:10240
    s_waitcnt lgkmcnt(10)
    v_mfma_f32_16x16x32_bf16 v[116:119], v[68:71], v[128:131], v[116:119]
    ds_read_b64_tr_b16 v[160:161], v19 offset:15360
    ds_read_b64_tr_b16 v[162:163], v19 offset:15520
    v_mfma_f32_16x16x32_bf16 v[120:123], v[68:71], v[132:135], v[120:123]
    ds_read_b64_tr_b16 v[164:165], v25 offset:15360
    ds_read_b64_tr_b16 v[166:167], v25 offset:15520
    v_mfma_f32_16x16x32_bf16 v[116:119], v[72:75], v[136:139], v[116:119]
    ds_read_b64_tr_b16 v[168:169], v19 offset:16640
    ds_read_b64_tr_b16 v[170:171], v19 offset:16800
    v_mfma_f32_16x16x32_bf16 v[120:123], v[72:75], v[140:143], v[120:123]
    ds_read_b64_tr_b16 v[172:173], v25 offset:16640
    ds_read_b64_tr_b16 v[174:175], v25 offset:16800
    s_waitcnt vmcnt(6)
    ds_read_b128 v[84:87], v26 offset:12288
    ds_read_b128 v[88:91], v27 offset:12288
    s_waitcnt lgkmcnt(10)
    v_mfma_f32_16x16x32_bf16 v[116:119], v[76:79], v[144:147], v[116:119]
    ds_read_b64_tr_b16 v[176:177], v19 offset:17920
    ds_read_b64_tr_b16 v[178:179], v19 offset:18080
    v_mfma_f32_16x16x32_bf16 v[120:123], v[76:79], v[148:151], v[120:123]
    ds_read_b64_tr_b16 v[180:181], v25 offset:17920
    ds_read_b64_tr_b16 v[182:183], v25 offset:18080
    v_mfma_f32_16x16x32_bf16 v[116:119], v[80:83], v[152:155], v[116:119]
    ds_read_b64_tr_b16 v[184:185], v19 offset:19200
    ds_read_b64_tr_b16 v[186:187], v19 offset:19360
    v_mfma_f32_16x16x32_bf16 v[120:123], v[80:83], v[156:159], v[120:123]
    ds_read_b64_tr_b16 v[188:189], v25 offset:19200
    ds_read_b64_tr_b16 v[190:191], v25 offset:19360
    s_waitcnt vmcnt(4)
    ds_read_b128 v[92:95], v26 offset:14336
    ds_read_b128 v[96:99], v27 offset:14336
    s_waitcnt lgkmcnt(10)
    v_mfma_f32_16x16x32_bf16 v[116:119], v[84:87], v[160:163], v[116:119]
    ds_read_b64_tr_b16 v[128:129], v19 offset:20480
    ds_read_b64_tr_b16 v[130:131], v19 offset:20640
    v_mfma_f32_16x16x32_bf16 v[120:123], v[84:87], v[164:167], v[120:123]
    ds_read_b64_tr_b16 v[132:133], v25 offset:20480
    ds_read_b64_tr_b16 v[134:135], v25 offset:20640
    v_mfma_f32_16x16x32_bf16 v[116:119], v[88:91], v[168:171], v[116:119]
    ds_read_b64_tr_b16 v[136:137], v19 offset:21760
    ds_read_b64_tr_b16 v[138:139], v19 offset:21920
    v_mfma_f32_16x16x32_bf16 v[120:123], v[88:91], v[172:175], v[120:123]
    ds_read_b64_tr_b16 v[140:141], v25 offset:21760
    ds_read_b64_tr_b16 v[142:143], v25 offset:21920
    s_waitcnt vmcnt(2)
    ds_read_b128 v[100:103], v26 offset:16384
    ds_read_b128 v[104:107], v27 offset:16384
    s_waitcnt lgkmcnt(10)
    v_mfma_f32_16x16x32_bf16 v[116:119], v[92:95], v[176:179], v[116:119]
    ds_read_b64_tr_b16 v[144:145], v19 offset:23040
    ds_read_b64_tr_b16 v[146:147], v19 offset:23200
    v_mfma_f32_16x16x32_bf16 v[120:123], v[92:95], v[180:183], v[120:123]
    ds_read_b64_tr_b16 v[148:149], v25 offset:23040
    ds_read_b64_tr_b16 v[150:151], v25 offset:23200
    v_mfma_f32_16x16x32_bf16 v[116:119], v[96:99], v[184:187], v[116:119]
    ds_read_b64_tr_b16 v[152:153], v19 offset:24320
    ds_read_b64_tr_b16 v[154:155], v19 offset:24480
    v_mfma_f32_16x16x32_bf16 v[120:123], v[96:99], v[188:191], v[120:123]
    ds_read_b64_tr_b16 v[156:157], v25 offset:24320
    ds_read_b64_tr_b16 v[158:159], v25 offset:24480
    s_waitcnt vmcnt(0)
    ds_read_b128 v[108:111], v26 offset:18432
    ds_read_b128 v[112:115], v27 offset:18432
    s_waitcnt lgkmcnt(10)
    v_mfma_f32_16x16x32_bf16 v[116:119], v[100:103], v[128:131], v[116:119]
    v_mfma_f32_16x16x32_bf16 v[120:123], v[100:103], v[132:135], v[120:123]
    v_mfma_f32_16x16x32_bf16 v[116:119], v[104:107], v[136:139], v[116:119]
    v_mfma_f32_16x16x32_bf16 v[120:123], v[104:107], v[140:143], v[120:123]
    s_waitcnt lgkmcnt(0)
    v_mfma_f32_16x16x32_bf16 v[116:119], v[108:111], v[144:147], v[116:119]
    v_mfma_f32_16x16x32_bf16 v[120:123], v[108:111], v[148:151], v[120:123]
    v_mfma_f32_16x16x32_bf16 v[116:119], v[112:115], v[152:155], v[116:119]
    v_mfma_f32_16x16x32_bf16 v[120:123], v[112:115], v[156:159], v[120:123]
    s_nop 6
    v_cvt_pk_bf16_f32 v124, v116, v117
    v_cvt_pk_bf16_f32 v125, v118, v119
    v_cvt_pk_bf16_f32 v126, v120, v121
    v_cvt_pk_bf16_f32 v127, v122, v123
    s_nop 0
    v_permlane16_swap_b32 v124, v126
    v_permlane16_swap_b32 v125, v127
    s_mov_b32 exec_lo, 0x100000
    s_mov_b32 exec_hi, 0x100000
    v_mov_b32 v124, 0x3f803f80
    v_mov_b32 v125, 0x3f803f80
    v_mov_b32 v126, 0x3f803f80
    v_mov_b32 v127, 0x3f803f80
    s_mov_b32 exec_lo, 0x1fffff
    s_mov_b32 exec_hi, 0x1fffff
    buffer_store_dwordx4 v[124:127], v11, s[52:55], s7 offen sc1
kvdone_8:
    s_mov_b64 exec, -1
    s_lshl_b32 s67, s3, 2
    v_add_u32 v8, s67, v13
    s_mov_b64 exec, 1
    ds_add_u32 v8, v14 offset:32
    s_mov_b64 exec, -1
    s_waitcnt vmcnt(0)
    s_lshl_b32 s7, s2, 7
    s_lshl_b32 s50, s3, 2
    s_add_u32 s7, s7, s50
    s_add_u32 s7, s7, 4096
    v_mov_b32 v8, s6
    s_mov_b64 exec, 1
    buffer_store_dword v8, off, s[52:55], s7 sc1
    s_mov_b64 exec, -1
    s_mov_b32 s64, 800000
ls_9:
    ds_read_b32 v8, v13 offset:4
    s_sub_u32 s64, s64, 1
    s_cbranch_scc1 lsd_10
    s_waitcnt lgkmcnt(0)
    v_cmp_gt_u32 vcc, 4, v8
    s_cbranch_vccnz ls_9
lsd_10:
    ds_read_b64_tr_b16 v[136:137], v32 offset:0
    ds_read_b64_tr_b16 v[138:139], v33 offset:0
    ds_read_b64_tr_b16 v[140:141], v32 offset:8
    ds_read_b64_tr_b16 v[142:143], v33 offset:8
    ds_read_b64_tr_b16 v[144:145], v32 offset:80
    ds_read_b64_tr_b16 v[146:147], v33 offset:80
    ds_read_b64_tr_b16 v[148:149], v32 offset:88
    ds_read_b64_tr_b16 v[150:151], v33 offset:88
    ds_read_b64_tr_b16 v[152:153], v34 offset:0
    ds_read_b64_tr_b16 v[154:155], v35 offset:0
    ds_read_b64_tr_b16 v[156:157], v32 offset:5120
    ds_read_b64_tr_b16 v[158:159], v33 offset:5120
    ds_read_b64_tr_b16 v[160:161], v32 offset:5128
    ds_read_b64_tr_b16 v[162:163], v33 offset:5128
    ds_read_b64_tr_b16 v[164:165], v32 offset:5200
    ds_read_b64_tr_b16 v[166:167], v33 offset:5200
    ds_read_b64_tr_b16 v[168:169], v32 offset:5208
    ds_read_b64_tr_b16 v[170:171], v33 offset:5208
    ds_read_b64_tr_b16 v[172:173], v34 offset:5120
    ds_read_b64_tr_b16 v[174:175], v35 offset:5120
    s_waitcnt lgkmcnt(10)
    v_mfma_f32_16x16x32_bf16 v[116:119], v[136:139], v[100:103], 0
    ds_read_b64_tr_b16 v[176:177], v32 offset:10240
    ds_read_b64_tr_b16 v[178:179], v33 offset:10240
    v_mfma_f32_16x16x32_bf16 v[120:123], v[140:143], v[100:103], 0
    ds_read_b64_tr_b16 v[180:181], v32 offset:10248
    ds_read_b64_tr_b16 v[182:183], v33 offset:10248
    v_mfma_f32_16x16x32_bf16 v[124:127], v[144:147], v[100:103], 0
    ds_read_b64_tr_b16 v[184:185], v32 offset:10320
    ds_read_b64_tr_b16 v[186:187], v33 offset:10320
    v_mfma_f32_16x16x32_bf16 v[128:131], v[148:151], v[100:103], 0
    ds_read_b64_tr_b16 v[188:189], v32 offset:10328
    ds_read_b64_tr_b16 v[190:191], v33 offset:10328
    v_mfma_f32_16x16x32_bf16 v[132:135], v[152:155], v[100:103], 0
    ds_read_b64_tr_b16 v[192:193], v34 offset:10240
    ds_read_b64_tr_b16 v[194:195], v35 offset:10240
    s_waitcnt lgkmcnt(10)
    v_mfma_f32_16x16x32_bf16 v[116:119], v[156:159], v[104:107], v[116:119]
    ds_read_b64_tr_b16 v[136:137], v32 offset:15360
    ds_read_b64_tr_b16 v[138:139], v33 offset:15360
    v_mfma_f32_16x16x32_bf16 v[120:123], v[160:163], v[104:107], v[120:123]
    ds_read_b64_tr_b16 v[140:141], v32 offset:15368
    ds_read_b64_tr_b16 v[142:143], v33 offset:15368
    v_mfma_f32_16x16x32_bf16 v[124:127], v[164:167], v[104:107], v[124:127]
    ds_read_b64_tr_b16 v[144:145], v32 offset:15440
    ds_read_b64_tr_b16 v[146:147], v33 offset:15440
    v_mfma_f32_16x16x32_bf16 v[128:131], v[168:171], v[104:107], v[128:131]
    ds_read_b64_tr_b16 v[148:149], v32 offset:15448
    ds_read_b64_tr_b16 v[150:151], v33 offset:15448
    v_mfma_f32_16x16x32_bf16 v[132:135], v[172:175], v[104:107], v[132:135]
    ds_read_b64_tr_b16 v[152:153], v34 offset:15360
    ds_read_b64_tr_b16 v[154:155], v35 offset:15360
    ds_read_b32 v8, v13 offset:8
    s_waitcnt lgkmcnt(11)
    v_mfma_f32_16x16x32_bf16 v[116:119], v[176:179], v[108:111], v[116:119]
    v_mfma_f32_16x16x32_bf16 v[120:123], v[180:183], v[108:111], v[120:123]
    v_mfma_f32_16x16x32_bf16 v[124:127], v[184:187], v[108:111], v[124:127]
    s_waitcnt lgkmcnt(0)
    v_cmp_gt_u32 vcc, 4, v8
    s_cbranch_vccnz spin_11
back_12:
    ds_read_b64_tr_b16 v[156:157], v32 offset:21504
    ds_read_b64_tr_b16 v[158:159], v33 offset:21504
    ds_read_b64_tr_b16 v[160:161], v32 offset:21512
    ds_read_b64_tr_b16 v[162:163], v33 offset:21512
    v_mfma_f32_16x16x32_bf16 v[128:131], v[188:191], v[108:111], v[128:131]
    ds_read_b64_tr_b16 v[164:165], v32 offset:21584
    ds_read_b64_tr_b16 v[166:167], v33 offset:21584
    ds_read_b64_tr_b16 v[168:169], v32 offset:21592
    v_mfma_f32_16x16x32_bf16 v[132:135], v[192:195], v[108:111], v[132:135]
    ds_read_b64_tr_b16 v[170:171], v33 offset:21592
    ds_read_b64_tr_b16 v[172:173], v34 offset:21504
    ds_read_b64_tr_b16 v[174:175], v35 offset:21504
    v_mfma_f32_16x16x32_bf16 v[116:119], v[136:139], v[112:115], v[116:119]
    ds_read_b64_tr_b16 v[176:177], v32 offset:41984
    ds_read_b64_tr_b16 v[178:179], v33 offset:41984
    v_mfma_f32_16x16x32_bf16 v[120:123], v[140:143], v[112:115], v[120:123]
    ds_read_b64_tr_b16 v[180:181], v32 offset:41992
    ds_read_b64_tr_b16 v[182:183], v33 offset:41992
    v_mfma_f32_16x16x32_bf16 v[124:127], v[144:147], v[112:115], v[124:127]
    ds_read_b64_tr_b16 v[184:185], v32 offset:42064
    ds_read_b64_tr_b16 v[186:187], v33 offset:42064
    v_mfma_f32_16x16x32_bf16 v[128:131], v[148:151], v[112:115], v[128:131]
    ds_read_b64_tr_b16 v[188:189], v32 offset:42072
    ds_read_b64_tr_b16 v[190:191], v33 offset:42072
    v_mfma_f32_16x16x32_bf16 v[132:135], v[152:155], v[112:115], v[132:135]
    ds_read_b64_tr_b16 v[192:193], v34 offset:41984
    ds_read_b64_tr_b16 v[194:195], v35 offset:41984
    ds_add_u32 v7, v14 offset:48
    s_waitcnt lgkmcnt(11)
    v_mfma_f32_16x16x32_bf16 v[116:119], v[156:159], v[36:39], v[116:119]
    ds_read_b64_tr_b16 v[136:137], v28 offset:11264
    ds_read_b64_tr_b16 v[138:139], v29 offset:11264
    v_mfma_f32_16x16x32_bf16 v[120:123], v[160:163], v[36:39], v[120:123]
    ds_read_b64_tr_b16 v[140:141], v28 offset:11272
    ds_read_b64_tr_b16 v[142:143], v29 offset:11272
    v_mfma_f32_16x16x32_bf16 v[124:127], v[164:167], v[36:39], v[124:127]
    ds_read_b64_tr_b16 v[144:145], v28 offset:11344
    ds_read_b64_tr_b16 v[146:147], v29 offset:11344
    v_mfma_f32_16x16x32_bf16 v[128:131], v[168:171], v[36:39], v[128:131]
    ds_read_b64_tr_b16 v[148:149], v28 offset:11352
    ds_read_b64_tr_b16 v[150:151], v29 offset:11352
    v_mfma_f32_16x16x32_bf16 v[132:135], v[172:175], v[36:39], v[132:135]
    ds_read_b64_tr_b16 v[152:153], v30 offset:11264
    ds_read_b64_tr_b16 v[154:155], v31 offset:11264
    s_waitcnt lgkmcnt(11)
    v_mfma_f32_16x16x32_bf16 v[116:119], v[176:179], v[52:55], v[116:119]
    ds_read_b64_tr_b16 v[156:157], v28 offset:31744
    ds_read_b64_tr_b16 v[158:159], v29 offset:31744
    v_mfma_f32_16x16x32_bf16 v[120:123], v[180:183], v[52:55], v[120:123]
    ds_read_b64_tr_b16 v[160:161], v28 offset:31752
    ds_read_b64_tr_b16 v[162:163], v29 offset:31752
    v_mfma_f32_16x16x32_bf16 v[124:127], v[184:187], v[52:55], v[124:127]
    ds_read_b64_tr_b16 v[164:165], v28 offset:31824
    ds_read_b64_tr_b16 v[166:167], v29 offset:31824
    v_mfma_f32_16x16x32_bf16 v[128:131], v[188:191], v[52:55], v[128:131]
    ds_read_b64_tr_b16 v[168:169], v28 offset:31832
    ds_read_b64_tr_b16 v[170:171], v29 offset:31832
    v_mfma_f32_16x16x32_bf16 v[132:135], v[192:195], v[52:55], v[132:135]
    ds_read_b64_tr_b16 v[172:173], v30 offset:31744
    ds_read_b64_tr_b16 v[174:175], v31 offset:31744
    ds_read_b32 v8, v13 offset:20
    s_waitcnt lgkmcnt(11)
    v_mfma_f32_16x16x32_bf16 v[116:119], v[136:139], v[68:71], v[116:119]
    v_mfma_f32_16x16x32_bf16 v[120:123], v[140:143], v[68:71], v[120:123]
    v_mfma_f32_16x16x32_bf16 v[124:127], v[144:147], v[68:71], v[124:127]
    s_waitcnt lgkmcnt(0)
    v_cmp_gt_u32 vcc, 4, v8
    s_cbranch_vccnz spin_13
back_14:
    ds_read_b64_tr_b16 v[176:177], v32 offset:26624
    ds_read_b64_tr_b16 v[178:179], v33 offset:26624
    ds_read_b64_tr_b16 v[180:181], v32 offset:26632
    ds_read_b64_tr_b16 v[182:183], v33 offset:26632
    v_mfma_f32_16x16x32_bf16 v[128:131], v[148:151], v[68:71], v[128:131]
    ds_read_b64_tr_b16 v[184:185], v32 offset:26704
    ds_read_b64_tr_b16 v[186:187], v33 offset:26704
    ds_read_b64_tr_b16 v[188:189], v32 offset:26712
    v_mfma_f32_16x16x32_bf16 v[132:135], v[152:155], v[68:71], v[132:135]
    ds_read_b64_tr_b16 v[190:191], v33 offset:26712
    ds_read_b64_tr_b16 v[192:193], v34 offset:26624
    ds_read_b64_tr_b16 v[194:195], v35 offset:26624
    v_mfma_f32_16x16x32_bf16 v[116:119], v[156:159], v[84:87], v[116:119]
    ds_read_b64_tr_b16 v[136:137], v32 offset:47104
    ds_read_b64_tr_b16 v[138:139], v33 offset:47104
    v_mfma_f32_16x16x32_bf16 v[120:123], v[160:163], v[84:87], v[120:123]
    ds_read_b64_tr_b16 v[140:141], v32 offset:47112
    ds_read_b64_tr_b16 v[142:143], v33 offset:47112
    v_mfma_f32_16x16x32_bf16 v[124:127], v[164:167], v[84:87], v[124:127]
    ds_read_b64_tr_b16 v[144:145], v32 offset:47184
    ds_read_b64_tr_b16 v[146:147], v33 offset:47184
    v_mfma_f32_16x16x32_bf16 v[128:131], v[168:171], v[84:87], v[128:131]
    ds_read_b64_tr_b16 v[148:149], v32 offset:47192
    ds_read_b64_tr_b16 v[150:151], v33 offset:47192
    v_mfma_f32_16x16x32_bf16 v[132:135], v[172:175], v[84:87], v[132:135]
    ds_read_b64_tr_b16 v[152:153], v34 offset:47104
    ds_read_b64_tr_b16 v[154:155], v35 offset:47104
    buffer_load_dword v16, v15, s[52:55], 0 offen sc1
    s_waitcnt lgkmcnt(10)
    v_mfma_f32_16x16x32_bf16 v[116:119], v[176:179], v[40:43], v[116:119]
    ds_read_b64_tr_b16 v[156:157], v28 offset:16384
    ds_read_b64_tr_b16 v[158:159], v29 offset:16384
    v_mfma_f32_16x16x32_bf16 v[120:123], v[180:183], v[40:43], v[120:123]
    ds_read_b64_tr_b16 v[160:161], v28 offset:16392
    ds_read_b64_tr_b16 v[162:163], v29 offset:16392
    v_mfma_f32_16x16x32_bf16 v[124:127], v[184:187], v[40:43], v[124:127]
    ds_read_b64_tr_b16 v[164:165], v28 offset:16464
    ds_read_b64_tr_b16 v[166:167], v29 offset:16464
    v_mfma_f32_16x16x32_bf16 v[128:131], v[188:191], v[40:43], v[128:131]
    ds_read_b64_tr_b16 v[168:169], v28 offset:16472
    ds_read_b64_tr_b16 v[170:171], v29 offset:16472
    v_mfma_f32_16x16x32_bf16 v[132:135], v[192:195], v[40:43], v[132:135]
    ds_read_b64_tr_b16 v[172:173], v30 offset:16384
    ds_read_b64_tr_b16 v[174:175], v31 offset:16384
    s_waitcnt lgkmcnt(10)
    v_mfma_f32_16x16x32_bf16 v[116:119], v[136:139], v[56:59], v[116:119]
    ds_read_b64_tr_b16 v[176:177], v28 offset:36864
    ds_read_b64_tr_b16 v[178:179], v29 offset:36864
    v_mfma_f32_16x16x32_bf16 v[120:123], v[140:143], v[56:59], v[120:123]
    ds_read_b64_tr_b16 v[180:181], v28 offset:36872
    ds_read_b64_tr_b16 v[182:183], v29 offset:36872
    v_mfma_f32_16x16x32_bf16 v[124:127], v[144:147], v[56:59], v[124:127]
    ds_read_b64_tr_b16 v[184:185], v28 offset:36944
    ds_read_b64_tr_b16 v[186:187], v29 offset:36944
    v_mfma_f32_16x16x32_bf16 v[128:131], v[148:151], v[56:59], v[128:131]
    ds_read_b64_tr_b16 v[188:189], v28 offset:36952
    ds_read_b64_tr_b16 v[190:191], v29 offset:36952
    v_mfma_f32_16x16x32_bf16 v[132:135], v[152:155], v[56:59], v[132:135]
    ds_read_b64_tr_b16 v[192:193], v30 offset:36864
    ds_read_b64_tr_b16 v[194:195], v31 offset:36864
    ds_read_b32 v8, v13 offset:24
    s_waitcnt lgkmcnt(11)
    v_mfma_f32_16x16x32_bf16 v[116:119], v[156:159], v[72:75], v[116:119]
    v_mfma_f32_16x16x32_bf16 v[120:123], v[160:163], v[72:75], v[120:123]
    v_mfma_f32_16x16x32_bf16 v[124:127], v[164:167], v[72:75], v[124:127]
    s_waitcnt lgkmcnt(0)
    v_cmp_gt_u32 vcc, 4, v8
    s_cbranch_vccnz spin_15
back_16:
    ds_read_b64_tr_b16 v[136:137], v32 offset:31744
    ds_read_b64_tr_b16 v[138:139], v33 offset:31744
    ds_read_b64_tr_b16 v[140:141], v32 offset:31752
    ds_read_b64_tr_b16 v[142:143], v33 offset:31752
    v_mfma_f32_16x16x32_bf16 v[128:131], v[168:171], v[72:75], v[128:131]
    ds_read_b64_tr_b16 v[144:145], v32 offset:31824
    ds_read_b64_tr_b16 v[146:147], v33 offset:31824
    ds_read_b64_tr_b16 v[148:149], v32 offset:31832
    v_mfma_f32_16x16x32_bf16 v[132:135], v[172:175], v[72:75], v[132:135]
    ds_read_b64_tr_b16 v[150:151], v33 offset:31832
    ds_read_b64_tr_b16 v[152:153], v34 offset:31744
    ds_read_b64_tr_b16 v[154:155], v35 offset:31744
    v_mfma_f32_16x16x32_bf16 v[116:119], v[176:179], v[88:91], v[116:119]
    ds_read_b64_tr_b16 v[156:157], v28 offset:1024
    ds_read_b64_tr_b16 v[158:159], v29 offset:1024
    v_mfma_f32_16x16x32_bf16 v[120:123], v[180:183], v[88:91], v[120:123]
    ds_read_b64_tr_b16 v[160:161], v28 offset:1032
    ds_read_b64_tr_b16 v[162:163], v29 offset:1032
    v_mfma_f32_16x16x32_bf16 v[124:127], v[184:187], v[88:91], v[124:127]
    ds_read_b64_tr_b16 v[164:165], v28 offset:1104
    ds_read_b64_tr_b16 v[166:167], v29 offset:1104
    v_mfma_f32_16x16x32_bf16 v[128:131], v[188:191], v[88:91], v[128:131]
    ds_read_b64_tr_b16 v[168:169], v28 offset:1112
    ds_read_b64_tr_b16 v[170:171], v29 offset:1112
    v_mfma_f32_16x16x32_bf16 v[132:135], v[192:195], v[88:91], v[132:135]
    ds_read_b64_tr_b16 v[172:173], v30 offset:1024
    ds_read_b64_tr_b16 v[174:175], v31 offset:1024
    s_mov_b32 s64, 800000
ls_17:
    ds_read_b32 v8, v13 offset:48
    s_sub_u32 s64, s64, 1
    s_cbranch_scc1 lsd_18
    s_waitcnt lgkmcnt(0)
    v_cmp_gt_u32 vcc, 4, v8
    s_cbranch_vccnz ls_17
lsd_18:
    s_waitcnt vmcnt(0)
    v_cmp_ne_u32 vcc, s6, v16
    s_mov_b64 s[56:57], s[52:53]
    s_mov_b32 s59, s55
    s_cmp_eq_u64 vcc, 0
    s_cselect_b32 s58, s54, 0
    s_cselect_b32 s63, 1, 0
    s_waitcnt lgkmcnt(10)
    v_mfma_f32_16x16x32_bf16 v[116:119], v[136:139], v[44:47], v[116:119]
    ds_read_b64_tr_b16 v[176:177], v28 offset:21504
    ds_read_b64_tr_b16 v[178:179], v29 offset:21504
    v_mfma_f32_16x16x32_bf16 v[120:123], v[140:143], v[44:47], v[120:123]
    ds_read_b64_tr_b16 v[180:181], v28 offset:21512
    ds_read_b64_tr_b16 v[182:183], v29 offset:21512
    v_mfma_f32_16x16x32_bf16 v[124:127], v[144:147], v[44:47], v[124:127]
    ds_read_b64_tr_b16 v[184:185], v28 offset:21584
    ds_read_b64_tr_b16 v[186:187], v29 offset:21584
    v_mfma_f32_16x16x32_bf16 v[128:131], v[148:151], v[44:47], v[128:131]
    ds_read_b64_tr_b16 v[188:189], v28 offset:21592
    ds_read_b64_tr_b16 v[190:191], v29 offset:21592
    s_lshr_b32 s62, s4, 2
    s_mul_i32 s62, s62, 21504
    s_add_u32 s62, s62, 131072
    s_lshr_b32 s7, s3, 1
    s_mul_i32 s7, s7, 10496
    s_and_b32 s50, s3, 1
    s_mul_i32 s69, s50, 2048
    s_add_u32 s69, s69, s7
    s_add_u32 m0, s69, 0
    s_add_u32 s69, s69, s62
    buffer_load_dwordx4 v12, s[56:59], s69 offen offset:0 sc1 lds
    v_mfma_f32_16x16x32_bf16 v[132:135], v[152:155], v[44:47], v[132:135]
    ds_read_b64_tr_b16 v[192:193], v30 offset:21504
    ds_read_b64_tr_b16 v[194:195], v31 offset:21504
    s_waitcnt lgkmcnt(10)
    v_mfma_f32_16x16x32_bf16 v[116:119], v[156:159], v[60:63], v[116:119]
    ds_read_b64_tr_b16 v[136:137], v28 offset:41984
    ds_read_b64_tr_b16 v[138:139], v29 offset:41984
    buffer_load_dwordx4 v12, s[56:59], s69 offen offset:1024 sc1 lds
    v_mfma_f32_16x16x32_bf16 v[120:123], v[160:163], v[60:63], v[120:123]
    ds_read_b64_tr_b16 v[140:141], v28 offset:41992
    ds_read_b64_tr_b16 v[142:143], v29 offset:41992
    v_mfma_f32_16x16x32_bf16 v[124:127], v[164:167], v[60:63], v[124:127]
    ds_read_b64_tr_b16 v[144:145], v28 offset:42064
    ds_read_b64_tr_b16 v[146:147], v29 offset:42064
    s_mul_i32 s69, s50, 512
    s_add_u32 s69, s69, s7
    s_add_u32 m0, s69, 4096
    s_add_u32 s69, s69, s62
    s_add_u32 s69, s69, 4096
    s_mov_b32 exec_hi, 0
    buffer_load_dwordx4 v12, s[56:59], s69 offen offset:0 sc1 lds
    s_mov_b32 exec_hi, -1
    v_mfma_f32_16x16x32_bf16 v[128:131], v[168:171], v[60:63], v[128:131]
    ds_read_b64_tr_b16 v[148:149], v28 offset:42072
    ds_read_b64_tr_b16 v[150:151], v29 offset:42072
    v_mfma_f32_16x16x32_bf16 v[132:135], v[172:175], v[60:63], v[132:135]
    ds_read_b64_tr_b16 v[152:153], v30 offset:41984
    ds_read_b64_tr_b16 v[154:155], v31 offset:41984
    s_mul_i32 s69, s50, 2688
    s_add_u32 s69, s69, s7
    s_add_u32 m0, s69, 5120
    s_add_u32 s69, s69, s62
    s_add_u32 s69, s69, 5120
    buffer_load_dwordx4 v12, s[56:59], s69 offen offset:0 sc1 lds
    ds_read_b32 v8, v13 offset:28
    s_waitcnt lgkmcnt(11)
    v_mfma_f32_16x16x32_bf16 v[116:119], v[176:179], v[76:79], v[116:119]
    v_mfma_f32_16x16x32_bf16 v[120:123], v[180:183], v[76:79], v[120:123]
    buffer_load_dwordx4 v12, s[56:59], s69 offen offset:1024 sc1 lds
    v_mfma_f32_16x16x32_bf16 v[124:127], v[184:187], v[76:79], v[124:127]
    s_waitcnt lgkmcnt(0)
    v_cmp_gt_u32 vcc, 4, v8
    s_cbranch_vccnz spin_19
back_20:
    ds_read_b64_tr_b16 v[156:157], v32 offset:36864
    ds_read_b64_tr_b16 v[158:159], v33 offset:36864
    ds_read_b64_tr_b16 v[160:161], v32 offset:36872
    ds_read_b64_tr_b16 v[162:163], v33 offset:36872
    v_mfma_f32_16x16x32_bf16 v[128:131], v[188:191], v[76:79], v[128:131]
    ds_read_b64_tr_b16 v[164:165], v32 offset:36944
    ds_read_b64_tr_b16 v[166:167], v33 offset:36944
    ds_read_b64_tr_b16 v[168:169], v32 offset:36952
    s_mov_b32 exec_hi, 255
    buffer_load_dwordx4 v12, s[56:59], s69 offen offset:2048 sc1 lds
    s_mov_b32 exec_hi, -1
    v_mfma_f32_16x16x32_bf16 v[132:135], v[192:195], v[76:79], v[132:135]
    ds_read_b64_tr_b16 v[170:171], v33 offset:36952
    ds_read_b64_tr_b16 v[172:173], v34 offset:36864
    ds_read_b64_tr_b16 v[174:175], v35 offset:36864
    v_mfma_f32_16x16x32_bf16 v[116:119], v[136:139], v[92:95], v[116:119]
    ds_read_b64_tr_b16 v[176:177], v28 offset:6144
    ds_read_b64_tr_b16 v[178:179], v29 offset:6144
    v_mfma_f32_16x16x32_bf16 v[120:123], v[140:143], v[92:95], v[120:123]
    ds_read_b64_tr_b16 v[180:181], v28 offset:6152
    ds_read_b64_tr_b16 v[182:183], v29 offset:6152
    v_mfma_f32_16x16x32_bf16 v[124:127], v[144:147], v[92:95], v[124:127]
    ds_read_b64_tr_b16 v[184:185], v28 offset:6224
    ds_read_b64_tr_b16 v[186:187], v29 offset:6224
    v_mfma_f32_16x16x32_bf16 v[128:131], v[148:151], v[92:95], v[128:131]
    ds_read_b64_tr_b16 v[188:189], v28 offset:6232
    ds_read_b64_tr_b16 v[190:191], v29 offset:6232
    v_mfma_f32_16x16x32_bf16 v[132:135], v[152:155], v[92:95], v[132:135]
    ds_read_b64_tr_b16 v[192:193], v30 offset:6144
    ds_read_b64_tr_b16 v[194:195], v31 offset:6144
    s_waitcnt lgkmcnt(10)
    v_mfma_f32_16x16x32_bf16 v[116:119], v[156:159], v[48:51], v[116:119]
    ds_read_b64_tr_b16 v[136:137], v28 offset:26624
    ds_read_b64_tr_b16 v[138:139], v29 offset:26624
    v_mfma_f32_16x16x32_bf16 v[120:123], v[160:163], v[48:51], v[120:123]
    ds_read_b64_tr_b16 v[140:141], v28 offset:26632
    ds_read_b64_tr_b16 v[142:143], v29 offset:26632
    v_mfma_f32_16x16x32_bf16 v[124:127], v[164:167], v[48:51], v[124:127]
    ds_read_b64_tr_b16 v[144:145], v28 offset:26704
    ds_read_b64_tr_b16 v[146:147], v29 offset:26704
    v_mfma_f32_16x16x32_bf16 v[128:131], v[168:171], v[48:51], v[128:131]
    ds_read_b64_tr_b16 v[148:149], v28 offset:26712
    ds_read_b64_tr_b16 v[150:151], v29 offset:26712
    v_mfma_f32_16x16x32_bf16 v[132:135], v[172:175], v[48:51], v[132:135]
    ds_read_b64_tr_b16 v[152:153], v30 offset:26624
    ds_read_b64_tr_b16 v[154:155], v31 offset:26624
    s_waitcnt lgkmcnt(10)
    v_mfma_f32_16x16x32_bf16 v[116:119], v[176:179], v[64:67], v[116:119]
    ds_read_b64_tr_b16 v[156:157], v28 offset:47104
    ds_read_b64_tr_b16 v[158:159], v29 offset:47104
    v_mfma_f32_16x16x32_bf16 v[120:123], v[180:183], v[64:67], v[120:123]
    ds_read_b64_tr_b16 v[160:161], v28 offset:47112
    ds_read_b64_tr_b16 v[162:163], v29 offset:47112
    v_mfma_f32_16x16x32_bf16 v[124:127], v[184:187], v[64:67], v[124:127]
    ds_read_b64_tr_b16 v[164:165], v28 offset:47184
    ds_read_b64_tr_b16 v[166:167], v29 offset:47184
    v_mfma_f32_16x16x32_bf16 v[128:131], v[188:191], v[64:67], v[128:131]
    ds_read_b64_tr_b16 v[168:169], v28 offset:47192
    ds_read_b64_tr_b16 v[170:171], v29 offset:47192
    v_mfma_f32_16x16x32_bf16 v[132:135], v[192:195], v[64:67], v[132:135]
    ds_read_b64_tr_b16 v[172:173], v30 offset:47104
    ds_read_b64_tr_b16 v[174:175], v31 offset:47104
    s_waitcnt lgkmcnt(10)
    v_mfma_f32_16x16x32_bf16 v[116:119], v[136:139], v[80:83], v[116:119]
    v_mfma_f32_16x16x32_bf16 v[120:123], v[140:143], v[80:83], v[120:123]
    v_mfma_f32_16x16x32_bf16 v[124:127], v[144:147], v[80:83], v[124:127]
    v_mfma_f32_16x16x32_bf16 v[128:131], v[148:151], v[80:83], v[128:131]
    v_mfma_f32_16x16x32_bf16 v[132:135], v[152:155], v[80:83], v[132:135]
    s_waitcnt lgkmcnt(0)
    s_waitcnt vmcnt(0)
    s_cmp_eq_u32 s63, 0
    s_cbranch_scc1 z_21
    ds_add_u32 v7, v14 offset:16
z_21:
    v_mfma_f32_16x16x32_bf16 v[116:119], v[156:159], v[96:99], v[116:119]
    v_mfma_f32_16x16x32_bf16 v[120:123], v[160:163], v[96:99], v[120:123]
    v_mfma_f32_16x16x32_bf16 v[124:127], v[164:167], v[96:99], v[124:127]
    v_mfma_f32_16x16x32_bf16 v[128:131], v[168:171], v[96:99], v[128:131]
    v_mfma_f32_16x16x32_bf16 v[132:135], v[172:175], v[96:99], v[132:135]
    s_branch join_4
qonly_3:
    s_lshl_b32 s67, s65, 2
    s_add_u32 s67, s67, s3
    s_mul_i32 s67, s67, 40960
    s_add_u32 s67, s67, s68
    s_mul_i32 m0, s3, 5120
    s_nop 0
    buffer_load_dwordx4 v20, s[12:15], s67 offen offset:0 lds
    buffer_load_dwordx4 v21, s[12:15], s67 offen offset:1024 lds
    buffer_load_dwordx4 v22, s[12:15], s67 offen offset:2048 lds
    buffer_load_dwordx4 v23, s[12:15], s67 offen offset:3072 lds
    s_add_u32 m0, m0, 4096
    s_nop 0
    buffer_load_dwordx4 v24, s[12:15], s67 offen lds
    s_add_u32 m0, m0, 1024
    s_add_u32 s65, s65, 1
    s_cmp_eq_u32 s65, 5
    s_cselect_b32 s65, 0, s65
    s_lshl_b32 s67, s65, 2
    s_add_u32 s67, s67, s3
    s_mul_i32 s67, s67, 40960
    s_add_u32 s67, s67, s68
    s_add_u32 m0, s51, 0
    s_nop 0
    buffer_load_dwordx4 v20, s[12:15], s67 offen offset:0 lds
    buffer_load_dwordx4 v21, s[12:15], s67 offen offset:1024 lds
    buffer_load_dwordx4 v22, s[12:15], s67 offen offset:2048 lds
    buffer_load_dwordx4 v23, s[12:15], s67 offen offset:3072 lds
    s_add_u32 m0, m0, 4096
    s_nop 0
    buffer_load_dwordx4 v24, s[12:15], s67 offen lds
    s_add_u32 m0, m0, 1024
    s_add_u32 s65, s65, 1
    s_cmp_eq_u32 s65, 5
    s_cselect_b32 s65, 0, s65
    v_bfe_u32 v8, v1, 2, 2
    v_bfe_u32 v9, v1, 4, 1
    v_mul_u32_u24 v9, 20, v9
    v_add_u32 v8, v8, v9
    v_lshrrev_b32 v9, 5, v1
    v_mul_u32_u24 v10, 40, v9
    v_add3_u32 v10, v10, v8, 16
    v_lshl_add_u32 v8, v9, 2, v8
    v_and_b32 v9, 3, v1
    v_mul_u32_u24 v9, 40, v9
    v_add_u32 v9, 53248, v9
    v_mul_u32_u24 v8, 160, v8
    v_add_u32 v247, v8, v9
    v_mul_u32_u24 v10, 160, v10
    v_add_u32 v248, v10, v9
    v_lshlrev_b32 v246, 3, v1
    s_waitcnt vmcnt(10)
    ds_read_b128 v[36:39], v26 offset:0
    ds_read_b128 v[40:43], v27 offset:0
    ds_read_b128 v[44:47], v26 offset:2048
    ds_read_b128 v[48:51], v27 offset:2048
    ds_read_b128 v[52:55], v26 offset:4096
    ds_read_b128 v[56:59], v27 offset:4096
    s_waitcnt lgkmcnt(0)
    s_mul_i32 s6, s6, 1664525
    s_add_u32 s6, s6, 1013904223
    s_add_u32 m0, s61, 0
    s_nop 0
    buffer_load_dwordx4 v17, s[8:11], s66 offen offset:0 lds
    s_add_u32 m0, m0, 1024
    s_nop 0
    buffer_load_dwordx4 v18, s[8:11], s66 offen offset:0 lds
    s_add_u32 s66, s66, 128
    s_cmp_eq_u32 s66, s60
    s_cselect_b32 s66, s50, s66
    s_add_u32 m0, s61, 2048
    s_nop 0
    buffer_load_dwordx4 v17, s[8:11], s66 offen offset:0 lds
    s_add_u32 m0, m0, 1024
    s_nop 0
    buffer_load_dwordx4 v18, s[8:11], s66 offen offset:0 lds
    s_add_u32 s66, s66, 128
    s_cmp_eq_u32 s66, s60
    s_cselect_b32 s66, s50, s66
    s_add_u32 m0, s61, 4096
    s_nop 0
    buffer_load_dwordx4 v17, s[8:11], s66 offen offset:0 lds
    s_add_u32 m0, m0, 1024
    s_nop 0
    buffer_load_dwordx4 v18, s[8:11], s66 offen offset:0 lds
    s_add_u32 s66, s66, 128
    s_cmp_eq_u32 s66, s60
    s_cselect_b32 s66, s50, s66
    s_waitcnt vmcnt(11)
    ds_add_u32 v7, v14 offset:4
    s_mov_b32 s64, 800000
ls_22:
    ds_read_b32 v8, v13 offset:4
    s_sub_u32 s64, s64, 1
    s_cbranch_scc1 lsd_23
    s_waitcnt lgkmcnt(0)
    v_cmp_gt_u32 vcc, 4, v8
    s_cbranch_vccnz ls_22
lsd_23:
    ds_read_b64_tr_b16 v[136:137], v32 offset:0
    ds_read_b64_tr_b16 v[138:139], v33 offset:0
    ds_read_b64_tr_b16 v[140:141], v32 offset:8
    ds_read_b64_tr_b16 v[142:143], v33 offset:8
    ds_read_b64_tr_b16 v[144:145], v32 offset:80
    ds_read_b64_tr_b16 v[146:147], v33 offset:80
    ds_read_b64_tr_b16 v[148:149], v32 offset:88
    ds_read_b64_tr_b16 v[150:151], v33 offset:88
    ds_read_b64_tr_b16 v[152:153], v34 offset:0
    ds_read_b64_tr_b16 v[154:155], v35 offset:0
    ds_read_b64_tr_b16 v[156:157], v32 offset:5120
    ds_read_b64_tr_b16 v[158:159], v33 offset:5120
    ds_read_b64_tr_b16 v[160:161], v32 offset:5128
    ds_read_b64_tr_b16 v[162:163], v33 offset:5128
    ds_read_b64_tr_b16 v[164:165], v32 offset:5200
    ds_read_b64_tr_b16 v[166:167], v33 offset:5200
    ds_read_b64_tr_b16 v[168:169], v32 offset:5208
    ds_read_b64_tr_b16 v[170:171], v33 offset:5208
    ds_read_b64_tr_b16 v[172:173], v34 offset:5120
    ds_read_b64_tr_b16 v[174:175], v35 offset:5120
    s_waitcnt lgkmcnt(10)
    v_mfma_f32_16x16x32_bf16 v[116:119], v[136:139], v[36:39], 0
    ds_read_b64_tr_b16 v[176:177], v32 offset:10240
    ds_read_b64_tr_b16 v[178:179], v33 offset:10240
    s_lshl_b32 s67, s65, 2
    s_add_u32 s67, s67, s3
    s_mul_i32 s67, s67, 40960
    s_add_u32 s67, s67, s68
    s_add_u32 m0, s51, 5120
    s_nop 0
    buffer_load_dwordx4 v20, s[12:15], s67 offen offset:0 lds
    v_mfma_f32_16x16x32_bf16 v[120:123], v[140:143], v[36:39], 0
    ds_read_b64_tr_b16 v[180:181], v32 offset:10248
    ds_read_b64_tr_b16 v[182:183], v33 offset:10248
    v_mfma_f32_16x16x32_bf16 v[124:127], v[144:147], v[36:39], 0
    ds_read_b64_tr_b16 v[184:185], v32 offset:10320
    ds_read_b64_tr_b16 v[186:187], v33 offset:10320
    buffer_load_dwordx4 v21, s[12:15], s67 offen offset:1024 lds
    v_mfma_f32_16x16x32_bf16 v[128:131], v[148:151], v[36:39], 0
    ds_read_b64_tr_b16 v[188:189], v32 offset:10328
    ds_read_b64_tr_b16 v[190:191], v33 offset:10328
    v_mfma_f32_16x16x32_bf16 v[132:135], v[152:155], v[36:39], 0
    ds_read_b64_tr_b16 v[192:193], v34 offset:10240
    ds_read_b64_tr_b16 v[194:195], v35 offset:10240
    buffer_load_dwordx4 v22, s[12:15], s67 offen offset:2048 lds
    s_waitcnt vmcnt(3)
    ds_read_b128 v[60:63], v26 offset:0
    ds_read_b128 v[64:67], v27 offset:0
    ds_read_b128 v[68:71], v26 offset:2048
    ds_read_b128 v[72:75], v27 offset:2048
    ds_read_b128 v[76:79], v26 offset:4096
    ds_read_b128 v[80:83], v27 offset:4096
    ds_add_u32 v7, v14 offset:8
    s_waitcnt lgkmcnt(15)
    v_mfma_f32_16x16x32_bf16 v[116:119], v[156:159], v[40:43], v[116:119]
    ds_read_b64_tr_b16 v[136:137], v32 offset:15360
    ds_read_b64_tr_b16 v[138:139], v33 offset:15360
    v_mfma_f32_16x16x32_bf16 v[120:123], v[160:163], v[40:43], v[120:123]
    ds_read_b64_tr_b16 v[140:141], v32 offset:15368
    ds_read_b64_tr_b16 v[142:143], v33 offset:15368
    buffer_load_dwordx4 v23, s[12:15], s67 offen offset:3072 lds
    v_mfma_f32_16x16x32_bf16 v[124:127], v[164:167], v[40:43], v[124:127]
    ds_read_b64_tr_b16 v[144:145], v32 offset:15440
    ds_read_b64_tr_b16 v[146:147], v33 offset:15440
    v_mfma_f32_16x16x32_bf16 v[128:131], v[168:171], v[40:43], v[128:131]
    ds_read_b64_tr_b16 v[148:149], v32 offset:15448
    ds_read_b64_tr_b16 v[150:151], v33 offset:15448
    s_add_u32 m0, m0, 4096
    s_nop 0
    buffer_load_dwordx4 v24, s[12:15], s67 offen lds
    s_add_u32 m0, m0, 1024
    s_add_u32 s65, s65, 1
    s_cmp_eq_u32 s65, 5
    s_cselect_b32 s65, 0, s65
    v_mfma_f32_16x16x32_bf16 v[132:135], v[172:175], v[40:43], v[132:135]
    ds_read_b64_tr_b16 v[152:153], v34 offset:15360
    ds_read_b64_tr_b16 v[154:155], v35 offset:15360
    ds_read_b32 v8, v13 offset:8
    s_waitcnt lgkmcnt(15)
    v_mfma_f32_16x16x32_bf16 v[116:119], v[176:179], v[44:47], v[116:119]
    s_waitcnt lgkmcnt(12)
    s_add_u32 m0, s61, 0
    s_nop 0
    buffer_load_dwordx4 v17, s[8:11], s66 offen offset:0 lds
    v_mfma_f32_16x16x32_bf16 v[120:123], v[180:183], v[44:47], v[120:123]
    v_mfma_f32_16x16x32_bf16 v[124:127], v[184:187], v[44:47], v[124:127]
    s_waitcnt lgkmcnt(0)
    v_cmp_gt_u32 vcc, 4, v8
    s_cbranch_vccnz spin_24
back_25:
    ds_read_b64_tr_b16 v[156:157], v32 offset:21504
    ds_read_b64_tr_b16 v[158:159], v33 offset:21504
    ds_read_b64_tr_b16 v[160:161], v32 offset:21512
    ds_read_b64_tr_b16 v[162:163], v33 offset:21512
    s_add_u32 m0, m0, 1024
    s_nop 0
    buffer_load_dwordx4 v18, s[8:11], s66 offen offset:0 lds
    v_mfma_f32_16x16x32_bf16 v[128:131], v[188:191], v[44:47], v[128:131]
    ds_read_b64_tr_b16 v[164:165], v32 offset:21584
    ds_read_b64_tr_b16 v[166:167], v33 offset:21584
    ds_read_b64_tr_b16 v[168:169], v32 offset:21592
    v_mfma_f32_16x16x32_bf16 v[132:135], v[192:195], v[44:47], v[132:135]
    ds_read_b64_tr_b16 v[170:171], v33 offset:21592
    ds_read_b64_tr_b16 v[172:173], v34 offset:21504
    ds_read_b64_tr_b16 v[174:175], v35 offset:21504
    s_add_u32 s66, s66, 128
    s_cmp_eq_u32 s66, s60
    s_cselect_b32 s66, s50, s66
    s_add_u32 m0, s61, 2048
    s_nop 0
    buffer_load_dwordx4 v17, s[8:11], s66 offen offset:0 lds
    v_mfma_f32_16x16x32_bf16 v[116:119], v[136:139], v[48:51], v[116:119]
    ds_read_b64_tr_b16 v[176:177], v32 offset:41984
    ds_read_b64_tr_b16 v[178:179], v33 offset:41984
    v_mfma_f32_16x16x32_bf16 v[120:123], v[140:143], v[48:51], v[120:123]
    ds_read_b64_tr_b16 v[180:181], v32 offset:41992
    ds_read_b64_tr_b16 v[182:183], v33 offset:41992
    s_add_u32 m0, m0, 1024
    s_nop 0
    buffer_load_dwordx4 v18, s[8:11], s66 offen offset:0 lds
    v_mfma_f32_16x16x32_bf16 v[124:127], v[144:147], v[48:51], v[124:127]
    ds_read_b64_tr_b16 v[184:185], v32 offset:42064
    ds_read_b64_tr_b16 v[186:187], v33 offset:42064
    v_mfma_f32_16x16x32_bf16 v[128:131], v[148:151], v[48:51], v[128:131]
    ds_read_b64_tr_b16 v[188:189], v32 offset:42072
    ds_read_b64_tr_b16 v[190:191], v33 offset:42072
    s_add_u32 s66, s66, 128
    s_cmp_eq_u32 s66, s60
    s_cselect_b32 s66, s50, s66
    s_add_u32 m0, s61, 4096
    s_nop 0
    buffer_load_dwordx4 v17, s[8:11], s66 offen offset:0 lds
    v_mfma_f32_16x16x32_bf16 v[132:135], v[152:155], v[48:51], v[132:135]
    ds_read_b64_tr_b16 v[192:193], v34 offset:41984
    ds_read_b64_tr_b16 v[194:195], v35 offset:41984
    s_waitcnt lgkmcnt(10)
    v_mfma_f32_16x16x32_bf16 v[116:119], v[156:159], v[52:55], v[116:119]
    ds_read_b64_tr_b16 v[136:137], v28 offset:11264
    ds_read_b64_tr_b16 v[138:139], v29 offset:11264
    s_add_u32 m0, m0, 1024
    s_nop 0
    buffer_load_dwordx4 v18, s[8:11], s66 offen offset:0 lds
    s_add_u32 s66, s66, 128
    s_cmp_eq_u32 s66, s60
    s_cselect_b32 s66, s50, s66
    v_mfma_f32_16x16x32_bf16 v[120:123], v[160:163], v[52:55], v[120:123]
    ds_read_b64_tr_b16 v[140:141], v28 offset:11272
    ds_read_b64_tr_b16 v[142:143], v29 offset:11272
    v_mfma_f32_16x16x32_bf16 v[124:127], v[164:167], v[52:55], v[124:127]
    ds_read_b64_tr_b16 v[144:145], v28 offset:11344
    ds_read_b64_tr_b16 v[146:147], v29 offset:11344
    s_lshl_b32 s67, s65, 2
    s_add_u32 s67, s67, s3
    s_mul_i32 s67, s67, 40960
    s_add_u32 s67, s67, s68
    s_add_u32 m0, s51, 10240
    s_nop 0
    buffer_load_dwordx4 v20, s[12:15], s67 offen offset:0 lds
    v_mfma_f32_16x16x32_bf16 v[128:131], v[168:171], v[52:55], v[128:131]
    ds_read_b64_tr_b16 v[148:149], v28 offset:11352
    ds_read_b64_tr_b16 v[150:151], v29 offset:11352
    v_mfma_f32_16x16x32_bf16 v[132:135], v[172:175], v[52:55], v[132:135]
    ds_read_b64_tr_b16 v[152:153], v30 offset:11264
    ds_read_b64_tr_b16 v[154:155], v31 offset:11264
    buffer_load_dwordx4 v21, s[12:15], s67 offen offset:1024 lds
    s_waitcnt vmcnt(8)
    ds_add_u32 v7, v14 offset:20
    s_waitcnt lgkmcnt(11)
    v_mfma_f32_16x16x32_bf16 v[116:119], v[176:179], v[56:59], v[116:119]
    ds_read_b64_tr_b16 v[156:157], v28 offset:31744
    ds_read_b64_tr_b16 v[158:159], v29 offset:31744
    v_mfma_f32_16x16x32_bf16 v[120:123], v[180:183], v[56:59], v[120:123]
    ds_read_b64_tr_b16 v[160:161], v28 offset:31752
    ds_read_b64_tr_b16 v[162:163], v29 offset:31752
    buffer_load_dwordx4 v22, s[12:15], s67 offen offset:2048 lds
    v_mfma_f32_16x16x32_bf16 v[124:127], v[184:187], v[56:59], v[124:127]
    ds_read_b64_tr_b16 v[164:165], v28 offset:31824
    ds_read_b64_tr_b16 v[166:167], v29 offset:31824
    v_mfma_f32_16x16x32_bf16 v[128:131], v[188:191], v[56:59], v[128:131]
    ds_read_b64_tr_b16 v[168:169], v28 offset:31832
    ds_read_b64_tr_b16 v[170:171], v29 offset:31832
    buffer_load_dwordx4 v23, s[12:15], s67 offen offset:3072 lds
    v_mfma_f32_16x16x32_bf16 v[132:135], v[192:195], v[56:59], v[132:135]
    ds_read_b64_tr_b16 v[172:173], v30 offset:31744
    ds_read_b64_tr_b16 v[174:175], v31 offset:31744
    ds_read_b32 v8, v13 offset:20
    s_waitcnt vmcnt(4)
    ds_read_b128 v[84:87], v26 offset:0
    ds_read_b128 v[88:91], v27 offset:0
    ds_read_b128 v[92:95], v26 offset:2048
    ds_read_b128 v[96:99], v27 offset:2048
    ds_read_b128 v[100:103], v26 offset:4096
    ds_read_b128 v[104:107], v27 offset:4096
    s_waitcnt lgkmcnt(15)
    v_mfma_f32_16x16x32_bf16 v[116:119], v[136:139], v[60:63], v[116:119]
    s_add_u32 m0, m0, 4096
    s_nop 0
    buffer_load_dwordx4 v24, s[12:15], s67 offen lds
    s_add_u32 m0, m0, 1024
    s_add_u32 s65, s65, 1
    s_cmp_eq_u32 s65, 5
    s_cselect_b32 s65, 0, s65
    v_mfma_f32_16x16x32_bf16 v[120:123], v[140:143], v[60:63], v[120:123]
    v_mfma_f32_16x16x32_bf16 v[124:127], v[144:147], v[60:63], v[124:127]
    s_waitcnt lgkmcnt(6)
    v_cmp_gt_u32 vcc, 4, v8
    s_cbranch_vccnz spin_26
back_27:
    ds_read_b64_tr_b16 v[176:177], v32 offset:26624
    ds_read_b64_tr_b16 v[178:179], v33 offset:26624
    ds_read_b64_tr_b16 v[180:181], v32 offset:26632
    ds_read_b64_tr_b16 v[182:183], v33 offset:26632
    v_mfma_f32_16x16x32_bf16 v[128:131], v[148:151], v[60:63], v[128:131]
    ds_read_b64_tr_b16 v[184:185], v32 offset:26704
    ds_read_b64_tr_b16 v[186:187], v33 offset:26704
    ds_read_b64_tr_b16 v[188:189], v32 offset:26712
    s_waitcnt lgkmcnt(11)
    s_add_u32 m0, s61, 0
    s_nop 0
    buffer_load_dwordx4 v17, s[8:11], s66 offen offset:0 lds
    v_mfma_f32_16x16x32_bf16 v[132:135], v[152:155], v[60:63], v[132:135]
    ds_read_b64_tr_b16 v[190:191], v33 offset:26712
    ds_read_b64_tr_b16 v[192:193], v34 offset:26624
    ds_read_b64_tr_b16 v[194:195], v35 offset:26624
    v_mfma_f32_16x16x32_bf16 v[116:119], v[156:159], v[64:67], v[116:119]
    ds_read_b64_tr_b16 v[136:137], v32 offset:47104
    ds_read_b64_tr_b16 v[138:139], v33 offset:47104
    s_add_u32 m0, m0, 1024
    s_nop 0
    buffer_load_dwordx4 v18, s[8:11], s66 offen offset:0 lds
    s_add_u32 s66, s66, 128
    s_cmp_eq_u32 s66, s60
    s_cselect_b32 s66, s50, s66
    v_mfma_f32_16x16x32_bf16 v[120:123], v[160:163], v[64:67], v[120:123]
    ds_read_b64_tr_b16 v[140:141], v32 offset:47112
    ds_read_b64_tr_b16 v[142:143], v33 offset:47112
    v_mfma_f32_16x16x32_bf16 v[124:127], v[164:167], v[64:67], v[124:127]
    ds_read_b64_tr_b16 v[144:145], v32 offset:47184
    ds_read_b64_tr_b16 v[146:147], v33 offset:47184
    s_lshl_b32 s67, s65, 2
    s_add_u32 s67, s67, s3
    s_mul_i32 s67, s67, 40960
    s_add_u32 s67, s67, s68
    s_add_u32 m0, s51, 15360
    s_nop 0
    buffer_load_dwordx4 v20, s[12:15], s67 offen offset:0 lds
    v_mfma_f32_16x16x32_bf16 v[128:131], v[168:171], v[64:67], v[128:131]
    ds_read_b64_tr_b16 v[148:149], v32 offset:47192
    ds_read_b64_tr_b16 v[150:151], v33 offset:47192
    v_mfma_f32_16x16x32_bf16 v[132:135], v[172:175], v[64:67], v[132:135]
    ds_read_b64_tr_b16 v[152:153], v34 offset:47104
    ds_read_b64_tr_b16 v[154:155], v35 offset:47104
    buffer_load_dwordx4 v21, s[12:15], s67 offen offset:1024 lds
    s_waitcnt lgkmcnt(10)
    v_mfma_f32_16x16x32_bf16 v[116:119], v[176:179], v[68:71], v[116:119]
    ds_read_b64_tr_b16 v[156:157], v28 offset:16384
    ds_read_b64_tr_b16 v[158:159], v29 offset:16384
    v_mfma_f32_16x16x32_bf16 v[120:123], v[180:183], v[68:71], v[120:123]
    ds_read_b64_tr_b16 v[160:161], v28 offset:16392
    ds_read_b64_tr_b16 v[162:163], v29 offset:16392
    buffer_load_dwordx4 v22, s[12:15], s67 offen offset:2048 lds
    v_mfma_f32_16x16x32_bf16 v[124:127], v[184:187], v[68:71], v[124:127]
    ds_read_b64_tr_b16 v[164:165], v28 offset:16464
    ds_read_b64_tr_b16 v[166:167], v29 offset:16464
    v_mfma_f32_16x16x32_bf16 v[128:131], v[188:191], v[68:71], v[128:131]
    ds_read_b64_tr_b16 v[168:169], v28 offset:16472
    ds_read_b64_tr_b16 v[170:171], v29 offset:16472
    buffer_load_dwordx4 v23, s[12:15], s67 offen offset:3072 lds
    v_mfma_f32_16x16x32_bf16 v[132:135], v[192:195], v[68:71], v[132:135]
    ds_read_b64_tr_b16 v[172:173], v30 offset:16384
    ds_read_b64_tr_b16 v[174:175], v31 offset:16384
    s_waitcnt vmcnt(6)
    ds_add_u32 v7, v14 offset:24
    s_waitcnt lgkmcnt(11)
    v_mfma_f32_16x16x32_bf16 v[116:119], v[136:139], v[72:75], v[116:119]
    ds_read_b64_tr_b16 v[176:177], v28 offset:36864
    ds_read_b64_tr_b16 v[178:179], v29 offset:36864
    s_add_u32 m0, m0, 4096
    s_nop 0
    buffer_load_dwordx4 v24, s[12:15], s67 offen lds
    s_add_u32 m0, m0, 1024
    s_add_u32 s65, s65, 1
    s_cmp_eq_u32 s65, 5
    s_cselect_b32 s65, 0, s65
    v_mfma_f32_16x16x32_bf16 v[120:123], v[140:143], v[72:75], v[120:123]
    ds_read_b64_tr_b16 v[180:181], v28 offset:36872
    ds_read_b64_tr_b16 v[182:183], v29 offset:36872
    v_mfma_f32_16x16x32_bf16 v[124:127], v[144:147], v[72:75], v[124:127]
    ds_read_b64_tr_b16 v[184:185], v28 offset:36944
    ds_read_b64_tr_b16 v[186:187], v29 offset:36944
    buffer_load_dword v16, v15, s[52:55], 0 offen sc1
    v_mfma_f32_16x16x32_bf16 v[128:131], v[148:151], v[72:75], v[128:131]
    ds_read_b64_tr_b16 v[188:189], v28 offset:36952
    ds_read_b64_tr_b16 v[190:191], v29 offset:36952
    v_mfma_f32_16x16x32_bf16 v[132:135], v[152:155], v[72:75], v[132:135]
    ds_read_b64_tr_b16 v[192:193], v30 offset:36864
    ds_read_b64_tr_b16 v[194:195], v31 offset:36864
    ds_read_b32 v8, v13 offset:24
    s_waitcnt lgkmcnt(12)
    v_mfma_f32_16x16x32_bf16 v[116:119], v[156:159], v[76:79], v[116:119]
    v_mfma_f32_16x16x32_bf16 v[120:123], v[160:163], v[76:79], v[120:123]
    v_mfma_f32_16x16x32_bf16 v[124:127], v[164:167], v[76:79], v[124:127]
    s_waitcnt lgkmcnt(0)
    v_cmp_gt_u32 vcc, 4, v8
    s_cbranch_vccnz spin_28
back_29:
    ds_read_b64_tr_b16 v[136:137], v32 offset:31744
    ds_read_b64_tr_b16 v[138:139], v33 offset:31744
    ds_read_b64_tr_b16 v[140:141], v32 offset:31752
    ds_read_b64_tr_b16 v[142:143], v33 offset:31752
    v_mfma_f32_16x16x32_bf16 v[128:131], v[168:171], v[76:79], v[128:131]
    ds_read_b64_tr_b16 v[144:145], v32 offset:31824
    ds_read_b64_tr_b16 v[146:147], v33 offset:31824
    ds_read_b64_tr_b16 v[148:149], v32 offset:31832
    v_mfma_f32_16x16x32_bf16 v[132:135], v[172:175], v[76:79], v[132:135]
    ds_read_b64_tr_b16 v[150:151], v33 offset:31832
    ds_read_b64_tr_b16 v[152:153], v34 offset:31744
    ds_read_b64_tr_b16 v[154:155], v35 offset:31744
    v_mfma_f32_16x16x32_bf16 v[116:119], v[176:179], v[80:83], v[116:119]
    ds_read_b64_tr_b16 v[156:157], v28 offset:1024
    ds_read_b64_tr_b16 v[158:159], v29 offset:1024
    v_mfma_f32_16x16x32_bf16 v[120:123], v[180:183], v[80:83], v[120:123]
    ds_read_b64_tr_b16 v[160:161], v28 offset:1032
    ds_read_b64_tr_b16 v[162:163], v29 offset:1032
    v_mfma_f32_16x16x32_bf16 v[124:127], v[184:187], v[80:83], v[124:127]
    ds_read_b64_tr_b16 v[164:165], v28 offset:1104
    ds_read_b64_tr_b16 v[166:167], v29 offset:1104
    v_mfma_f32_16x16x32_bf16 v[128:131], v[188:191], v[80:83], v[128:131]
    ds_read_b64_tr_b16 v[168:169], v28 offset:1112
    ds_read_b64_tr_b16 v[170:171], v29 offset:1112
    v_mfma_f32_16x16x32_bf16 v[132:135], v[192:195], v[80:83], v[132:135]
    ds_read_b64_tr_b16 v[172:173], v30 offset:1024
    ds_read_b64_tr_b16 v[174:175], v31 offset:1024
    s_waitcnt vmcnt(0)
    v_cmp_ne_u32 vcc, s6, v16
    s_mov_b64 s[56:57], s[52:53]
    s_mov_b32 s59, s55
    s_cmp_eq_u64 vcc, 0
    s_cselect_b32 s58, s54, 0
    s_cselect_b32 s63, 1, 0
    s_waitcnt lgkmcnt(10)
    v_mfma_f32_16x16x32_bf16 v[116:119], v[136:139], v[84:87], v[116:119]
    ds_read_b64_tr_b16 v[176:177], v28 offset:21504
    ds_read_b64_tr_b16 v[178:179], v29 offset:21504
    v_mfma_f32_16x16x32_bf16 v[120:123], v[140:143], v[84:87], v[120:123]
    ds_read_b64_tr_b16 v[180:181], v28 offset:21512
    ds_read_b64_tr_b16 v[182:183], v29 offset:21512
    v_mfma_f32_16x16x32_bf16 v[124:127], v[144:147], v[84:87], v[124:127]
    ds_read_b64_tr_b16 v[184:185], v28 offset:21584
    ds_read_b64_tr_b16 v[186:187], v29 offset:21584
    v_mfma_f32_16x16x32_bf16 v[128:131], v[148:151], v[84:87], v[128:131]
    ds_read_b64_tr_b16 v[188:189], v28 offset:21592
    ds_read_b64_tr_b16 v[190:191], v29 offset:21592
    s_lshr_b32 s62, s4, 2
    s_mul_i32 s62, s62, 21504
    s_add_u32 s62, s62, 131072
    s_lshr_b32 s7, s3, 1
    s_mul_i32 s7, s7, 10496
    s_and_b32 s50, s3, 1
    s_mul_i32 s69, s50, 2048
    s_add_u32 s69, s69, s7
    s_add_u32 m0, s69, 0
    s_add_u32 s69, s69, s62
    buffer_load_dwordx4 v12, s[56:59], s69 offen offset:0 sc1 lds
    v_mfma_f32_16x16x32_bf16 v[132:135], v[152:155], v[84:87], v[132:135]
    ds_read_b64_tr_b16 v[192:193], v30 offset:21504
    ds_read_b64_tr_b16 v[194:195], v31 offset:21504
    ds_read_b128 v[108:111], v26 offset:0
    ds_read_b128 v[112:115], v27 offset:0
    ds_add_u32 v7, v14 offset:28
    s_waitcnt lgkmcnt(13)
    v_mfma_f32_16x16x32_bf16 v[116:119], v[156:159], v[88:91], v[116:119]
    ds_read_b64_tr_b16 v[136:137], v28 offset:41984
    ds_read_b64_tr_b16 v[138:139], v29 offset:41984
    buffer_load_dwordx4 v12, s[56:59], s69 offen offset:1024 sc1 lds
    v_mfma_f32_16x16x32_bf16 v[120:123], v[160:163], v[88:91], v[120:123]
    ds_read_b64_tr_b16 v[140:141], v28 offset:41992
    ds_read_b64_tr_b16 v[142:143], v29 offset:41992
    v_mfma_f32_16x16x32_bf16 v[124:127], v[164:167], v[88:91], v[124:127]
    ds_read_b64_tr_b16 v[144:145], v28 offset:42064
    ds_read_b64_tr_b16 v[146:147], v29 offset:42064
    s_mul_i32 s69, s50, 512
    s_add_u32 s69, s69, s7
    s_add_u32 m0, s69, 4096
    s_add_u32 s69, s69, s62
    s_add_u32 s69, s69, 4096
    s_mov_b32 exec_hi, 0
    buffer_load_dwordx4 v12, s[56:59], s69 offen offset:0 sc1 lds
    s_mov_b32 exec_hi, -1
    v_mfma_f32_16x16x32_bf16 v[128:131], v[168:171], v[88:91], v[128:131]
    ds_read_b64_tr_b16 v[148:149], v28 offset:42072
    ds_read_b64_tr_b16 v[150:151], v29 offset:42072
    v_mfma_f32_16x16x32_bf16 v[132:135], v[172:175], v[88:91], v[132:135]
    ds_read_b64_tr_b16 v[152:153], v30 offset:41984
    ds_read_b64_tr_b16 v[154:155], v31 offset:41984
    s_mul_i32 s69, s50, 2688
    s_add_u32 s69, s69, s7
    s_add_u32 m0, s69, 5120
    s_add_u32 s69, s69, s62
    s_add_u32 s69, s69, 5120
    buffer_load_dwordx4 v12, s[56:59], s69 offen offset:0 sc1 lds
    ds_read_b32 v8, v13 offset:28
    s_waitcnt lgkmcnt(14)
    v_mfma_f32_16x16x32_bf16 v[116:119], v[176:179], v[92:95], v[116:119]
    v_mfma_f32_16x16x32_bf16 v[120:123], v[180:183], v[92:95], v[120:123]
    buffer_load_dwordx4 v12, s[56:59], s69 offen offset:1024 sc1 lds
    v_mfma_f32_16x16x32_bf16 v[124:127], v[184:187], v[92:95], v[124:127]
    s_waitcnt lgkmcnt(0)
    v_cmp_gt_u32 vcc, 4, v8
    s_cbranch_vccnz spin_30
back_31:
    ds_read_b64_tr_b16 v[156:157], v32 offset:36864
    ds_read_b64_tr_b16 v[158:159], v33 offset:36864
    ds_read_b64_tr_b16 v[160:161], v32 offset:36872
    ds_read_b64_tr_b16 v[162:163], v33 offset:36872
    v_mfma_f32_16x16x32_bf16 v[128:131], v[188:191], v[92:95], v[128:131]
    ds_read_b64_tr_b16 v[164:165], v32 offset:36944
    ds_read_b64_tr_b16 v[166:167], v33 offset:36944
    ds_read_b64_tr_b16 v[168:169], v32 offset:36952
    s_mov_b32 exec_hi, 255
    buffer_load_dwordx4 v12, s[56:59], s69 offen offset:2048 sc1 lds
    s_mov_b32 exec_hi, -1
    v_mfma_f32_16x16x32_bf16 v[132:135], v[192:195], v[92:95], v[132:135]
    ds_read_b64_tr_b16 v[170:171], v33 offset:36952
    ds_read_b64_tr_b16 v[172:173], v34 offset:36864
    ds_read_b64_tr_b16 v[174:175], v35 offset:36864
    ds_add_u32 v7, v14 offset:52
    v_mfma_f32_16x16x32_bf16 v[116:119], v[136:139], v[96:99], v[116:119]
    ds_read_b64_tr_b16 v[176:177], v28 offset:6144
    ds_read_b64_tr_b16 v[178:179], v29 offset:6144
    v_mfma_f32_16x16x32_bf16 v[120:123], v[140:143], v[96:99], v[120:123]
    ds_read_b64_tr_b16 v[180:181], v28 offset:6152
    ds_read_b64_tr_b16 v[182:183], v29 offset:6152
    v_mfma_f32_16x16x32_bf16 v[124:127], v[144:147], v[96:99], v[124:127]
    ds_read_b64_tr_b16 v[184:185], v28 offset:6224
    ds_read_b64_tr_b16 v[186:187], v29 offset:6224
    v_mfma_f32_16x16x32_bf16 v[128:131], v[148:151], v[96:99], v[128:131]
    ds_read_b64_tr_b16 v[188:189], v28 offset:6232
    ds_read_b64_tr_b16 v[190:191], v29 offset:6232
    v_mfma_f32_16x16x32_bf16 v[132:135], v[152:155], v[96:99], v[132:135]
    ds_read_b64_tr_b16 v[192:193], v30 offset:6144
    ds_read_b64_tr_b16 v[194:195], v31 offset:6144
    s_waitcnt lgkmcnt(11)
    v_mfma_f32_16x16x32_bf16 v[116:119], v[156:159], v[100:103], v[116:119]
    ds_read_b64_tr_b16 v[136:137], v28 offset:26624
    ds_read_b64_tr_b16 v[138:139], v29 offset:26624
    v_mfma_f32_16x16x32_bf16 v[120:123], v[160:163], v[100:103], v[120:123]
    ds_read_b64_tr_b16 v[140:141], v28 offset:26632
    ds_read_b64_tr_b16 v[142:143], v29 offset:26632
    v_mfma_f32_16x16x32_bf16 v[124:127], v[164:167], v[100:103], v[124:127]
    ds_read_b64_tr_b16 v[144:145], v28 offset:26704
    ds_read_b64_tr_b16 v[146:147], v29 offset:26704
    v_mfma_f32_16x16x32_bf16 v[128:131], v[168:171], v[100:103], v[128:131]
    ds_read_b64_tr_b16 v[148:149], v28 offset:26712
    ds_read_b64_tr_b16 v[150:151], v29 offset:26712
    v_mfma_f32_16x16x32_bf16 v[132:135], v[172:175], v[100:103], v[132:135]
    ds_read_b64_tr_b16 v[152:153], v30 offset:26624
    ds_read_b64_tr_b16 v[154:155], v31 offset:26624
    s_waitcnt lgkmcnt(10)
    v_mfma_f32_16x16x32_bf16 v[116:119], v[176:179], v[104:107], v[116:119]
    ds_read_b64_tr_b16 v[156:157], v28 offset:47104
    ds_read_b64_tr_b16 v[158:159], v29 offset:47104
    v_mfma_f32_16x16x32_bf16 v[120:123], v[180:183], v[104:107], v[120:123]
    ds_read_b64_tr_b16 v[160:161], v28 offset:47112
    ds_read_b64_tr_b16 v[162:163], v29 offset:47112
    v_mfma_f32_16x16x32_bf16 v[124:127], v[184:187], v[104:107], v[124:127]
    ds_read_b64_tr_b16 v[164:165], v28 offset:47184
    ds_read_b64_tr_b16 v[166:167], v29 offset:47184
    v_mfma_f32_16x16x32_bf16 v[128:131], v[188:191], v[104:107], v[128:131]
    ds_read_b64_tr_b16 v[168:169], v28 offset:47192
    ds_read_b64_tr_b16 v[170:171], v29 offset:47192
    v_mfma_f32_16x16x32_bf16 v[132:135], v[192:195], v[104:107], v[132:135]
    ds_read_b64_tr_b16 v[172:173], v30 offset:47104
    ds_read_b64_tr_b16 v[174:175], v31 offset:47104
    s_waitcnt lgkmcnt(10)
    v_mfma_f32_16x16x32_bf16 v[116:119], v[136:139], v[108:111], v[116:119]
    v_mfma_f32_16x16x32_bf16 v[120:123], v[140:143], v[108:111], v[120:123]
    v_mfma_f32_16x16x32_bf16 v[124:127], v[144:147], v[108:111], v[124:127]
    v_mfma_f32_16x16x32_bf16 v[128:131], v[148:151], v[108:111], v[128:131]
    v_mfma_f32_16x16x32_bf16 v[132:135], v[152:155], v[108:111], v[132:135]
    s_waitcnt lgkmcnt(0)
    s_waitcnt vmcnt(0)
    s_cmp_eq_u32 s63, 0
    s_cbranch_scc1 z_32
    ds_add_u32 v7, v14 offset:16
z_32:
    v_mfma_f32_16x16x32_bf16 v[116:119], v[156:159], v[112:115], v[116:119]
    v_mfma_f32_16x16x32_bf16 v[120:123], v[160:163], v[112:115], v[120:123]
    v_mfma_f32_16x16x32_bf16 v[124:127], v[164:167], v[112:115], v[124:127]
    v_mfma_f32_16x16x32_bf16 v[128:131], v[168:171], v[112:115], v[128:131]
    v_mfma_f32_16x16x32_bf16 v[132:135], v[172:175], v[112:115], v[132:135]
join_4:
    s_cmp_eq_u32 s63, 1
    s_cbranch_scc1 p4_33
    s_mov_b32 s64, 200000
poll_34:
    buffer_load_dword v16, v15, s[52:55], 0 offen sc1
    s_sub_u32 s64, s64, 1
    s_cbranch_scc1 pdone_35
    s_waitcnt vmcnt(0)
    v_cmp_ne_u32 vcc, s6, v16
    s_cbranch_vccnz poll_34
pdone_35:
    s_lshr_b32 s62, s4, 2
    s_mul_i32 s62, s62, 21504
    s_add_u32 s62, s62, 131072
    s_lshr_b32 s7, s3, 1
    s_mul_i32 s7, s7, 10496
    s_and_b32 s50, s3, 1
    s_mul_i32 s69, s50, 2048
    s_add_u32 s69, s69, s7
    s_add_u32 m0, s69, 0
    s_add_u32 s69, s69, s62
    buffer_load_dwordx4 v12, s[52:55], s69 offen offset:0 sc1 lds
    buffer_load_dwordx4 v12, s[52:55], s69 offen offset:1024 sc1 lds
    s_mul_i32 s69, s50, 512
    s_add_u32 s69, s69, s7
    s_add_u32 m0, s69, 4096
    s_add_u32 s69, s69, s62
    s_add_u32 s69, s69, 4096
    s_mov_b32 exec_hi, 0
    buffer_load_dwordx4 v12, s[52:55], s69 offen offset:0 sc1 lds
    s_mov_b32 exec_hi, -1
    s_mul_i32 s69, s50, 2688
    s_add_u32 s69, s69, s7
    s_add_u32 m0, s69, 5120
    s_add_u32 s69, s69, s62
    s_add_u32 s69, s69, 5120
    buffer_load_dwordx4 v12, s[52:55], s69 offen offset:0 sc1 lds
    buffer_load_dwordx4 v12, s[52:55], s69 offen offset:1024 sc1 lds
    s_mov_b32 exec_hi, 255
    buffer_load_dwordx4 v12, s[52:55], s69 offen offset:2048 sc1 lds
    s_mov_b32 exec_hi, -1
    s_waitcnt vmcnt(0)
    ds_add_u32 v7, v14 offset:16
p4_33:
    s_setprio 0
    s_mov_b32 s64, 800000
ls_36:
    ds_read_b32 v8, v13 offset:16
    s_sub_u32 s64, s64, 1
    s_cbranch_scc1 lsd_37
    s_waitcnt lgkmcnt(0)
    v_cmp_gt_u32 vcc, 8, v8
    s_cbranch_vccnz ls_36
lsd_37:
    s_setprio 2
    ds_read_b128 v[68:71], v242
    ds_read_b128 v[76:79], v242 offset:4096
    ds_read_b128 v[84:87], v243
    ds_read_b128 v[92:95], v243 offset:672
    v_cvt_pk_bf16_f32 v20, v116, v117
    v_cvt_pk_bf16_f32 v21, v118, v119
    v_cvt_pk_bf16_f32 v22, v120, v121
    v_cvt_pk_bf16_f32 v23, v122, v123
    v_cvt_pk_bf16_f32 v24, v124, v125
    v_cvt_pk_bf16_f32 v25, v126, v127
    v_cvt_pk_bf16_f32 v26, v128, v129
    v_cvt_pk_bf16_f32 v27, v130, v131
    v_cvt_pk_bf16_f32 v28, v132, v133
    v_cvt_pk_bf16_f32 v29, v134, v135
    s_lshl_b32 s7, s4, 7
    s_add_u32 s7, s7, 65536
    v_and_b32 v15, 7, v1
    v_lshlrev_b32 v15, 12, v15
    v_add_u32 v15, s7, v15
    s_waitcnt lgkmcnt(2)
    v_mfma_f32_32x32x4_2b_bf16 v[140:171], v[76:77], v[28:29], 0 cbsz:1 abid:0
    s_nop 15
    s_nop 1
    v_mfma_f32_32x32x16_bf16 v[140:155], v[68:71], v[20:23], v[140:155]
    s_mov_b32 s60, 0
    s_mov_b32 s61, 21504
    s_waitcnt lgkmcnt(0)
    s_nop 9
.p2align 6
L_loop:
    ds_read_b128 v[72:75], v242 offset:1024
    ds_read_b128 v[88:91], v243 offset:1344
    v_exp_f32 v140, v140
    v_smfmac_f32_32x32x32_bf16 v[220:235], v[236:239], v[196:203], v244
    v_exp_f32 v141, v141
    v_exp_f32 v142, v142
    v_exp_f32 v143, v143
    v_exp_f32 v144, v144
    v_mfma_f32_32x32x16_bf16 v[156:171], v[68:71], v[24:27], v[156:171]
    v_exp_f32 v145, v145
    v_exp_f32 v146, v146
    v_exp_f32 v147, v147
    v_mfma_f32_32x32x4_2b_bf16 v[172:203], v[78:79], v[28:29], 0 cbsz:1 abid:0
    v_exp_f32 v148, v148
    v_exp_f32 v149, v149
    v_exp_f32 v150, v150
    v_exp_f32 v151, v151
    s_waitcnt lgkmcnt(0)
    v_exp_f32 v152, v152
    v_exp_f32 v153, v153
    v_exp_f32 v154, v154
    v_exp_f32 v155, v155
    v_smfmac_f32_32x32x32_bf16 v[204:219], v[84:87], v[140:147], v244
    ds_read_b128 v[236:239], v243 offset:2016
    v_exp_f32 v156, v156
    v_exp_f32 v157, v157
    v_exp_f32 v158, v158
    v_exp_f32 v159, v159
    v_mfma_f32_32x32x16_bf16 v[172:187], v[72:75], v[20:23], v[172:187]
    v_exp_f32 v160, v160
    v_exp_f32 v161, v161
    v_exp_f32 v162, v162
    v_exp_f32 v163, v163
    v_smfmac_f32_32x32x32_bf16 v[204:219], v[92:95], v[148:155], v244
    v_exp_f32 v164, v164
    v_exp_f32 v165, v165
    v_exp_f32 v166, v166
    v_exp_f32 v167, v167
    v_exp_f32 v168, v168
    v_smfmac_f32_32x32x32_bf16 v[220:235], v[84:87], v[156:163], v244
    v_exp_f32 v169, v169
    v_exp_f32 v170, v170
    v_exp_f32 v171, v171
    ds_read_b128 v[68:71], v242 offset:2048
    ds_read_b128 v[84:87], v243 offset:2688
    v_exp_f32 v172, v172
    v_smfmac_f32_32x32x32_bf16 v[220:235], v[92:95], v[164:171], v244
    v_exp_f32 v173, v173
    v_exp_f32 v174, v174
    v_exp_f32 v175, v175
    v_exp_f32 v176, v176
    v_mfma_f32_32x32x16_bf16 v[188:203], v[72:75], v[24:27], v[188:203]
    v_exp_f32 v177, v177
    v_exp_f32 v178, v178
    v_exp_f32 v179, v179
    v_mfma_f32_32x32x4_2b_bf16 v[140:171], v[76:77], v[28:29], 0 cbsz:1 abid:1
    v_exp_f32 v180, v180
    v_exp_f32 v181, v181
    v_exp_f32 v182, v182
    v_exp_f32 v183, v183
    s_waitcnt lgkmcnt(0)
    v_exp_f32 v184, v184
    v_exp_f32 v185, v185
    v_exp_f32 v186, v186
    v_exp_f32 v187, v187
    v_smfmac_f32_32x32x32_bf16 v[204:219], v[88:91], v[172:179], v244
    ds_read_b128 v[92:95], v243 offset:3360
    v_exp_f32 v188, v188
    v_exp_f32 v189, v189
    v_exp_f32 v190, v190
    v_exp_f32 v191, v191
    v_mfma_f32_32x32x16_bf16 v[140:155], v[68:71], v[20:23], v[140:155]
    v_exp_f32 v192, v192
    v_exp_f32 v193, v193
    v_exp_f32 v194, v194
    v_exp_f32 v195, v195
    v_smfmac_f32_32x32x32_bf16 v[204:219], v[236:239], v[180:187], v244
    v_exp_f32 v196, v196
    v_exp_f32 v197, v197
    v_exp_f32 v198, v198
    v_exp_f32 v199, v199
    v_exp_f32 v200, v200
    v_smfmac_f32_32x32x32_bf16 v[220:235], v[88:91], v[188:195], v244
    v_exp_f32 v201, v201
    v_exp_f32 v202, v202
    v_exp_f32 v203, v203
    ds_read_b128 v[72:75], v242 offset:3072
    ds_read_b128 v[88:91], v243 offset:4032
    ds_read_b128 v[80:83], v242 offset:14592
    v_exp_f32 v140, v140
    v_smfmac_f32_32x32x32_bf16 v[220:235], v[236:239], v[196:203], v244
    v_exp_f32 v141, v141
    v_exp_f32 v142, v142
    v_exp_f32 v143, v143
    v_exp_f32 v144, v144
    v_mfma_f32_32x32x16_bf16 v[156:171], v[68:71], v[24:27], v[156:171]
    v_exp_f32 v145, v145
    v_exp_f32 v146, v146
    v_exp_f32 v147, v147
    v_mfma_f32_32x32x4_2b_bf16 v[172:203], v[78:79], v[28:29], 0 cbsz:1 abid:1
    v_exp_f32 v148, v148
    v_exp_f32 v149, v149
    v_exp_f32 v150, v150
    v_exp_f32 v151, v151
    s_waitcnt lgkmcnt(0)
    v_exp_f32 v152, v152
    v_exp_f32 v153, v153
    v_exp_f32 v154, v154
    v_exp_f32 v155, v155
    v_smfmac_f32_32x32x32_bf16 v[204:219], v[84:87], v[140:147], v244
    ds_read_b128 v[236:239], v243 offset:4704
    v_exp_f32 v156, v156
    v_exp_f32 v157, v157
    v_exp_f32 v158, v158
    v_exp_f32 v159, v159
    v_mfma_f32_32x32x16_bf16 v[172:187], v[72:75], v[20:23], v[172:187]
    v_exp_f32 v160, v160
    v_exp_f32 v161, v161
    v_exp_f32 v162, v162
    v_exp_f32 v163, v163
    v_smfmac_f32_32x32x32_bf16 v[204:219], v[92:95], v[148:155], v244
    v_exp_f32 v164, v164
    v_exp_f32 v165, v165
    v_exp_f32 v166, v166
    v_exp_f32 v167, v167
    v_exp_f32 v168, v168
    v_smfmac_f32_32x32x32_bf16 v[220:235], v[84:87], v[156:163], v244
    v_exp_f32 v169, v169
    v_exp_f32 v170, v170
    v_exp_f32 v171, v171
    ds_read_b128 v[68:71], v242 offset:10496
    ds_read_b128 v[84:87], v243 offset:10496
    v_exp_f32 v172, v172
    v_smfmac_f32_32x32x32_bf16 v[220:235], v[92:95], v[164:171], v244
    v_exp_f32 v173, v173
    v_exp_f32 v174, v174
    v_exp_f32 v175, v175
    v_exp_f32 v176, v176
    v_mfma_f32_32x32x16_bf16 v[188:203], v[72:75], v[24:27], v[188:203]
    v_exp_f32 v177, v177
    v_exp_f32 v178, v178
    v_exp_f32 v179, v179
    v_mfma_f32_32x32x4_2b_bf16 v[140:171], v[80:81], v[28:29], 0 cbsz:1 abid:0
    v_exp_f32 v180, v180
    v_exp_f32 v181, v181
    v_exp_f32 v182, v182
    v_exp_f32 v183, v183
    s_waitcnt lgkmcnt(0)
    v_exp_f32 v184, v184
    v_exp_f32 v185, v185
    v_exp_f32 v186, v186
    v_exp_f32 v187, v187
    v_smfmac_f32_32x32x32_bf16 v[204:219], v[88:91], v[172:179], v244
    ds_read_b128 v[92:95], v243 offset:11168
    v_exp_f32 v188, v188
    v_exp_f32 v189, v189
    v_exp_f32 v190, v190
    v_exp_f32 v191, v191
    v_mfma_f32_32x32x16_bf16 v[140:155], v[68:71], v[20:23], v[140:155]
    v_exp_f32 v192, v192
    v_exp_f32 v193, v193
    v_exp_f32 v194, v194
    v_exp_f32 v195, v195
    v_smfmac_f32_32x32x32_bf16 v[204:219], v[236:239], v[180:187], v244
    v_exp_f32 v196, v196
    v_exp_f32 v197, v197
    v_exp_f32 v198, v198
    v_exp_f32 v199, v199
    v_exp_f32 v200, v200
    v_smfmac_f32_32x32x32_bf16 v[220:235], v[88:91], v[188:195], v244
    v_exp_f32 v201, v201
    v_exp_f32 v202, v202
    v_exp_f32 v203, v203
    ds_read_b128 v[72:75], v242 offset:11520
    ds_read_b128 v[88:91], v243 offset:11840
    v_exp_f32 v140, v140
    v_smfmac_f32_32x32x32_bf16 v[220:235], v[236:239], v[196:203], v244
    v_exp_f32 v141, v141
    v_exp_f32 v142, v142
    v_exp_f32 v143, v143
    v_exp_f32 v144, v144
    v_mfma_f32_32x32x16_bf16 v[156:171], v[68:71], v[24:27], v[156:171]
    v_exp_f32 v145, v145
    v_exp_f32 v146, v146
    v_exp_f32 v147, v147
    v_mfma_f32_32x32x4_2b_bf16 v[172:203], v[82:83], v[28:29], 0 cbsz:1 abid:0
    v_exp_f32 v148, v148
    v_exp_f32 v149, v149
    v_exp_f32 v150, v150
    v_exp_f32 v151, v151
    s_waitcnt lgkmcnt(0)
    v_exp_f32 v152, v152
    v_exp_f32 v153, v153
    v_exp_f32 v154, v154
    v_exp_f32 v155, v155
    v_smfmac_f32_32x32x32_bf16 v[204:219], v[84:87], v[140:147], v244
    ds_read_b128 v[236:239], v243 offset:12512
    v_exp_f32 v156, v156
    v_exp_f32 v157, v157
    v_exp_f32 v158, v158
    v_exp_f32 v159, v159
    v_mfma_f32_32x32x16_bf16 v[172:187], v[72:75], v[20:23], v[172:187]
    v_exp_f32 v160, v160
    v_exp_f32 v161, v161
    v_exp_f32 v162, v162
    v_exp_f32 v163, v163
    v_smfmac_f32_32x32x32_bf16 v[204:219], v[92:95], v[148:155], v244
    v_exp_f32 v164, v164
    v_exp_f32 v165, v165
    v_exp_f32 v166, v166
    v_exp_f32 v167, v167
    v_exp_f32 v168, v168
    v_smfmac_f32_32x32x32_bf16 v[220:235], v[84:87], v[156:163], v244
    v_exp_f32 v169, v169
    v_exp_f32 v170, v170
    v_exp_f32 v171, v171
    ds_read_b128 v[68:71], v242 offset:12544
    ds_read_b128 v[84:87], v243 offset:13184
    v_exp_f32 v172, v172
    v_smfmac_f32_32x32x32_bf16 v[220:235], v[92:95], v[164:171], v244
    v_exp_f32 v173, v173
    v_exp_f32 v174, v174
    v_exp_f32 v175, v175
    v_exp_f32 v176, v176
    v_mfma_f32_32x32x16_bf16 v[188:203], v[72:75], v[24:27], v[188:203]
    v_exp_f32 v177, v177
    v_exp_f32 v178, v178
    v_exp_f32 v179, v179
    v_mfma_f32_32x32x4_2b_bf16 v[140:171], v[80:81], v[28:29], 0 cbsz:1 abid:1
    v_exp_f32 v180, v180
    v_exp_f32 v181, v181
    v_exp_f32 v182, v182
    v_exp_f32 v183, v183
    s_waitcnt lgkmcnt(0)
    v_exp_f32 v184, v184
    v_exp_f32 v185, v185
    v_exp_f32 v186, v186
    v_exp_f32 v187, v187
    v_smfmac_f32_32x32x32_bf16 v[204:219], v[88:91], v[172:179], v244
    ds_read_b128 v[92:95], v243 offset:13856
    v_exp_f32 v188, v188
    v_exp_f32 v189, v189
    v_exp_f32 v190, v190
    v_exp_f32 v191, v191
    v_mfma_f32_32x32x16_bf16 v[140:155], v[68:71], v[20:23], v[140:155]
    v_exp_f32 v192, v192
    v_exp_f32 v193, v193
    v_exp_f32 v194, v194
    v_exp_f32 v195, v195
    v_smfmac_f32_32x32x32_bf16 v[204:219], v[236:239], v[180:187], v244
    v_exp_f32 v196, v196
    v_exp_f32 v197, v197
    v_exp_f32 v198, v198
    v_exp_f32 v199, v199
    v_exp_f32 v200, v200
    v_smfmac_f32_32x32x32_bf16 v[220:235], v[88:91], v[188:195], v244
    v_exp_f32 v201, v201
    v_exp_f32 v202, v202
    v_exp_f32 v203, v203
    ds_read_b128 v[72:75], v242 offset:13568
    ds_read_b128 v[88:91], v243 offset:14528
    v_exp_f32 v140, v140
    v_smfmac_f32_32x32x32_bf16 v[220:235], v[236:239], v[196:203], v244
    v_exp_f32 v141, v141
    v_exp_f32 v142, v142
    v_exp_f32 v143, v143
    v_exp_f32 v144, v144
    v_mfma_f32_32x32x16_bf16 v[156:171], v[68:71], v[24:27], v[156:171]
    v_exp_f32 v145, v145
    v_exp_f32 v146, v146
    v_exp_f32 v147, v147
    v_mfma_f32_32x32x4_2b_bf16 v[172:203], v[82:83], v[28:29], 0 cbsz:1 abid:1
    v_exp_f32 v148, v148
    v_exp_f32 v149, v149
    v_exp_f32 v150, v150
    v_exp_f32 v151, v151
    s_waitcnt lgkmcnt(0)
    v_exp_f32 v152, v152
    v_exp_f32 v153, v153
    v_exp_f32 v154, v154
    v_exp_f32 v155, v155
    v_smfmac_f32_32x32x32_bf16 v[204:219], v[84:87], v[140:147], v244
    ds_read_b128 v[236:239], v243 offset:15200
    v_exp_f32 v156, v156
    v_exp_f32 v157, v157
    v_exp_f32 v158, v158
    v_exp_f32 v159, v159
    v_mfma_f32_32x32x16_bf16 v[172:187], v[72:75], v[20:23], v[172:187]
    v_exp_f32 v160, v160
    v_exp_f32 v161, v161
    v_exp_f32 v162, v162
    v_exp_f32 v163, v163
    v_smfmac_f32_32x32x32_bf16 v[204:219], v[92:95], v[148:155], v244
    v_exp_f32 v164, v164
    v_exp_f32 v165, v165
    v_exp_f32 v166, v166
    v_exp_f32 v167, v167
    s_waitcnt lgkmcnt(0)
    s_barrier
    v_exp_f32 v168, v168
    v_smfmac_f32_32x32x32_bf16 v[220:235], v[84:87], v[156:163], v244
    ds_read_b128 v[76:79], v242 offset:25600
    v_exp_f32 v169, v169
    v_exp_f32 v170, v170
    v_exp_f32 v171, v171
    ds_read_b128 v[68:71], v242 offset:21504
    ds_read_b128 v[84:87], v243 offset:21504
    v_exp_f32 v172, v172
    v_smfmac_f32_32x32x32_bf16 v[220:235], v[92:95], v[164:171], v244
    v_exp_f32 v173, v173
    v_exp_f32 v174, v174
    v_exp_f32 v175, v175
    v_exp_f32 v176, v176
    v_mfma_f32_32x32x16_bf16 v[188:203], v[72:75], v[24:27], v[188:203]
    v_exp_f32 v177, v177
    v_exp_f32 v178, v178
    v_exp_f32 v179, v179
    s_waitcnt lgkmcnt(2)
    v_mfma_f32_32x32x4_2b_bf16 v[140:171], v[76:77], v[28:29], 0 cbsz:1 abid:0
    v_exp_f32 v180, v180
    v_exp_f32 v181, v181
    v_exp_f32 v182, v182
    v_exp_f32 v183, v183
    s_waitcnt lgkmcnt(0)
    v_exp_f32 v184, v184
    v_exp_f32 v185, v185
    v_exp_f32 v186, v186
    v_exp_f32 v187, v187
    v_smfmac_f32_32x32x32_bf16 v[204:219], v[88:91], v[172:179], v244
    ds_read_b128 v[92:95], v243 offset:22176
    v_exp_f32 v188, v188
    v_exp_f32 v189, v189
    v_exp_f32 v190, v190
    v_exp_f32 v191, v191
    v_mfma_f32_32x32x16_bf16 v[140:155], v[68:71], v[20:23], v[140:155]
    v_exp_f32 v192, v192
    v_exp_f32 v193, v193
    v_exp_f32 v194, v194
    v_exp_f32 v195, v195
    v_smfmac_f32_32x32x32_bf16 v[204:219], v[236:239], v[180:187], v244
    v_exp_f32 v196, v196
    v_exp_f32 v197, v197
    v_exp_f32 v198, v198
    v_exp_f32 v199, v199
    v_exp_f32 v200, v200
    v_smfmac_f32_32x32x32_bf16 v[220:235], v[88:91], v[188:195], v244
    v_exp_f32 v201, v201
    v_exp_f32 v202, v202
    v_exp_f32 v203, v203
    ds_read_b128 v[72:75], v242 offset:22528
    ds_read_b128 v[88:91], v243 offset:22848
    v_exp_f32 v140, v140
    v_smfmac_f32_32x32x32_bf16 v[220:235], v[236:239], v[196:203], v244
    v_exp_f32 v141, v141
    v_exp_f32 v142, v142
    v_exp_f32 v143, v143
    v_exp_f32 v144, v144
    v_mfma_f32_32x32x16_bf16 v[156:171], v[68:71], v[24:27], v[156:171]
    v_exp_f32 v145, v145
    v_exp_f32 v146, v146
    v_exp_f32 v147, v147
    v_mfma_f32_32x32x4_2b_bf16 v[172:203], v[78:79], v[28:29], 0 cbsz:1 abid:0
    v_exp_f32 v148, v148
    v_exp_f32 v149, v149
    v_exp_f32 v150, v150
    v_exp_f32 v151, v151
    s_waitcnt lgkmcnt(0)
    v_exp_f32 v152, v152
    v_exp_f32 v153, v153
    v_exp_f32 v154, v154
    v_exp_f32 v155, v155
    v_smfmac_f32_32x32x32_bf16 v[204:219], v[84:87], v[140:147], v244
    ds_read_b128 v[236:239], v243 offset:23520
    v_exp_f32 v156, v156
    v_exp_f32 v157, v157
    v_exp_f32 v158, v158
    v_exp_f32 v159, v159
    v_mfma_f32_32x32x16_bf16 v[172:187], v[72:75], v[20:23], v[172:187]
    v_exp_f32 v160, v160
    v_exp_f32 v161, v161
    v_exp_f32 v162, v162
    v_exp_f32 v163, v163
    v_smfmac_f32_32x32x32_bf16 v[204:219], v[92:95], v[148:155], v244
    v_exp_f32 v164, v164
    v_exp_f32 v165, v165
    v_exp_f32 v166, v166
    v_exp_f32 v167, v167
    v_exp_f32 v168, v168
    v_smfmac_f32_32x32x32_bf16 v[220:235], v[84:87], v[156:163], v244
    v_exp_f32 v169, v169
    v_exp_f32 v170, v170
    v_exp_f32 v171, v171
    ds_read_b128 v[68:71], v242 offset:23552
    ds_read_b128 v[84:87], v243 offset:24192
    v_exp_f32 v172, v172
    v_smfmac_f32_32x32x32_bf16 v[220:235], v[92:95], v[164:171], v244
    v_exp_f32 v173, v173
    v_exp_f32 v174, v174
    v_exp_f32 v175, v175
    v_exp_f32 v176, v176
    v_mfma_f32_32x32x16_bf16 v[188:203], v[72:75], v[24:27], v[188:203]
    v_exp_f32 v177, v177
    v_exp_f32 v178, v178
    v_exp_f32 v179, v179
    v_mfma_f32_32x32x4_2b_bf16 v[140:171], v[76:77], v[28:29], 0 cbsz:1 abid:1
    v_exp_f32 v180, v180
    v_exp_f32 v181, v181
    v_exp_f32 v182, v182
    v_exp_f32 v183, v183
    s_waitcnt lgkmcnt(0)
    v_exp_f32 v184, v184
    v_exp_f32 v185, v185
    v_exp_f32 v186, v186
    v_exp_f32 v187, v187
    v_smfmac_f32_32x32x32_bf16 v[204:219], v[88:91], v[172:179], v244
    ds_read_b128 v[92:95], v243 offset:24864
    v_exp_f32 v188, v188
    v_exp_f32 v189, v189
    v_exp_f32 v190, v190
    v_exp_f32 v191, v191
    v_mfma_f32_32x32x16_bf16 v[140:155], v[68:71], v[20:23], v[140:155]
    v_exp_f32 v192, v192
    v_exp_f32 v193, v193
    v_exp_f32 v194, v194
    v_exp_f32 v195, v195
    v_smfmac_f32_32x32x32_bf16 v[204:219], v[236:239], v[180:187], v244
    v_exp_f32 v196, v196
    v_exp_f32 v197, v197
    v_exp_f32 v198, v198
    v_exp_f32 v199, v199
    v_exp_f32 v200, v200
    v_smfmac_f32_32x32x32_bf16 v[220:235], v[88:91], v[188:195], v244
    v_exp_f32 v201, v201
    v_exp_f32 v202, v202
    v_exp_f32 v203, v203
    ds_read_b128 v[72:75], v242 offset:24576
    ds_read_b128 v[88:91], v243 offset:25536
    ds_read_b128 v[80:83], v242 offset:36096
    v_exp_f32 v140, v140
    v_smfmac_f32_32x32x32_bf16 v[220:235], v[236:239], v[196:203], v244
    v_exp_f32 v141, v141
    v_exp_f32 v142, v142
    v_exp_f32 v143, v143
    v_exp_f32 v144, v144
    v_mfma_f32_32x32x16_bf16 v[156:171], v[68:71], v[24:27], v[156:171]
    v_exp_f32 v145, v145
    v_exp_f32 v146, v146
    v_exp_f32 v147, v147
    v_mfma_f32_32x32x4_2b_bf16 v[172:203], v[78:79], v[28:29], 0 cbsz:1 abid:1
    v_exp_f32 v148, v148
    v_exp_f32 v149, v149
    v_exp_f32 v150, v150
    v_exp_f32 v151, v151
    s_waitcnt lgkmcnt(0)
    v_exp_f32 v152, v152
    v_exp_f32 v153, v153
    v_exp_f32 v154, v154
    v_exp_f32 v155, v155
    v_smfmac_f32_32x32x32_bf16 v[204:219], v[84:87], v[140:147], v244
    ds_read_b128 v[236:239], v243 offset:26208
    v_exp_f32 v156, v156
    v_exp_f32 v157, v157
    v_exp_f32 v158, v158
    v_exp_f32 v159, v159
    v_mfma_f32_32x32x16_bf16 v[172:187], v[72:75], v[20:23], v[172:187]
    v_exp_f32 v160, v160
    v_exp_f32 v161, v161
    v_exp_f32 v162, v162
    v_exp_f32 v163, v163
    v_smfmac_f32_32x32x32_bf16 v[204:219], v[92:95], v[148:155], v244
    v_exp_f32 v164, v164
    v_exp_f32 v165, v165
    v_exp_f32 v166, v166
    v_exp_f32 v167, v167
    v_exp_f32 v168, v168
    v_smfmac_f32_32x32x32_bf16 v[220:235], v[84:87], v[156:163], v244
    v_exp_f32 v169, v169
    v_exp_f32 v170, v170
    v_exp_f32 v171, v171
    ds_read_b128 v[68:71], v242 offset:32000
    ds_read_b128 v[84:87], v243 offset:32000
    v_exp_f32 v172, v172
    v_smfmac_f32_32x32x32_bf16 v[220:235], v[92:95], v[164:171], v244
    v_exp_f32 v173, v173
    v_exp_f32 v174, v174
    v_exp_f32 v175, v175
    v_exp_f32 v176, v176
    v_mfma_f32_32x32x16_bf16 v[188:203], v[72:75], v[24:27], v[188:203]
    v_exp_f32 v177, v177
    v_exp_f32 v178, v178
    v_exp_f32 v179, v179
    v_mfma_f32_32x32x4_2b_bf16 v[140:171], v[80:81], v[28:29], 0 cbsz:1 abid:0
    v_exp_f32 v180, v180
    v_exp_f32 v181, v181
    v_exp_f32 v182, v182
    v_exp_f32 v183, v183
    s_waitcnt lgkmcnt(0)
    v_exp_f32 v184, v184
    v_exp_f32 v185, v185
    v_exp_f32 v186, v186
    v_exp_f32 v187, v187
    v_smfmac_f32_32x32x32_bf16 v[204:219], v[88:91], v[172:179], v244
    ds_read_b128 v[92:95], v243 offset:32672
    v_exp_f32 v188, v188
    v_exp_f32 v189, v189
    v_exp_f32 v190, v190
    v_exp_f32 v191, v191
    v_mfma_f32_32x32x16_bf16 v[140:155], v[68:71], v[20:23], v[140:155]
    v_exp_f32 v192, v192
    v_exp_f32 v193, v193
    v_exp_f32 v194, v194
    v_exp_f32 v195, v195
    v_smfmac_f32_32x32x32_bf16 v[204:219], v[236:239], v[180:187], v244
    v_exp_f32 v196, v196
    v_exp_f32 v197, v197
    v_exp_f32 v198, v198
    v_exp_f32 v199, v199
    v_exp_f32 v200, v200
    v_smfmac_f32_32x32x32_bf16 v[220:235], v[88:91], v[188:195], v244
    v_exp_f32 v201, v201
    v_exp_f32 v202, v202
    v_exp_f32 v203, v203
    ds_read_b128 v[72:75], v242 offset:33024
    ds_read_b128 v[88:91], v243 offset:33344
    v_exp_f32 v140, v140
    v_smfmac_f32_32x32x32_bf16 v[220:235], v[236:239], v[196:203], v244
    v_exp_f32 v141, v141
    v_exp_f32 v142, v142
    v_exp_f32 v143, v143
    v_exp_f32 v144, v144
    v_mfma_f32_32x32x16_bf16 v[156:171], v[68:71], v[24:27], v[156:171]
    v_exp_f32 v145, v145
    v_exp_f32 v146, v146
    v_exp_f32 v147, v147
    v_mfma_f32_32x32x4_2b_bf16 v[172:203], v[82:83], v[28:29], 0 cbsz:1 abid:0
    v_exp_f32 v148, v148
    v_exp_f32 v149, v149
    v_exp_f32 v150, v150
    v_exp_f32 v151, v151
    s_waitcnt lgkmcnt(0)
    v_exp_f32 v152, v152
    v_exp_f32 v153, v153
    v_exp_f32 v154, v154
    v_exp_f32 v155, v155
    v_smfmac_f32_32x32x32_bf16 v[204:219], v[84:87], v[140:147], v244
    ds_read_b128 v[236:239], v243 offset:34016
    v_exp_f32 v156, v156
    v_exp_f32 v157, v157
    v_exp_f32 v158, v158
    v_exp_f32 v159, v159
    v_mfma_f32_32x32x16_bf16 v[172:187], v[72:75], v[20:23], v[172:187]
    v_exp_f32 v160, v160
    v_exp_f32 v161, v161
    v_exp_f32 v162, v162
    v_exp_f32 v163, v163
    v_smfmac_f32_32x32x32_bf16 v[204:219], v[92:95], v[148:155], v244
    v_exp_f32 v164, v164
    v_exp_f32 v165, v165
    v_exp_f32 v166, v166
    v_exp_f32 v167, v167
    v_exp_f32 v168, v168
    v_smfmac_f32_32x32x32_bf16 v[220:235], v[84:87], v[156:163], v244
    v_exp_f32 v169, v169
    v_exp_f32 v170, v170
    v_exp_f32 v171, v171
    ds_read_b128 v[68:71], v242 offset:34048
    ds_read_b128 v[84:87], v243 offset:34688
    v_exp_f32 v172, v172
    v_smfmac_f32_32x32x32_bf16 v[220:235], v[92:95], v[164:171], v244
    v_exp_f32 v173, v173
    v_exp_f32 v174, v174
    v_exp_f32 v175, v175
    v_exp_f32 v176, v176
    v_mfma_f32_32x32x16_bf16 v[188:203], v[72:75], v[24:27], v[188:203]
    v_exp_f32 v177, v177
    v_exp_f32 v178, v178
    v_exp_f32 v179, v179
    v_mfma_f32_32x32x4_2b_bf16 v[140:171], v[80:81], v[28:29], 0 cbsz:1 abid:1
    v_exp_f32 v180, v180
    v_exp_f32 v181, v181
    v_exp_f32 v182, v182
    v_exp_f32 v183, v183
    s_waitcnt lgkmcnt(0)
    v_exp_f32 v184, v184
    v_exp_f32 v185, v185
    v_exp_f32 v186, v186
    v_exp_f32 v187, v187
    v_smfmac_f32_32x32x32_bf16 v[204:219], v[88:91], v[172:179], v244
    ds_read_b128 v[92:95], v243 offset:35360
    v_exp_f32 v188, v188
    v_exp_f32 v189, v189
    v_exp_f32 v190, v190
    v_exp_f32 v191, v191
    v_mfma_f32_32x32x16_bf16 v[140:155], v[68:71], v[20:23], v[140:155]
    v_exp_f32 v192, v192
    v_exp_f32 v193, v193
    v_exp_f32 v194, v194
    v_exp_f32 v195, v195
    v_smfmac_f32_32x32x32_bf16 v[204:219], v[236:239], v[180:187], v244
    v_exp_f32 v196, v196
    v_exp_f32 v197, v197
    v_exp_f32 v198, v198
    v_exp_f32 v199, v199
    v_exp_f32 v200, v200
    v_smfmac_f32_32x32x32_bf16 v[220:235], v[88:91], v[188:195], v244
    v_exp_f32 v201, v201
    v_exp_f32 v202, v202
    v_exp_f32 v203, v203
    ds_read_b128 v[72:75], v242 offset:35072
    ds_read_b128 v[88:91], v243 offset:36032
    v_exp_f32 v140, v140
    v_smfmac_f32_32x32x32_bf16 v[220:235], v[236:239], v[196:203], v244
    v_exp_f32 v141, v141
    v_exp_f32 v142, v142
    v_exp_f32 v143, v143
    v_exp_f32 v144, v144
    v_mfma_f32_32x32x16_bf16 v[156:171], v[68:71], v[24:27], v[156:171]
    v_exp_f32 v145, v145
    v_exp_f32 v146, v146
    v_exp_f32 v147, v147
    v_mfma_f32_32x32x4_2b_bf16 v[172:203], v[82:83], v[28:29], 0 cbsz:1 abid:1
    v_exp_f32 v148, v148
    v_exp_f32 v149, v149
    v_exp_f32 v150, v150
    v_exp_f32 v151, v151
    s_waitcnt lgkmcnt(0)
    v_exp_f32 v152, v152
    v_exp_f32 v153, v153
    v_exp_f32 v154, v154
    v_exp_f32 v155, v155
    v_smfmac_f32_32x32x32_bf16 v[204:219], v[84:87], v[140:147], v244
    ds_read_b128 v[236:239], v243 offset:36704
    v_exp_f32 v156, v156
    v_exp_f32 v157, v157
    v_exp_f32 v158, v158
    v_exp_f32 v159, v159
    v_mfma_f32_32x32x16_bf16 v[172:187], v[72:75], v[20:23], v[172:187]
    v_exp_f32 v160, v160
    v_exp_f32 v161, v161
    v_exp_f32 v162, v162
    v_exp_f32 v163, v163
    v_smfmac_f32_32x32x32_bf16 v[204:219], v[92:95], v[148:155], v244
    v_exp_f32 v164, v164
    v_exp_f32 v165, v165
    v_exp_f32 v166, v166
    v_exp_f32 v167, v167
    s_waitcnt lgkmcnt(0)
    s_barrier
    v_exp_f32 v168, v168
    v_smfmac_f32_32x32x32_bf16 v[220:235], v[84:87], v[156:163], v244
    ds_read_b128 v[76:79], v242 offset:4096
    v_exp_f32 v169, v169
    v_exp_f32 v170, v170
    v_exp_f32 v171, v171
    ds_read_b128 v[68:71], v242 offset:0
    ds_read_b128 v[84:87], v243 offset:0
    v_exp_f32 v172, v172
    v_smfmac_f32_32x32x32_bf16 v[220:235], v[92:95], v[164:171], v244
    v_exp_f32 v173, v173
    v_exp_f32 v174, v174
    v_exp_f32 v175, v175
    v_exp_f32 v176, v176
    v_mfma_f32_32x32x16_bf16 v[188:203], v[72:75], v[24:27], v[188:203]
    v_exp_f32 v177, v177
    v_exp_f32 v178, v178
    v_exp_f32 v179, v179
    s_waitcnt lgkmcnt(2)
    v_mfma_f32_32x32x4_2b_bf16 v[140:171], v[76:77], v[28:29], 0 cbsz:1 abid:0
    v_exp_f32 v180, v180
    v_exp_f32 v181, v181
    v_exp_f32 v182, v182
    v_exp_f32 v183, v183
    s_waitcnt lgkmcnt(0)
    v_exp_f32 v184, v184
    v_exp_f32 v185, v185
    v_exp_f32 v186, v186
    v_exp_f32 v187, v187
    v_smfmac_f32_32x32x32_bf16 v[204:219], v[88:91], v[172:179], v244
    ds_read_b128 v[92:95], v243 offset:672
    v_exp_f32 v188, v188
    v_exp_f32 v189, v189
    v_exp_f32 v190, v190
    v_exp_f32 v191, v191
    v_mfma_f32_32x32x16_bf16 v[140:155], v[68:71], v[20:23], v[140:155]
    v_exp_f32 v192, v192
    v_exp_f32 v193, v193
    v_exp_f32 v194, v194
    v_exp_f32 v195, v195
    v_smfmac_f32_32x32x32_bf16 v[204:219], v[236:239], v[180:187], v244
    v_exp_f32 v196, v196
    s_add_u32 s60, s60, 2
    s_cmp_lt_u32 s60, 8
    v_exp_f32 v197, v197
    v_exp_f32 v198, v198
    v_exp_f32 v199, v199
    v_exp_f32 v200, v200
    v_smfmac_f32_32x32x32_bf16 v[220:235], v[88:91], v[188:195], v244
    v_exp_f32 v201, v201
    v_exp_f32 v202, v202
    v_exp_f32 v203, v203
    s_cbranch_scc1 L_loop
    s_nop 0
    v_smfmac_f32_32x32x32_bf16 v[220:235], v[236:239], v[196:203], v244
L_slow_ret:
    s_lshl_b32 s62, s4, 5
    s_add_u32 s62, s62, s3
    s_mul_i32 s62, s62, 2560
    s_add_u32 s62, s62, 4194304
    s_mul_i32 s65, s5, 10240
    s_add_u32 s65, s65, s62
    s_waitcnt lgkmcnt(0)
    buffer_load_dword v16, v15, s[52:55], 0 offen sc1
    v_add_f32 v8, |v204|, |v216|
    v_add_f32 v8, |v205|, v8
    v_add_f32 v8, |v206|, v8
    v_add_f32 v8, |v207|, v8
    v_add_f32 v8, |v208|, v8
    v_add_f32 v8, |v209|, v8
    v_add_f32 v8, |v210|, v8
    v_add_f32 v8, |v211|, v8
    v_add_f32 v8, |v212|, v8
    v_add_f32 v8, |v213|, v8
    v_add_f32 v8, |v214|, v8
    v_add_f32 v8, |v215|, v8
    v_add_f32 v9, |v220|, |v232|
    v_add_f32 v9, |v221|, v9
    v_add_f32 v9, |v222|, v9
    v_add_f32 v9, |v223|, v9
    v_add_f32 v9, |v224|, v9
    v_add_f32 v9, |v225|, v9
    v_add_f32 v9, |v226|, v9
    v_add_f32 v9, |v227|, v9
    v_add_f32 v9, |v228|, v9
    v_add_f32 v9, |v229|, v9
    v_add_f32 v9, |v230|, v9
    v_add_f32 v9, |v231|, v9
    v_add_f32 v8, v8, v9
    v_min_f32 v9, v216, v232
    v_cmp_ngt_f32 vcc, 0x71800000, v8
    s_cbranch_vccnz L_slow
    v_cmp_ngt_f32 vcc, v9, v245
    s_cbranch_vccnz L_slow
L_guard_ok:
    v_rcp_f32 v8, v216
    v_rcp_f32 v9, v232
    v_mul_f32 v204, v204, v8
    v_mul_f32 v205, v205, v8
    v_mul_f32 v206, v206, v8
    v_mul_f32 v207, v207, v8
    v_mul_f32 v208, v208, v8
    v_mul_f32 v209, v209, v8
    v_mul_f32 v210, v210, v8
    v_mul_f32 v211, v211, v8
    v_mul_f32 v212, v212, v8
    v_mul_f32 v213, v213, v8
    v_mul_f32 v214, v214, v8
    v_mul_f32 v215, v215, v8
    v_cvt_pk_bf16_f32 v204, v204, v205
    v_cvt_pk_bf16_f32 v205, v206, v207
    v_cvt_pk_bf16_f32 v206, v208, v209
    v_cvt_pk_bf16_f32 v207, v210, v211
    v_cvt_pk_bf16_f32 v208, v212, v213
    v_cvt_pk_bf16_f32 v209, v214, v215
    v_min_u32 v236, -2, v204
    v_min_u32 v237, -2, v205
    v_min_u32 v238, -2, v206
    v_min_u32 v239, -2, v207
    buffer_store_dwordx4 v[236:239], v12, s[52:55], s65 offen offset:0
    v_mul_f32 v220, v220, v9
    v_mul_f32 v221, v221, v9
    v_mul_f32 v222, v222, v9
    v_mul_f32 v223, v223, v9
    v_mul_f32 v224, v224, v9
    v_mul_f32 v225, v225, v9
    v_mul_f32 v226, v226, v9
    v_mul_f32 v227, v227, v9
    v_mul_f32 v228, v228, v9
    v_mul_f32 v229, v229, v9
    v_mul_f32 v230, v230, v9
    v_mul_f32 v231, v231, v9
    v_cvt_pk_bf16_f32 v220, v220, v221
    v_cvt_pk_bf16_f32 v221, v222, v223
    v_cvt_pk_bf16_f32 v222, v224, v225
    v_cvt_pk_bf16_f32 v223, v226, v227
    v_cvt_pk_bf16_f32 v224, v228, v229
    v_cvt_pk_bf16_f32 v225, v230, v231
    v_min_u32 v240, -2, v220
    v_min_u32 v241, -2, v221
    v_min_u32 v242, -2, v222
    v_min_u32 v243, -2, v223
    buffer_store_dwordx4 v[240:243], v12, s[52:55], s65 offen offset:1024
    v_permlane32_swap_b32 v208, v224
    v_permlane32_swap_b32 v209, v225
    v_min_u32 v244, -2, v208
    v_min_u32 v245, -2, v209
    buffer_store_dwordx2 v[244:245], v246, s[52:55], s65 offen offset:2048
    s_mov_b32 s61, 0
    s_bitcmp1_b32 s61, 4
    s_cbranch_scc1 bst_38
    s_bitset1_b32 s61, 4
    s_add_u32 s51, s65, 4194304
    buffer_store_dwordx4 v[236:239], v12, s[52:55], s51 offen offset:0 sc1
    buffer_store_dwordx4 v[240:243], v12, s[52:55], s51 offen offset:1024 sc1
    buffer_store_dwordx2 v[244:245], v246, s[52:55], s51 offen offset:2048 sc1
bst_38:
    v_mov_b32 v13, 104448
    s_waitcnt vmcnt(6)
    v_cmp_ne_u32 vcc, s6, v16
    s_cbranch_vccnz fl_39c
fl_39:
    s_waitcnt lgkmcnt(4)
    s_add_u32 s51, s62, 0
    buffer_load_dwordx4 v[36:39], v12, s[52:55], s51 offen offset:0 sc1
    ds_read_b64_tr_b16 v[136:137], v247 offset:0
    buffer_load_dwordx4 v[40:43], v12, s[52:55], s51 offen offset:1024 sc1
    ds_read_b64_tr_b16 v[138:139], v247 offset:1280
    ds_read_b64_tr_b16 v[140:141], v247 offset:8
    buffer_load_dwordx2 v[52:53], v246, s[52:55], s51 offen offset:2048 sc1
    ds_read_b64_tr_b16 v[142:143], v247 offset:1288
    ds_read_b64_tr_b16 v[144:145], v247 offset:16
    s_add_u32 s51, s62, 10240
    buffer_load_dwordx4 v[44:47], v12, s[52:55], s51 offen offset:0 sc1
    ds_read_b64_tr_b16 v[146:147], v247 offset:1296
    ds_read_b64_tr_b16 v[148:149], v247 offset:24
    buffer_load_dwordx4 v[48:51], v12, s[52:55], s51 offen offset:1024 sc1
    ds_read_b64_tr_b16 v[150:151], v247 offset:1304
    ds_read_b64_tr_b16 v[152:153], v247 offset:32
    buffer_load_dwordx2 v[54:55], v246, s[52:55], s51 offen offset:2048 sc1
    ds_read_b64_tr_b16 v[154:155], v247 offset:1312
    s_waitcnt lgkmcnt(4)
    s_add_u32 s51, s62, 20480
    buffer_load_dwordx4 v[56:59], v12, s[52:55], s51 offen offset:0 sc1
    ds_read_b64_tr_b16 v[156:157], v247 offset:6400
    buffer_load_dwordx4 v[60:63], v12, s[52:55], s51 offen offset:1024 sc1
    ds_read_b64_tr_b16 v[158:159], v247 offset:7680
    ds_read_b64_tr_b16 v[160:161], v247 offset:6408
    buffer_load_dwordx2 v[72:73], v246, s[52:55], s51 offen offset:2048 sc1
    ds_read_b64_tr_b16 v[162:163], v247 offset:7688
    ds_read_b64_tr_b16 v[164:165], v247 offset:6416
    s_add_u32 s51, s62, 30720
    buffer_load_dwordx4 v[64:67], v12, s[52:55], s51 offen offset:0 sc1
    ds_read_b64_tr_b16 v[166:167], v247 offset:7696
    ds_read_b64_tr_b16 v[168:169], v247 offset:6424
    buffer_load_dwordx4 v[68:71], v12, s[52:55], s51 offen offset:1024 sc1
    ds_read_b64_tr_b16 v[170:171], v247 offset:7704
    ds_read_b64_tr_b16 v[172:173], v247 offset:6432
    buffer_load_dwordx2 v[74:75], v246, s[52:55], s51 offen offset:2048 sc1
    ds_read_b64_tr_b16 v[174:175], v247 offset:7712
    s_waitcnt lgkmcnt(4)
    s_add_u32 s51, s62, 40960
    buffer_load_dwordx4 v[76:79], v12, s[52:55], s51 offen offset:0 sc1
    ds_read_b64_tr_b16 v[176:177], v247 offset:12800
    buffer_load_dwordx4 v[80:83], v12, s[52:55], s51 offen offset:1024 sc1
    ds_read_b64_tr_b16 v[178:179], v247 offset:14080
    ds_read_b64_tr_b16 v[180:181], v247 offset:12808
    buffer_load_dwordx2 v[92:93], v246, s[52:55], s51 offen offset:2048 sc1
    ds_read_b64_tr_b16 v[182:183], v247 offset:14088
    ds_read_b64_tr_b16 v[184:185], v247 offset:12816
    s_add_u32 s51, s62, 51200
    buffer_load_dwordx4 v[84:87], v12, s[52:55], s51 offen offset:0 sc1
    ds_read_b64_tr_b16 v[186:187], v247 offset:14096
    ds_read_b64_tr_b16 v[188:189], v247 offset:12824
    buffer_load_dwordx4 v[88:91], v12, s[52:55], s51 offen offset:1024 sc1
    ds_read_b64_tr_b16 v[190:191], v247 offset:14104
    ds_read_b64_tr_b16 v[192:193], v247 offset:12832
    buffer_load_dwordx2 v[94:95], v246, s[52:55], s51 offen offset:2048 sc1
    ds_read_b64_tr_b16 v[194:195], v247 offset:14112
    s_waitcnt lgkmcnt(4)
    s_add_u32 s51, s62, 61440
    buffer_load_dwordx4 v[96:99], v12, s[52:55], s51 offen offset:0 sc1
    ds_read_b64_tr_b16 v[196:197], v247 offset:19200
    buffer_load_dwordx4 v[100:103], v12, s[52:55], s51 offen offset:1024 sc1
    ds_read_b64_tr_b16 v[198:199], v247 offset:20480
    ds_read_b64_tr_b16 v[200:201], v247 offset:19208
    buffer_load_dwordx2 v[112:113], v246, s[52:55], s51 offen offset:2048 sc1
    ds_read_b64_tr_b16 v[202:203], v247 offset:20488
    ds_read_b64_tr_b16 v[204:205], v247 offset:19216
    s_add_u32 s51, s62, 71680
    buffer_load_dwordx4 v[104:107], v12, s[52:55], s51 offen offset:0 sc1
    ds_read_b64_tr_b16 v[206:207], v247 offset:20496
    ds_read_b64_tr_b16 v[208:209], v247 offset:19224
    buffer_load_dwordx4 v[108:111], v12, s[52:55], s51 offen offset:1024 sc1
    ds_read_b64_tr_b16 v[210:211], v247 offset:20504
    ds_read_b64_tr_b16 v[212:213], v247 offset:19232
    buffer_load_dwordx2 v[114:115], v246, s[52:55], s51 offen offset:2048 sc1
    ds_read_b64_tr_b16 v[214:215], v247 offset:20512
    s_waitcnt vmcnt(18)
    s_mov_b32 s60, 0
    v_max3_u32 v8, v36, v37, v38
    v_max3_u32 v9, v39, v40, v41
    v_max3_u32 v8, v8, v42, v43
    v_max3_u32 v9, v9, v44, v45
    v_max3_u32 v8, v8, v46, v47
    v_max3_u32 v9, v9, v48, v49
    v_max3_u32 v8, v8, v50, v51
    v_max3_u32 v9, v9, v52, v53
    v_max3_u32 v8, v8, v54, v55
    v_max_u32 v8, v8, v9
    v_cmp_eq_u32 vcc, -1, v8
    s_cbranch_vccnz rnd_44
go_45:
    s_waitcnt lgkmcnt(10)
    v_mfma_f32_16x16x32_bf16 v[116:119], v[136:139], v[36:39], 0
    ds_read_b64_tr_b16 v[216:217], v248 offset:0
    ds_read_b64_tr_b16 v[218:219], v248 offset:12800
    v_mfma_f32_16x16x32_bf16 v[120:123], v[140:143], v[36:39], 0
    ds_read_b64_tr_b16 v[220:221], v248 offset:8
    ds_read_b64_tr_b16 v[222:223], v248 offset:12808
    v_mfma_f32_16x16x32_bf16 v[124:127], v[144:147], v[36:39], 0
    ds_read_b64_tr_b16 v[224:225], v248 offset:16
    ds_read_b64_tr_b16 v[226:227], v248 offset:12816
    v_mfma_f32_16x16x32_bf16 v[128:131], v[148:151], v[36:39], 0
    ds_read_b64_tr_b16 v[228:229], v248 offset:24
    ds_read_b64_tr_b16 v[230:231], v248 offset:12824
    v_mfma_f32_16x16x32_bf16 v[132:135], v[152:155], v[36:39], 0
    ds_read_b64_tr_b16 v[232:233], v248 offset:32
    ds_read_b64_tr_b16 v[234:235], v248 offset:12832
    s_waitcnt lgkmcnt(10)
    v_mfma_f32_16x16x32_bf16 v[116:119], v[156:159], v[40:43], v[116:119]
    ds_read_b64_tr_b16 v[136:137], v247 offset:25600
    ds_read_b64_tr_b16 v[138:139], v247 offset:26880
    v_mfma_f32_16x16x32_bf16 v[120:123], v[160:163], v[40:43], v[120:123]
    ds_read_b64_tr_b16 v[140:141], v247 offset:25608
    ds_read_b64_tr_b16 v[142:143], v247 offset:26888
    v_mfma_f32_16x16x32_bf16 v[124:127], v[164:167], v[40:43], v[124:127]
    ds_read_b64_tr_b16 v[144:145], v247 offset:25616
    ds_read_b64_tr_b16 v[146:147], v247 offset:26896
    v_mfma_f32_16x16x32_bf16 v[128:131], v[168:171], v[40:43], v[128:131]
    ds_read_b64_tr_b16 v[148:149], v247 offset:25624
    ds_read_b64_tr_b16 v[150:151], v247 offset:26904
    v_mfma_f32_16x16x32_bf16 v[132:135], v[172:175], v[40:43], v[132:135]
    ds_read_b64_tr_b16 v[152:153], v247 offset:25632
    ds_read_b64_tr_b16 v[154:155], v247 offset:26912
    s_waitcnt lgkmcnt(10)
    v_mfma_f32_16x16x32_bf16 v[116:119], v[176:179], v[44:47], v[116:119]
    ds_read_b64_tr_b16 v[156:157], v247 offset:32000
    ds_read_b64_tr_b16 v[158:159], v247 offset:33280
    v_mfma_f32_16x16x32_bf16 v[120:123], v[180:183], v[44:47], v[120:123]
    ds_read_b64_tr_b16 v[160:161], v247 offset:32008
    ds_read_b64_tr_b16 v[162:163], v247 offset:33288
    v_mfma_f32_16x16x32_bf16 v[124:127], v[184:187], v[44:47], v[124:127]
    ds_read_b64_tr_b16 v[164:165], v247 offset:32016
    ds_read_b64_tr_b16 v[166:167], v247 offset:33296
    v_mfma_f32_16x16x32_bf16 v[128:131], v[188:191], v[44:47], v[128:131]
    ds_read_b64_tr_b16 v[168:169], v247 offset:32024
    ds_read_b64_tr_b16 v[170:171], v247 offset:33304
    v_mfma_f32_16x16x32_bf16 v[132:135], v[192:195], v[44:47], v[132:135]
    ds_read_b64_tr_b16 v[172:173], v247 offset:32032
    ds_read_b64_tr_b16 v[174:175], v247 offset:33312
    s_waitcnt lgkmcnt(10)
    v_mfma_f32_16x16x32_bf16 v[116:119], v[196:199], v[48:51], v[116:119]
    ds_read_b64_tr_b16 v[176:177], v247 offset:38400
    ds_read_b64_tr_b16 v[178:179], v247 offset:39680
    v_mfma_f32_16x16x32_bf16 v[120:123], v[200:203], v[48:51], v[120:123]
    ds_read_b64_tr_b16 v[180:181], v247 offset:38408
    ds_read_b64_tr_b16 v[182:183], v247 offset:39688
    v_mfma_f32_16x16x32_bf16 v[124:127], v[204:207], v[48:51], v[124:127]
    ds_read_b64_tr_b16 v[184:185], v247 offset:38416
    ds_read_b64_tr_b16 v[186:187], v247 offset:39696
    v_mfma_f32_16x16x32_bf16 v[128:131], v[208:211], v[48:51], v[128:131]
    ds_read_b64_tr_b16 v[188:189], v247 offset:38424
    ds_read_b64_tr_b16 v[190:191], v247 offset:39704
    v_mfma_f32_16x16x32_bf16 v[132:135], v[212:215], v[48:51], v[132:135]
    ds_read_b64_tr_b16 v[192:193], v247 offset:38432
    ds_read_b64_tr_b16 v[194:195], v247 offset:39712
    s_waitcnt lgkmcnt(10)
    v_mfma_f32_16x16x32_bf16 v[116:119], v[216:219], v[52:55], v[116:119]
    ds_read_b64_tr_b16 v[196:197], v247 offset:44800
    ds_read_b64_tr_b16 v[198:199], v247 offset:46080
    v_mfma_f32_16x16x32_bf16 v[120:123], v[220:223], v[52:55], v[120:123]
    ds_read_b64_tr_b16 v[200:201], v247 offset:44808
    ds_read_b64_tr_b16 v[202:203], v247 offset:46088
    v_mfma_f32_16x16x32_bf16 v[124:127], v[224:227], v[52:55], v[124:127]
    ds_read_b64_tr_b16 v[204:205], v247 offset:44816
    ds_read_b64_tr_b16 v[206:207], v247 offset:46096
    v_mfma_f32_16x16x32_bf16 v[128:131], v[228:231], v[52:55], v[128:131]
    ds_read_b64_tr_b16 v[208:209], v247 offset:44824
    ds_read_b64_tr_b16 v[210:211], v247 offset:46104
    v_mfma_f32_16x16x32_bf16 v[132:135], v[232:235], v[52:55], v[132:135]
    ds_read_b64_tr_b16 v[212:213], v247 offset:44832
    ds_read_b64_tr_b16 v[214:215], v247 offset:46112
    s_waitcnt vmcnt(0)
    v_max3_u32 v8, v56, v57, v58
    v_max3_u32 v9, v59, v60, v61
    v_max3_u32 v8, v8, v62, v63
    v_max3_u32 v9, v9, v64, v65
    v_max3_u32 v8, v8, v66, v67
    v_max3_u32 v9, v9, v68, v69
    v_max3_u32 v8, v8, v70, v71
    v_max3_u32 v9, v9, v72, v73
    v_max3_u32 v8, v8, v74, v75
    v_max3_u32 v9, v9, v76, v77
    v_max3_u32 v8, v8, v78, v79
    v_max3_u32 v9, v9, v80, v81
    v_max3_u32 v8, v8, v82, v83
    v_max3_u32 v9, v9, v84, v85
    v_max3_u32 v8, v8, v86, v87
    v_max3_u32 v9, v9, v88, v89
    v_max3_u32 v8, v8, v90, v91
    v_max3_u32 v9, v9, v92, v93
    v_max3_u32 v8, v8, v94, v95
    v_max3_u32 v9, v9, v96, v97
    v_max3_u32 v8, v8, v98, v99
    v_max3_u32 v9, v9, v100, v101
    v_max3_u32 v8, v8, v102, v103
    v_max3_u32 v9, v9, v104, v105
    v_max3_u32 v8, v8, v106, v107
    v_max3_u32 v9, v9, v108, v109
    v_max3_u32 v8, v8, v110, v111
    v_max3_u32 v9, v9, v112, v113
    v_max3_u32 v8, v8, v114, v115
    v_max_u32 v8, v8, v9
    v_cmp_eq_u32 vcc, -1, v8
    s_cbranch_vccnz rnd_50
    s_or_b32 s61, s61, 14
go_51:
    s_setprio 0
    s_waitcnt lgkmcnt(10)
    v_mfma_f32_16x16x32_bf16 v[116:119], v[136:139], v[56:59], v[116:119]
    ds_read_b64_tr_b16 v[216:217], v248 offset:25600
    ds_read_b64_tr_b16 v[218:219], v248 offset:38400
    v_mfma_f32_16x16x32_bf16 v[120:123], v[140:143], v[56:59], v[120:123]
    ds_read_b64_tr_b16 v[220:221], v248 offset:25608
    ds_read_b64_tr_b16 v[222:223], v248 offset:38408
    v_mfma_f32_16x16x32_bf16 v[124:127], v[144:147], v[56:59], v[124:127]
    ds_read_b64_tr_b16 v[224:225], v248 offset:25616
    ds_read_b64_tr_b16 v[226:227], v248 offset:38416
    v_mfma_f32_16x16x32_bf16 v[128:131], v[148:151], v[56:59], v[128:131]
    ds_read_b64_tr_b16 v[228:229], v248 offset:25624
    ds_read_b64_tr_b16 v[230:231], v248 offset:38424
    v_mfma_f32_16x16x32_bf16 v[132:135], v[152:155], v[56:59], v[132:135]
    ds_read_b64_tr_b16 v[232:233], v248 offset:25632
    ds_read_b64_tr_b16 v[234:235], v248 offset:38432
    s_mov_b32 s64, 800000
ls_60:
    ds_read_b32 v8, v13 offset:0
    s_sub_u32 s64, s64, 1
    s_cbranch_scc1 lsd_61
    s_waitcnt lgkmcnt(0)
    v_cmp_gt_u32 vcc, 4, v8
    s_cbranch_vccnz ls_60
lsd_61:
    v_subrev_u32 v247, 51200, v247
    v_subrev_u32 v248, 51200, v248
    s_waitcnt lgkmcnt(10)
    v_mfma_f32_16x16x32_bf16 v[116:119], v[156:159], v[60:63], v[116:119]
    ds_read_b64_tr_b16 v[136:137], v247 offset:0
    ds_read_b64_tr_b16 v[138:139], v247 offset:1280
    v_mfma_f32_16x16x32_bf16 v[120:123], v[160:163], v[60:63], v[120:123]
    ds_read_b64_tr_b16 v[140:141], v247 offset:8
    ds_read_b64_tr_b16 v[142:143], v247 offset:1288
    v_mfma_f32_16x16x32_bf16 v[124:127], v[164:167], v[60:63], v[124:127]
    ds_read_b64_tr_b16 v[144:145], v247 offset:16
    ds_read_b64_tr_b16 v[146:147], v247 offset:1296
    v_mfma_f32_16x16x32_bf16 v[128:131], v[168:171], v[60:63], v[128:131]
    ds_read_b64_tr_b16 v[148:149], v247 offset:24
    ds_read_b64_tr_b16 v[150:151], v247 offset:1304
    v_mfma_f32_16x16x32_bf16 v[132:135], v[172:175], v[60:63], v[132:135]
    ds_read_b64_tr_b16 v[152:153], v247 offset:32
    ds_read_b64_tr_b16 v[154:155], v247 offset:1312
    s_waitcnt lgkmcnt(10)
    v_mfma_f32_16x16x32_bf16 v[116:119], v[176:179], v[64:67], v[116:119]
    ds_read_b64_tr_b16 v[156:157], v247 offset:6400
    ds_read_b64_tr_b16 v[158:159], v247 offset:7680
    v_mfma_f32_16x16x32_bf16 v[120:123], v[180:183], v[64:67], v[120:123]
    ds_read_b64_tr_b16 v[160:161], v247 offset:6408
    ds_read_b64_tr_b16 v[162:163], v247 offset:7688
    v_mfma_f32_16x16x32_bf16 v[124:127], v[184:187], v[64:67], v[124:127]
    ds_read_b64_tr_b16 v[164:165], v247 offset:6416
    ds_read_b64_tr_b16 v[166:167], v247 offset:7696
    v_mfma_f32_16x16x32_bf16 v[128:131], v[188:191], v[64:67], v[128:131]
    ds_read_b64_tr_b16 v[168:169], v247 offset:6424
    ds_read_b64_tr_b16 v[170:171], v247 offset:7704
    v_mfma_f32_16x16x32_bf16 v[132:135], v[192:195], v[64:67], v[132:135]
    ds_read_b64_tr_b16 v[172:173], v247 offset:6432
    ds_read_b64_tr_b16 v[174:175], v247 offset:7712
    s_waitcnt lgkmcnt(10)
    v_mfma_f32_16x16x32_bf16 v[116:119], v[196:199], v[68:71], v[116:119]
    ds_read_b64_tr_b16 v[176:177], v247 offset:12800
    ds_read_b64_tr_b16 v[178:179], v247 offset:14080
    v_mfma_f32_16x16x32_bf16 v[120:123], v[200:203], v[68:71], v[120:123]
    ds_read_b64_tr_b16 v[180:181], v247 offset:12808
    ds_read_b64_tr_b16 v[182:183], v247 offset:14088
    v_mfma_f32_16x16x32_bf16 v[124:127], v[204:207], v[68:71], v[124:127]
    ds_read_b64_tr_b16 v[184:185], v247 offset:12816
    ds_read_b64_tr_b16 v[186:187], v247 offset:14096
    v_mfma_f32_16x16x32_bf16 v[128:131], v[208:211], v[68:71], v[128:131]
    ds_read_b64_tr_b16 v[188:189], v247 offset:12824
    ds_read_b64_tr_b16 v[190:191], v247 offset:14104
    v_mfma_f32_16x16x32_bf16 v[132:135], v[212:215], v[68:71], v[132:135]
    ds_read_b64_tr_b16 v[192:193], v247 offset:12832
    ds_read_b64_tr_b16 v[194:195], v247 offset:14112
    s_waitcnt lgkmcnt(10)
    v_mfma_f32_16x16x32_bf16 v[116:119], v[216:219], v[72:75], v[116:119]
    ds_read_b64_tr_b16 v[196:197], v247 offset:19200
    ds_read_b64_tr_b16 v[198:199], v247 offset:20480
    v_mfma_f32_16x16x32_bf16 v[120:123], v[220:223], v[72:75], v[120:123]
    ds_read_b64_tr_b16 v[200:201], v247 offset:19208
    ds_read_b64_tr_b16 v[202:203], v247 offset:20488
    v_mfma_f32_16x16x32_bf16 v[124:127], v[224:227], v[72:75], v[124:127]
    ds_read_b64_tr_b16 v[204:205], v247 offset:19216
    ds_read_b64_tr_b16 v[206:207], v247 offset:20496
    v_mfma_f32_16x16x32_bf16 v[128:131], v[228:231], v[72:75], v[128:131]
    ds_read_b64_tr_b16 v[208:209], v247 offset:19224
    ds_read_b64_tr_b16 v[210:211], v247 offset:20504
    v_mfma_f32_16x16x32_bf16 v[132:135], v[232:235], v[72:75], v[132:135]
    ds_read_b64_tr_b16 v[212:213], v247 offset:19232
    ds_read_b64_tr_b16 v[214:215], v247 offset:20512
    s_bitcmp1_b32 s61, 2
    s_cbranch_scc0 rnd_62
go_63:
    s_waitcnt lgkmcnt(10)
    ds_add_u32 v7, v14 offset:1036
    v_mfma_f32_16x16x32_bf16 v[116:119], v[136:139], v[76:79], v[116:119]
    ds_read_b64_tr_b16 v[216:217], v248 offset:0
    ds_read_b64_tr_b16 v[218:219], v248 offset:12800
    v_mfma_f32_16x16x32_bf16 v[120:123], v[140:143], v[76:79], v[120:123]
    ds_read_b64_tr_b16 v[220:221], v248 offset:8
    ds_read_b64_tr_b16 v[222:223], v248 offset:12808
    v_mfma_f32_16x16x32_bf16 v[124:127], v[144:147], v[76:79], v[124:127]
    ds_read_b64_tr_b16 v[224:225], v248 offset:16
    ds_read_b64_tr_b16 v[226:227], v248 offset:12816
    v_mfma_f32_16x16x32_bf16 v[128:131], v[148:151], v[76:79], v[128:131]
    ds_read_b64_tr_b16 v[228:229], v248 offset:24
    ds_read_b64_tr_b16 v[230:231], v248 offset:12824
    v_mfma_f32_16x16x32_bf16 v[132:135], v[152:155], v[76:79], v[132:135]
    ds_read_b64_tr_b16 v[232:233], v248 offset:32
    ds_read_b64_tr_b16 v[234:235], v248 offset:12832
    s_waitcnt lgkmcnt(10)
    v_mfma_f32_16x16x32_bf16 v[116:119], v[156:159], v[80:83], v[116:119]
    ds_read_b64_tr_b16 v[136:137], v247 offset:25600
    ds_read_b64_tr_b16 v[138:139], v247 offset:26880
    v_mfma_f32_16x16x32_bf16 v[120:123], v[160:163], v[80:83], v[120:123]
    ds_read_b64_tr_b16 v[140:141], v247 offset:25608
    ds_read_b64_tr_b16 v[142:143], v247 offset:26888
    v_mfma_f32_16x16x32_bf16 v[124:127], v[164:167], v[80:83], v[124:127]
    ds_read_b64_tr_b16 v[144:145], v247 offset:25616
    ds_read_b64_tr_b16 v[146:147], v247 offset:26896
    v_mfma_f32_16x16x32_bf16 v[128:131], v[168:171], v[80:83], v[128:131]
    ds_read_b64_tr_b16 v[148:149], v247 offset:25624
    ds_read_b64_tr_b16 v[150:151], v247 offset:26904
    v_mfma_f32_16x16x32_bf16 v[132:135], v[172:175], v[80:83], v[132:135]
    ds_read_b64_tr_b16 v[152:153], v247 offset:25632
    ds_read_b64_tr_b16 v[154:155], v247 offset:26912
    s_waitcnt lgkmcnt(10)
    v_mfma_f32_16x16x32_bf16 v[116:119], v[176:179], v[84:87], v[116:119]
    ds_read_b64_tr_b16 v[156:157], v247 offset:32000
    ds_read_b64_tr_b16 v[158:159], v247 offset:33280
    v_mfma_f32_16x16x32_bf16 v[120:123], v[180:183], v[84:87], v[120:123]
    ds_read_b64_tr_b16 v[160:161], v247 offset:32008
    ds_read_b64_tr_b16 v[162:163], v247 offset:33288
    v_mfma_f32_16x16x32_bf16 v[124:127], v[184:187], v[84:87], v[124:127]
    ds_read_b64_tr_b16 v[164:165], v247 offset:32016
    ds_read_b64_tr_b16 v[166:167], v247 offset:33296
    v_mfma_f32_16x16x32_bf16 v[128:131], v[188:191], v[84:87], v[128:131]
    ds_read_b64_tr_b16 v[168:169], v247 offset:32024
    ds_read_b64_tr_b16 v[170:171], v247 offset:33304
    v_mfma_f32_16x16x32_bf16 v[132:135], v[192:195], v[84:87], v[132:135]
    ds_read_b64_tr_b16 v[172:173], v247 offset:32032
    ds_read_b64_tr_b16 v[174:175], v247 offset:33312
    s_waitcnt lgkmcnt(10)
    v_mfma_f32_16x16x32_bf16 v[116:119], v[196:199], v[88:91], v[116:119]
    ds_read_b64_tr_b16 v[176:177], v247 offset:38400
    ds_read_b64_tr_b16 v[178:179], v247 offset:39680
    v_mfma_f32_16x16x32_bf16 v[120:123], v[200:203], v[88:91], v[120:123]
    ds_read_b64_tr_b16 v[180:181], v247 offset:38408
    ds_read_b64_tr_b16 v[182:183], v247 offset:39688
    v_mfma_f32_16x16x32_bf16 v[124:127], v[204:207], v[88:91], v[124:127]
    ds_read_b64_tr_b16 v[184:185], v247 offset:38416
    ds_read_b64_tr_b16 v[186:187], v247 offset:39696
    v_mfma_f32_16x16x32_bf16 v[128:131], v[208:211], v[88:91], v[128:131]
    ds_read_b64_tr_b16 v[188:189], v247 offset:38424
    ds_read_b64_tr_b16 v[190:191], v247 offset:39704
    v_mfma_f32_16x16x32_bf16 v[132:135], v[212:215], v[88:91], v[132:135]
    ds_read_b64_tr_b16 v[192:193], v247 offset:38432
    ds_read_b64_tr_b16 v[194:195], v247 offset:39712
    s_waitcnt lgkmcnt(10)
    v_mfma_f32_16x16x32_bf16 v[116:119], v[216:219], v[92:95], v[116:119]
    ds_read_b64_tr_b16 v[196:197], v247 offset:44800
    ds_read_b64_tr_b16 v[198:199], v247 offset:46080
    v_mfma_f32_16x16x32_bf16 v[120:123], v[220:223], v[92:95], v[120:123]
    ds_read_b64_tr_b16 v[200:201], v247 offset:44808
    ds_read_b64_tr_b16 v[202:203], v247 offset:46088
    v_mfma_f32_16x16x32_bf16 v[124:127], v[224:227], v[92:95], v[124:127]
    ds_read_b64_tr_b16 v[204:205], v247 offset:44816
    ds_read_b64_tr_b16 v[206:207], v247 offset:46096
    v_mfma_f32_16x16x32_bf16 v[128:131], v[228:231], v[92:95], v[128:131]
    ds_read_b64_tr_b16 v[208:209], v247 offset:44824
    ds_read_b64_tr_b16 v[210:211], v247 offset:46104
    v_mfma_f32_16x16x32_bf16 v[132:135], v[232:235], v[92:95], v[132:135]
    ds_read_b64_tr_b16 v[212:213], v247 offset:44832
    ds_read_b64_tr_b16 v[214:215], v247 offset:46112
    s_bitcmp1_b32 s61, 3
    s_cbranch_scc0 rnd_70
go_71:
    s_waitcnt lgkmcnt(10)
    v_mfma_f32_16x16x32_bf16 v[116:119], v[136:139], v[96:99], v[116:119]
    ds_read_b64_tr_b16 v[216:217], v248 offset:25600
    ds_read_b64_tr_b16 v[218:219], v248 offset:38400
    v_mfma_f32_16x16x32_bf16 v[120:123], v[140:143], v[96:99], v[120:123]
    ds_read_b64_tr_b16 v[220:221], v248 offset:25608
    ds_read_b64_tr_b16 v[222:223], v248 offset:38408
    v_mfma_f32_16x16x32_bf16 v[124:127], v[144:147], v[96:99], v[124:127]
    ds_read_b64_tr_b16 v[224:225], v248 offset:25616
    ds_read_b64_tr_b16 v[226:227], v248 offset:38416
    v_mfma_f32_16x16x32_bf16 v[128:131], v[148:151], v[96:99], v[128:131]
    ds_read_b64_tr_b16 v[228:229], v248 offset:25624
    ds_read_b64_tr_b16 v[230:231], v248 offset:38424
    v_mfma_f32_16x16x32_bf16 v[132:135], v[152:155], v[96:99], v[132:135]
    ds_read_b64_tr_b16 v[232:233], v248 offset:25632
    ds_read_b64_tr_b16 v[234:235], v248 offset:38432
    s_waitcnt lgkmcnt(10)
    v_mfma_f32_16x16x32_bf16 v[116:119], v[156:159], v[100:103], v[116:119]
    s_mov_b32 s56, s44
    s_and_b32 s57, s45, 0xffff
    v_mfma_f32_16x16x32_bf16 v[120:123], v[160:163], v[100:103], v[120:123]
    s_mov_b32 s58, 0x500000
    s_mov_b32 s59, 0x20000
    v_mfma_f32_16x16x32_bf16 v[124:127], v[164:167], v[100:103], v[124:127]
    s_mul_i32 s7, s3, 2816
    s_add_u32 s7, s7, 53248
    v_mfma_f32_16x16x32_bf16 v[128:131], v[168:171], v[100:103], v[128:131]
    v_and_b32 v8, 15, v1
    v_mul_u32_u24 v8, 176, v8
    v_mfma_f32_16x16x32_bf16 v[132:135], v[172:175], v[100:103], v[132:135]
    v_lshrrev_b32 v9, 4, v1
    v_mul_u32_u24 v9, 40, v9
    s_waitcnt lgkmcnt(10)
    v_mfma_f32_16x16x32_bf16 v[116:119], v[176:179], v[104:107], v[116:119]
    v_add3_u32 v20, v8, v9, s7
    v_add_u32 v8, 0, v1
    v_mfma_f32_16x16x32_bf16 v[120:123], v[180:183], v[104:107], v[120:123]
    v_mul_u32_u24 v9, 205, v8
    v_lshrrev_b32 v9, 11, v9
    v_mfma_f32_16x16x32_bf16 v[124:127], v[184:187], v[104:107], v[124:127]
    v_add_u32 v10, v8, v9
    v_lshl_add_u32 v22, v10, 4, s7
    v_mfma_f32_16x16x32_bf16 v[128:131], v[188:191], v[104:107], v[128:131]
    v_mul_u32_u24 v9, 150, v9
    v_add_lshl_u32 v26, v8, v9, 4
    v_mfma_f32_16x16x32_bf16 v[132:135], v[192:195], v[104:107], v[132:135]
    v_add_u32 v8, 64, v1
    v_mul_u32_u24 v9, 205, v8
    s_waitcnt lgkmcnt(10)
    v_mfma_f32_16x16x32_bf16 v[116:119], v[196:199], v[108:111], v[116:119]
    v_lshrrev_b32 v9, 11, v9
    v_add_u32 v10, v8, v9
    v_mfma_f32_16x16x32_bf16 v[120:123], v[200:203], v[108:111], v[120:123]
    v_lshl_add_u32 v23, v10, 4, s7
    v_mul_u32_u24 v9, 150, v9
    v_mfma_f32_16x16x32_bf16 v[124:127], v[204:207], v[108:111], v[124:127]
    v_add_lshl_u32 v27, v8, v9, 4
    v_add_u32 v8, 128, v1
    v_mfma_f32_16x16x32_bf16 v[128:131], v[208:211], v[108:111], v[128:131]
    v_mul_u32_u24 v9, 205, v8
    v_lshrrev_b32 v9, 11, v9
    v_mfma_f32_16x16x32_bf16 v[132:135], v[212:215], v[108:111], v[132:135]
    v_add_u32 v10, v8, v9
    v_lshl_add_u32 v24, v10, 4, s7
    s_waitcnt lgkmcnt(0)
    v_mfma_f32_16x16x32_bf16 v[116:119], v[216:219], v[112:115], v[116:119]
    v_mul_u32_u24 v9, 150, v9
    v_add_lshl_u32 v28, v8, v9, 4
    v_mfma_f32_16x16x32_bf16 v[120:123], v[220:223], v[112:115], v[120:123]
    v_mfma_f32_16x16x32_bf16 v[124:127], v[224:227], v[112:115], v[124:127]
    v_mfma_f32_16x16x32_bf16 v[128:131], v[228:231], v[112:115], v[128:131]
    v_mfma_f32_16x16x32_bf16 v[132:135], v[232:235], v[112:115], v[132:135]
    s_lshl_b32 s7, s4, 2
    s_add_u32 s7, s7, s3
    s_mul_i32 s7, s7, 40960
    s_add_u32 s7, s7, s68
    s_mov_b32 s64, 800000
ls_76:
    ds_read_b32 v8, v13 offset:12
    s_sub_u32 s64, s64, 1
    s_cbranch_scc1 lsd_77
    s_waitcnt lgkmcnt(0)
    v_cmp_gt_u32 vcc, 4, v8
    s_cbranch_vccnz ls_76
lsd_77:
    v_cvt_pk_bf16_f32 v36, v116, v117
    v_cvt_pk_bf16_f32 v37, v118, v119
    v_cvt_pk_bf16_f32 v38, v120, v121
    v_cvt_pk_bf16_f32 v39, v122, v123
    v_cvt_pk_bf16_f32 v40, v124, v125
    v_cvt_pk_bf16_f32 v41, v126, v127
    v_cvt_pk_bf16_f32 v42, v128, v129
    v_cvt_pk_bf16_f32 v43, v130, v131
    v_cvt_pk_bf16_f32 v44, v132, v133
    v_cvt_pk_bf16_f32 v45, v134, v135
    ds_write_b64 v20, v[36:37] offset:0
    ds_write_b64 v20, v[38:39] offset:8
    ds_write_b64 v20, v[40:41] offset:16
    ds_write_b64 v20, v[42:43] offset:24
    ds_write_b64 v20, v[44:45] offset:32
    ds_read_b128 v[48:51], v22
    ds_read_b128 v[52:55], v23
    ds_read_b128 v[56:59], v24
    s_waitcnt lgkmcnt(2)
    buffer_store_dwordx4 v[48:51], v26, s[56:59], s7 offen
    s_waitcnt lgkmcnt(1)
    buffer_store_dwordx4 v[52:55], v27, s[56:59], s7 offen
    s_waitcnt lgkmcnt(0)
    s_mov_b32 exec_hi, 0
    buffer_store_dwordx4 v[56:59], v28, s[56:59], s7 offen
    s_endpgm
fl_39c:
    s_mov_b32 s64, 200000
    s_branch poll0_43
poll_41:
    s_sleep 2
poll0_43:
    buffer_load_dword v16, v15, s[52:55], 0 offen sc1
    s_sub_u32 s64, s64, 1
    s_cbranch_scc1 pdone_42
    s_waitcnt vmcnt(0)
    v_cmp_ne_u32 vcc, s6, v16
    s_cbranch_vccnz poll_41
pdone_42:
    s_branch fl_39
rnd_44:
    s_add_u32 s60, s60, 1
    s_cmp_lt_u32 s60, 12
    s_cbranch_scc1 ab_46
    s_bitcmp1_b32 s61, 4
    s_cbranch_scc1 bst_47
    s_bitset1_b32 s61, 4
    s_add_u32 s51, s65, 4194304
    buffer_store_dwordx4 v[236:239], v12, s[52:55], s51 offen offset:0 sc1
    buffer_store_dwordx4 v[240:243], v12, s[52:55], s51 offen offset:1024 sc1
    buffer_store_dwordx2 v[244:245], v246, s[52:55], s51 offen offset:2048 sc1
bst_47:
    s_xor_b32 s62, s62, 0xc00000
ab_46:
    s_waitcnt vmcnt(0)
    v_max3_u32 v8, v36, v37, v38
    v_max3_u32 v9, v39, v40, v41
    v_max3_u32 v8, v8, v42, v43
    v_max3_u32 v9, v9, v44, v45
    v_max3_u32 v8, v8, v46, v47
    v_max3_u32 v9, v9, v48, v49
    v_max3_u32 v8, v8, v50, v51
    v_max3_u32 v9, v9, v52, v53
    v_max3_u32 v8, v8, v54, v55
    v_max_u32 v8, v8, v9
    v_cmp_eq_u32 vcc, -1, v8
    s_cbranch_vccz ok_48
    s_add_u32 s51, s62, 0
    buffer_load_dwordx4 v[36:39], v12, s[52:55], s51 offen offset:0 sc1
    buffer_load_dwordx4 v[40:43], v12, s[52:55], s51 offen offset:1024 sc1
    buffer_load_dwordx2 v[52:53], v246, s[52:55], s51 offen offset:2048 sc1
    s_add_u32 s51, s62, 10240
    buffer_load_dwordx4 v[44:47], v12, s[52:55], s51 offen offset:0 sc1
    buffer_load_dwordx4 v[48:51], v12, s[52:55], s51 offen offset:1024 sc1
    buffer_load_dwordx2 v[54:55], v246, s[52:55], s51 offen offset:2048 sc1
    s_branch nx_49
ok_48:
    s_bitset1_b32 s61, 0
nx_49:
    s_bitcmp1_b32 s61, 0
    s_cbranch_scc1 go_45
    s_cmp_lt_u32 s60, 50000
    s_cbranch_scc1 rnd_44
    s_waitcnt vmcnt(0)
    s_branch go_45
rnd_50:
    s_add_u32 s60, s60, 1
    s_cmp_lt_u32 s60, 12
    s_cbranch_scc1 ab_52
    s_bitcmp1_b32 s61, 4
    s_cbranch_scc1 bst_53
    s_bitset1_b32 s61, 4
    s_add_u32 s51, s65, 4194304
    buffer_store_dwordx4 v[236:239], v12, s[52:55], s51 offen offset:0 sc1
    buffer_store_dwordx4 v[240:243], v12, s[52:55], s51 offen offset:1024 sc1
    buffer_store_dwordx2 v[244:245], v246, s[52:55], s51 offen offset:2048 sc1
bst_53:
    s_xor_b32 s62, s62, 0xc00000
ab_52:
    s_waitcnt vmcnt(0)
    v_max3_u32 v8, v56, v57, v58
    v_max3_u32 v9, v59, v60, v61
    v_max3_u32 v8, v8, v62, v63
    v_max3_u32 v9, v9, v64, v65
    v_max3_u32 v8, v8, v66, v67
    v_max3_u32 v9, v9, v68, v69
    v_max3_u32 v8, v8, v70, v71
    v_max3_u32 v9, v9, v72, v73
    v_max3_u32 v8, v8, v74, v75
    v_max_u32 v8, v8, v9
    v_cmp_eq_u32 vcc, -1, v8
    s_cbranch_vccz ok_54
    s_add_u32 s51, s62, 20480
    buffer_load_dwordx4 v[56:59], v12, s[52:55], s51 offen offset:0 sc1
    buffer_load_dwordx4 v[60:63], v12, s[52:55], s51 offen offset:1024 sc1
    buffer_load_dwordx2 v[72:73], v246, s[52:55], s51 offen offset:2048 sc1
    s_add_u32 s51, s62, 30720
    buffer_load_dwordx4 v[64:67], v12, s[52:55], s51 offen offset:0 sc1
    buffer_load_dwordx4 v[68:71], v12, s[52:55], s51 offen offset:1024 sc1
    buffer_load_dwordx2 v[74:75], v246, s[52:55], s51 offen offset:2048 sc1
    s_branch nx_55
ok_54:
    s_bitset1_b32 s61, 1
nx_55:
    s_bitcmp1_b32 s61, 2
    s_cbranch_scc1 nx_57
    v_max3_u32 v8, v76, v77, v78
    v_max3_u32 v9, v79, v80, v81
    v_max3_u32 v8, v8, v82, v83
    v_max3_u32 v9, v9, v84, v85
    v_max3_u32 v8, v8, v86, v87
    v_max3_u32 v9, v9, v88, v89
    v_max3_u32 v8, v8, v90, v91
    v_max3_u32 v9, v9, v92, v93
    v_max3_u32 v8, v8, v94, v95
    v_max_u32 v8, v8, v9
    v_cmp_eq_u32 vcc, -1, v8
    s_cbranch_vccz ok_56
    s_add_u32 s51, s62, 40960
    buffer_load_dwordx4 v[76:79], v12, s[52:55], s51 offen offset:0 sc1
    buffer_load_dwordx4 v[80:83], v12, s[52:55], s51 offen offset:1024 sc1
    buffer_load_dwordx2 v[92:93], v246, s[52:55], s51 offen offset:2048 sc1
    s_add_u32 s51, s62, 51200
    buffer_load_dwordx4 v[84:87], v12, s[52:55], s51 offen offset:0 sc1
    buffer_load_dwordx4 v[88:91], v12, s[52:55], s51 offen offset:1024 sc1
    buffer_load_dwordx2 v[94:95], v246, s[52:55], s51 offen offset:2048 sc1
    s_branch nx_57
ok_56:
    s_bitset1_b32 s61, 2
nx_57:
    s_bitcmp1_b32 s61, 3
    s_cbranch_scc1 nx_59
    v_max3_u32 v8, v96, v97, v98
    v_max3_u32 v9, v99, v100, v101
    v_max3_u32 v8, v8, v102, v103
    v_max3_u32 v9, v9, v104, v105
    v_max3_u32 v8, v8, v106, v107
    v_max3_u32 v9, v9, v108, v109
    v_max3_u32 v8, v8, v110, v111
    v_max3_u32 v9, v9, v112, v113
    v_max3_u32 v8, v8, v114, v115
    v_max_u32 v8, v8, v9
    v_cmp_eq_u32 vcc, -1, v8
    s_cbranch_vccz ok_58
    s_add_u32 s51, s62, 61440
    buffer_load_dwordx4 v[96:99], v12, s[52:55], s51 offen offset:0 sc1
    buffer_load_dwordx4 v[100:103], v12, s[52:55], s51 offen offset:1024 sc1
    buffer_load_dwordx2 v[112:113], v246, s[52:55], s51 offen offset:2048 sc1
    s_add_u32 s51, s62, 71680
    buffer_load_dwordx4 v[104:107], v12, s[52:55], s51 offen offset:0 sc1
    buffer_load_dwordx4 v[108:111], v12, s[52:55], s51 offen offset:1024 sc1
    buffer_load_dwordx2 v[114:115], v246, s[52:55], s51 offen offset:2048 sc1
    s_branch nx_59
ok_58:
    s_bitset1_b32 s61, 3
nx_59:
    s_bitcmp1_b32 s61, 1
    s_cbranch_scc1 go_51
    s_cmp_lt_u32 s60, 50000
    s_cbranch_scc1 rnd_50
    s_waitcnt vmcnt(0)
    s_branch go_51
rnd_62:
    s_add_u32 s60, s60, 1
    s_cmp_lt_u32 s60, 12
    s_cbranch_scc1 ab_64
    s_bitcmp1_b32 s61, 4
    s_cbranch_scc1 bst_65
    s_bitset1_b32 s61, 4
    s_add_u32 s51, s65, 4194304
    buffer_store_dwordx4 v[236:239], v12, s[52:55], s51 offen offset:0 sc1
    buffer_store_dwordx4 v[240:243], v12, s[52:55], s51 offen offset:1024 sc1
    buffer_store_dwordx2 v[244:245], v246, s[52:55], s51 offen offset:2048 sc1
bst_65:
    s_xor_b32 s62, s62, 0xc00000
ab_64:
    s_waitcnt vmcnt(0)
    v_max3_u32 v8, v76, v77, v78
    v_max3_u32 v9, v79, v80, v81
    v_max3_u32 v8, v8, v82, v83
    v_max3_u32 v9, v9, v84, v85
    v_max3_u32 v8, v8, v86, v87
    v_max3_u32 v9, v9, v88, v89
    v_max3_u32 v8, v8, v90, v91
    v_max3_u32 v9, v9, v92, v93
    v_max3_u32 v8, v8, v94, v95
    v_max_u32 v8, v8, v9
    v_cmp_eq_u32 vcc, -1, v8
    s_cbranch_vccz ok_66
    s_add_u32 s51, s62, 40960
    buffer_load_dwordx4 v[76:79], v12, s[52:55], s51 offen offset:0 sc1
    buffer_load_dwordx4 v[80:83], v12, s[52:55], s51 offen offset:1024 sc1
    buffer_load_dwordx2 v[92:93], v246, s[52:55], s51 offen offset:2048 sc1
    s_add_u32 s51, s62, 51200
    buffer_load_dwordx4 v[84:87], v12, s[52:55], s51 offen offset:0 sc1
    buffer_load_dwordx4 v[88:91], v12, s[52:55], s51 offen offset:1024 sc1
    buffer_load_dwordx2 v[94:95], v246, s[52:55], s51 offen offset:2048 sc1
    s_branch nx_67
ok_66:
    s_bitset1_b32 s61, 2
nx_67:
    s_bitcmp1_b32 s61, 3
    s_cbranch_scc1 nx_69
    v_max3_u32 v8, v96, v97, v98
    v_max3_u32 v9, v99, v100, v101
    v_max3_u32 v8, v8, v102, v103
    v_max3_u32 v9, v9, v104, v105
    v_max3_u32 v8, v8, v106, v107
    v_max3_u32 v9, v9, v108, v109
    v_max3_u32 v8, v8, v110, v111
    v_max3_u32 v9, v9, v112, v113
    v_max3_u32 v8, v8, v114, v115
    v_max_u32 v8, v8, v9
    v_cmp_eq_u32 vcc, -1, v8
    s_cbranch_vccz ok_68
    s_add_u32 s51, s62, 61440
    buffer_load_dwordx4 v[96:99], v12, s[52:55], s51 offen offset:0 sc1
    buffer_load_dwordx4 v[100:103], v12, s[52:55], s51 offen offset:1024 sc1
    buffer_load_dwordx2 v[112:113], v246, s[52:55], s51 offen offset:2048 sc1
    s_add_u32 s51, s62, 71680
    buffer_load_dwordx4 v[104:107], v12, s[52:55], s51 offen offset:0 sc1
    buffer_load_dwordx4 v[108:111], v12, s[52:55], s51 offen offset:1024 sc1
    buffer_load_dwordx2 v[114:115], v246, s[52:55], s51 offen offset:2048 sc1
    s_branch nx_69
ok_68:
    s_bitset1_b32 s61, 3
nx_69:
    s_bitcmp1_b32 s61, 2
    s_cbranch_scc1 go_63
    s_cmp_lt_u32 s60, 50000
    s_cbranch_scc1 rnd_62
    s_waitcnt vmcnt(0)
    s_branch go_63
rnd_70:
    s_add_u32 s60, s60, 1
    s_cmp_lt_u32 s60, 12
    s_cbranch_scc1 ab_72
    s_bitcmp1_b32 s61, 4
    s_cbranch_scc1 bst_73
    s_bitset1_b32 s61, 4
    s_add_u32 s51, s65, 4194304
    buffer_store_dwordx4 v[236:239], v12, s[52:55], s51 offen offset:0 sc1
    buffer_store_dwordx4 v[240:243], v12, s[52:55], s51 offen offset:1024 sc1
    buffer_store_dwordx2 v[244:245], v246, s[52:55], s51 offen offset:2048 sc1
bst_73:
    s_xor_b32 s62, s62, 0xc00000
ab_72:
    s_waitcnt vmcnt(0)
    v_max3_u32 v8, v96, v97, v98
    v_max3_u32 v9, v99, v100, v101
    v_max3_u32 v8, v8, v102, v103
    v_max3_u32 v9, v9, v104, v105
    v_max3_u32 v8, v8, v106, v107
    v_max3_u32 v9, v9, v108, v109
    v_max3_u32 v8, v8, v110, v111
    v_max3_u32 v9, v9, v112, v113
    v_max3_u32 v8, v8, v114, v115
    v_max_u32 v8, v8, v9
    v_cmp_eq_u32 vcc, -1, v8
    s_cbranch_vccz ok_74
    s_add_u32 s51, s62, 61440
    buffer_load_dwordx4 v[96:99], v12, s[52:55], s51 offen offset:0 sc1
    buffer_load_dwordx4 v[100:103], v12, s[52:55], s51 offen offset:1024 sc1
    buffer_load_dwordx2 v[112:113], v246, s[52:55], s51 offen offset:2048 sc1
    s_add_u32 s51, s62, 71680
    buffer_load_dwordx4 v[104:107], v12, s[52:55], s51 offen offset:0 sc1
    buffer_load_dwordx4 v[108:111], v12, s[52:55], s51 offen offset:1024 sc1
    buffer_load_dwordx2 v[114:115], v246, s[52:55], s51 offen offset:2048 sc1
    s_branch nx_75
ok_74:
    s_bitset1_b32 s61, 3
nx_75:
    s_bitcmp1_b32 s61, 3
    s_cbranch_scc1 go_71
    s_cmp_lt_u32 s60, 50000
    s_cbranch_scc1 rnd_70
    s_waitcnt vmcnt(0)
    s_branch go_71
spin_11:
    s_mov_b32 s64, 800000
ls_78:
    ds_read_b32 v8, v13 offset:8
    s_sub_u32 s64, s64, 1
    s_cbranch_scc1 lsd_79
    s_waitcnt lgkmcnt(0)
    v_cmp_gt_u32 vcc, 4, v8
    s_cbranch_vccnz ls_78
lsd_79:
    s_branch back_12
spin_13:
    s_mov_b32 s64, 800000
ls_80:
    ds_read_b32 v8, v13 offset:20
    s_sub_u32 s64, s64, 1
    s_cbranch_scc1 lsd_81
    s_waitcnt lgkmcnt(0)
    v_cmp_gt_u32 vcc, 4, v8
    s_cbranch_vccnz ls_80
lsd_81:
    s_branch back_14
spin_15:
    s_mov_b32 s64, 800000
ls_82:
    ds_read_b32 v8, v13 offset:24
    s_sub_u32 s64, s64, 1
    s_cbranch_scc1 lsd_83
    s_waitcnt lgkmcnt(0)
    v_cmp_gt_u32 vcc, 4, v8
    s_cbranch_vccnz ls_82
lsd_83:
    s_branch back_16
spin_19:
    s_mov_b32 s64, 800000
ls_84:
    ds_read_b32 v8, v13 offset:28
    s_sub_u32 s64, s64, 1
    s_cbranch_scc1 lsd_85
    s_waitcnt lgkmcnt(0)
    v_cmp_gt_u32 vcc, 4, v8
    s_cbranch_vccnz ls_84
lsd_85:
    s_branch back_20
spin_24:
    s_mov_b32 s64, 800000
ls_86:
    ds_read_b32 v8, v13 offset:8
    s_sub_u32 s64, s64, 1
    s_cbranch_scc1 lsd_87
    s_waitcnt lgkmcnt(0)
    v_cmp_gt_u32 vcc, 4, v8
    s_cbranch_vccnz ls_86
lsd_87:
    s_branch back_25
spin_26:
    s_mov_b32 s64, 800000
ls_88:
    ds_read_b32 v8, v13 offset:20
    s_sub_u32 s64, s64, 1
    s_cbranch_scc1 lsd_89
    s_waitcnt lgkmcnt(0)
    v_cmp_gt_u32 vcc, 4, v8
    s_cbranch_vccnz ls_88
lsd_89:
    s_branch back_27
spin_28:
    s_mov_b32 s64, 800000
ls_90:
    ds_read_b32 v8, v13 offset:24
    s_sub_u32 s64, s64, 1
    s_cbranch_scc1 lsd_91
    s_waitcnt lgkmcnt(0)
    v_cmp_gt_u32 vcc, 4, v8
    s_cbranch_vccnz ls_90
lsd_91:
    s_branch back_29
spin_30:
    s_mov_b32 s64, 800000
ls_92:
    ds_read_b32 v8, v13 offset:28
    s_sub_u32 s64, s64, 1
    s_cbranch_scc1 lsd_93
    s_waitcnt lgkmcnt(0)
    v_cmp_gt_u32 vcc, 4, v8
    s_cbranch_vccnz ls_92
lsd_93:
    s_branch back_31
L_slow:
    s_cmp_lg_u32 s60, 8
    s_cbranch_scc1 L_guard_ok
    s_waitcnt vmcnt(0) lgkmcnt(0)
    v_mov_b32 v242, 0xff800000
    v_mov_b32 v36, 0
    v_mov_b32 v204, 0
    v_mov_b32 v37, 0
    v_mov_b32 v205, 0
    v_mov_b32 v38, 0
    v_mov_b32 v206, 0
    v_mov_b32 v39, 0
    v_mov_b32 v207, 0
    v_mov_b32 v40, 0
    v_mov_b32 v208, 0
    v_mov_b32 v41, 0
    v_mov_b32 v209, 0
    v_mov_b32 v42, 0
    v_mov_b32 v210, 0
    v_mov_b32 v43, 0
    v_mov_b32 v211, 0
    v_mov_b32 v44, 0
    v_mov_b32 v212, 0
    v_mov_b32 v45, 0
    v_mov_b32 v213, 0
    v_mov_b32 v46, 0
    v_mov_b32 v214, 0
    v_mov_b32 v47, 0
    v_mov_b32 v215, 0
    v_mov_b32 v48, 0
    v_mov_b32 v216, 0
    v_mov_b32 v49, 0
    v_mov_b32 v217, 0
    v_mov_b32 v50, 0
    v_mov_b32 v218, 0
    v_mov_b32 v51, 0
    v_mov_b32 v219, 0
    v_mov_b32 v243, 0xff800000
    v_mov_b32 v52, 0
    v_mov_b32 v220, 0
    v_mov_b32 v53, 0
    v_mov_b32 v221, 0
    v_mov_b32 v54, 0
    v_mov_b32 v222, 0
    v_mov_b32 v55, 0
    v_mov_b32 v223, 0
    v_mov_b32 v56, 0
    v_mov_b32 v224, 0
    v_mov_b32 v57, 0
    v_mov_b32 v225, 0
    v_mov_b32 v58, 0
    v_mov_b32 v226, 0
    v_mov_b32 v59, 0
    v_mov_b32 v227, 0
    v_mov_b32 v60, 0
    v_mov_b32 v228, 0
    v_mov_b32 v61, 0
    v_mov_b32 v229, 0
    v_mov_b32 v62, 0
    v_mov_b32 v230, 0
    v_mov_b32 v63, 0
    v_mov_b32 v231, 0
    v_mov_b32 v64, 0
    v_mov_b32 v232, 0
    v_mov_b32 v65, 0
    v_mov_b32 v233, 0
    v_mov_b32 v66, 0
    v_mov_b32 v234, 0
    v_mov_b32 v67, 0
    v_mov_b32 v235, 0
    s_mov_b32 s61, 0
L_slow_pass:
    s_mov_b32 s60, 0
L_slow_it:
    s_lshr_b32 s7, s60, 2
    s_mul_i32 s7, s7, 21504
    s_bfe_u32 s50, s60, 0x10001
    s_mul_i32 s50, s50, 10496
    s_add_u32 s7, s7, s50
    s_add_u32 s7, s7, 131072
    s_and_b32 s50, s60, 1
    s_lshl_b32 s51, s50, 10
    s_add_u32 s51, s51, s7
    buffer_load_dwordx4 v[68:71], v240, s[52:55], s51 offen offset:0 sc1
    buffer_load_dwordx4 v[72:75], v240, s[52:55], s51 offen offset:2048 sc1
    s_lshl_b32 s51, s50, 3
    s_add_u32 s51, s51, s7
    s_add_u32 s51, s51, 4096
    buffer_load_dwordx2 v[76:77], v240, s[52:55], s51 offen sc1
    s_mul_i32 s51, s50, 1344
    s_add_u32 s51, s51, s7
    buffer_load_dwordx4 v[84:87], v241, s[52:55], s51 offen offset:0 sc1
    buffer_load_dwordx4 v[92:95], v241, s[52:55], s51 offen offset:672 sc1
    buffer_load_dwordx4 v[88:91], v241, s[52:55], s51 offen offset:2688 sc1
    buffer_load_dwordx4 v[236:239], v241, s[52:55], s51 offen offset:3360 sc1
    s_waitcnt vmcnt(0)
    v_mfma_f32_32x32x4_2b_bf16 v[140:171], v[76:77], v[28:29], v[36:67] cbsz:1 abid:0
    v_mfma_f32_32x32x4_2b_bf16 v[172:203], v[76:77], v[28:29], v[36:67] cbsz:1 abid:1
    s_nop 15
    s_nop 0
    v_mfma_f32_32x32x16_bf16 v[140:155], v[68:71], v[20:23], v[140:155]
    v_mfma_f32_32x32x16_bf16 v[156:171], v[68:71], v[24:27], v[156:171]
    v_mfma_f32_32x32x16_bf16 v[172:187], v[72:75], v[20:23], v[172:187]
    v_mfma_f32_32x32x16_bf16 v[188:203], v[72:75], v[24:27], v[188:203]
    s_nop 15
    s_cmp_eq_u32 s61, 1
    s_cbranch_scc1 L_slow_p2
    v_max3_f32 v242, v242, v140, v141
    v_max3_f32 v242, v242, v142, v143
    v_max3_f32 v242, v242, v144, v145
    v_max3_f32 v242, v242, v146, v147
    v_max3_f32 v242, v242, v148, v149
    v_max3_f32 v242, v242, v150, v151
    v_max3_f32 v242, v242, v152, v153
    v_max3_f32 v242, v242, v154, v155
    v_max3_f32 v243, v243, v156, v157
    v_max3_f32 v243, v243, v158, v159
    v_max3_f32 v243, v243, v160, v161
    v_max3_f32 v243, v243, v162, v163
    v_max3_f32 v243, v243, v164, v165
    v_max3_f32 v243, v243, v166, v167
    v_max3_f32 v243, v243, v168, v169
    v_max3_f32 v243, v243, v170, v171
    v_max3_f32 v242, v242, v172, v173
    v_max3_f32 v242, v242, v174, v175
    v_max3_f32 v242, v242, v176, v177
    v_max3_f32 v242, v242, v178, v179
    v_max3_f32 v242, v242, v180, v181
    v_max3_f32 v242, v242, v182, v183
    v_max3_f32 v242, v242, v184, v185
    v_max3_f32 v242, v242, v186, v187
    v_max3_f32 v243, v243, v188, v189
    v_max3_f32 v243, v243, v190, v191
    v_max3_f32 v243, v243, v192, v193
    v_max3_f32 v243, v243, v194, v195
    v_max3_f32 v243, v243, v196, v197
    v_max3_f32 v243, v243, v198, v199
    v_max3_f32 v243, v243, v200, v201
    v_max3_f32 v243, v243, v202, v203
    s_branch L_slow_nx
L_slow_p2:
    v_exp_f32 v140, v140
    v_exp_f32 v141, v141
    v_exp_f32 v142, v142
    v_exp_f32 v143, v143
    v_exp_f32 v144, v144
    v_exp_f32 v145, v145
    v_exp_f32 v146, v146
    v_exp_f32 v147, v147
    v_exp_f32 v148, v148
    v_exp_f32 v149, v149
    v_exp_f32 v150, v150
    v_exp_f32 v151, v151
    v_exp_f32 v152, v152
    v_exp_f32 v153, v153
    v_exp_f32 v154, v154
    v_exp_f32 v155, v155
    v_exp_f32 v156, v156
    v_exp_f32 v157, v157
    v_exp_f32 v158, v158
    v_exp_f32 v159, v159
    v_exp_f32 v160, v160
    v_exp_f32 v161, v161
    v_exp_f32 v162, v162
    v_exp_f32 v163, v163
    v_exp_f32 v164, v164
    v_exp_f32 v165, v165
    v_exp_f32 v166, v166
    v_exp_f32 v167, v167
    v_exp_f32 v168, v168
    v_exp_f32 v169, v169
    v_exp_f32 v170, v170
    v_exp_f32 v171, v171
    v_exp_f32 v172, v172
    v_exp_f32 v173, v173
    v_exp_f32 v174, v174
    v_exp_f32 v175, v175
    v_exp_f32 v176, v176
    v_exp_f32 v177, v177
    v_exp_f32 v178, v178
    v_exp_f32 v179, v179
    v_exp_f32 v180, v180
    v_exp_f32 v181, v181
    v_exp_f32 v182, v182
    v_exp_f32 v183, v183
    v_exp_f32 v184, v184
    v_exp_f32 v185, v185
    v_exp_f32 v186, v186
    v_exp_f32 v187, v187
    v_exp_f32 v188, v188
    v_exp_f32 v189, v189
    v_exp_f32 v190, v190
    v_exp_f32 v191, v191
    v_exp_f32 v192, v192
    v_exp_f32 v193, v193
    v_exp_f32 v194, v194
    v_exp_f32 v195, v195
    v_exp_f32 v196, v196
    v_exp_f32 v197, v197
    v_exp_f32 v198, v198
    v_exp_f32 v199, v199
    v_exp_f32 v200, v200
    v_exp_f32 v201, v201
    v_exp_f32 v202, v202
    v_exp_f32 v203, v203
    s_nop 1
    v_smfmac_f32_32x32x32_bf16 v[204:219], v[84:87], v[140:147], v244
    v_smfmac_f32_32x32x32_bf16 v[204:219], v[92:95], v[148:155], v244
    v_smfmac_f32_32x32x32_bf16 v[220:235], v[84:87], v[156:163], v244
    v_smfmac_f32_32x32x32_bf16 v[220:235], v[92:95], v[164:171], v244
    v_smfmac_f32_32x32x32_bf16 v[204:219], v[88:91], v[172:179], v244
    v_smfmac_f32_32x32x32_bf16 v[204:219], v[236:239], v[180:187], v244
    v_smfmac_f32_32x32x32_bf16 v[220:235], v[88:91], v[188:195], v244
    v_smfmac_f32_32x32x32_bf16 v[220:235], v[236:239], v[196:203], v244
    s_nop 15
L_slow_nx:
    s_add_u32 s60, s60, 1
    s_cmp_lt_u32 s60, 32
    s_cbranch_scc1 L_slow_it
    s_cmp_eq_u32 s61, 1
    s_cbranch_scc1 L_slow_ret
    v_mov_b32 v8, v242
    s_nop 1
    v_permlane32_swap_b32 v242, v8
    v_max_f32 v242, v242, v8
    v_sub_f32 v36, 0, v242
    v_sub_f32 v37, 0, v242
    v_sub_f32 v38, 0, v242
    v_sub_f32 v39, 0, v242
    v_sub_f32 v40, 0, v242
    v_sub_f32 v41, 0, v242
    v_sub_f32 v42, 0, v242
    v_sub_f32 v43, 0, v242
    v_sub_f32 v44, 0, v242
    v_sub_f32 v45, 0, v242
    v_sub_f32 v46, 0, v242
    v_sub_f32 v47, 0, v242
    v_sub_f32 v48, 0, v242
    v_sub_f32 v49, 0, v242
    v_sub_f32 v50, 0, v242
    v_sub_f32 v51, 0, v242
    v_mov_b32 v8, v243
    s_nop 1
    v_permlane32_swap_b32 v243, v8
    v_max_f32 v243, v243, v8
    v_sub_f32 v52, 0, v243
    v_sub_f32 v53, 0, v243
    v_sub_f32 v54, 0, v243
    v_sub_f32 v55, 0, v243
    v_sub_f32 v56, 0, v243
    v_sub_f32 v57, 0, v243
    v_sub_f32 v58, 0, v243
    v_sub_f32 v59, 0, v243
    v_sub_f32 v60, 0, v243
    v_sub_f32 v61, 0, v243
    v_sub_f32 v62, 0, v243
    v_sub_f32 v63, 0, v243
    v_sub_f32 v64, 0, v243
    v_sub_f32 v65, 0, v243
    v_sub_f32 v66, 0, v243
    v_sub_f32 v67, 0, v243
    s_mov_b32 s61, 1
    s_branch L_slow_pass
L_h_go:
    s_setprio 3
    s_load_dword s6, s[48:49], 0
    s_mov_b32 s52, s48
    s_and_b32 s53, s49, 0xffff
    s_mov_b32 s54, 0x1000000
    s_mov_b32 s55, 0x20000
    s_mov_b32 s12, s24
    s_and_b32 s13, s25, 0xffff
    s_mov_b32 s14, 0xc8000
    s_mov_b32 s15, 0x20000
    v_add_u32 v8, 0, v1
    v_mul_u32_u24 v9, 205, v8
    v_lshrrev_b32 v9, 11, v9
    v_mul_u32_u24 v10, 10, v9
    v_sub_u32 v8, v8, v10
    v_mul_u32_u24 v9, 80, v9
    v_add_u32 v8, v8, v9
    v_lshlrev_b32 v18, 4, v8
    v_add_u32 v8, 64, v1
    v_mul_u32_u24 v9, 205, v8
    v_lshrrev_b32 v9, 11, v9
    v_mul_u32_u24 v10, 10, v9
    v_sub_u32 v8, v8, v10
    v_mul_u32_u24 v9, 80, v9
    v_add_u32 v8, v8, v9
    v_subrev_u32 v8, 64, v8
    v_lshlrev_b32 v19, 4, v8
    v_add_u32 v8, 128, v1
    v_mul_u32_u24 v9, 205, v8
    v_lshrrev_b32 v9, 11, v9
    v_mul_u32_u24 v10, 10, v9
    v_sub_u32 v8, v8, v10
    v_mul_u32_u24 v9, 80, v9
    v_add_u32 v8, v8, v9
    v_subrev_u32 v8, 128, v8
    v_lshlrev_b32 v20, 4, v8
    v_add_u32 v8, 192, v1
    v_mul_u32_u24 v9, 205, v8
    v_lshrrev_b32 v9, 11, v9
    v_mul_u32_u24 v10, 10, v9
    v_sub_u32 v8, v8, v10
    v_mul_u32_u24 v9, 80, v9
    v_add_u32 v8, v8, v9
    v_subrev_u32 v8, 192, v8
    v_lshlrev_b32 v21, 4, v8
    v_add_u32 v8, 256, v1
    v_mul_u32_u24 v9, 205, v8
    v_lshrrev_b32 v9, 11, v9
    v_mul_u32_u24 v10, 10, v9
    v_sub_u32 v8, v8, v10
    v_mul_u32_u24 v9, 80, v9
    v_add_u32 v8, v8, v9
    v_lshlrev_b32 v22, 4, v8
    s_lshr_b32 s62, s4, 2
    s_add_u32 s62, s62, 1
    s_and_b32 s62, s62, 7
    s_mul_i32 s62, s62, 21504
    s_add_u32 s62, s62, 131072
    s_mov_b32 s63, 21504
    s_mul_i32 s7, s67, 3
    s_add_u32 s7, s7, 8
    s_mul_i32 s61, s7, 5120
    s_add_u32 s61, s61, 2048
    s_mul_i32 s68, s7, 40960
    s_mul_i32 s7, s5, 160
    s_add_u32 s68, s68, s7
    s_add_u32 s68, s68, 409600
    s_cmp_lt_i32 s66, 0
    s_cbranch_scc1 L_h_tr
    s_mul_i32 s7, s67, 8448
    s_add_u32 s7, s7, 103552
    v_lshlrev_b32 v32, 3, v1
    v_add_u32 v32, s7, v32
    v_add_u32 v33, 2112, v32
    v_add_u32 v34, 4224, v32
    v_add_u32 v35, 6336, v32
    v_and_b32 v12, 15, v1
    v_lshrrev_b32 v13, 4, v1
    v_mul_u32_u24 v14, 528, v12
    v_lshl_add_u32 v14, v13, 4, v14
    v_add_u32 v36, s7, v14
    s_mul_i32 s50, s67, 4608
    s_add_u32 s50, s50, 145408
    v_lshlrev_b32 v14, 4, v12
    v_and_b32 v15, 1, v13
    v_lshl_add_u32 v15, v15, 3, v14
    v_and_b32 v37, 32, v1
    v_lshl_add_u32 v15, v37, 4, v15
    s_add_u32 s51, s50, 3832
    v_sub_u32 v37, s51, v15
    v_lshlrev_b32 v15, 9, v13
    v_add_u32 v15, v15, v14
    s_mov_b32 exec_lo, 0
    s_mov_b32 exec_hi, 0xffff0000
    v_add_u32 v15, 512, v15
    s_mov_b64 exec, -1
    s_add_u32 s51, s50, 2288
    v_sub_u32 v38, s51, v15
    v_and_b32 v8, 7, v1
    v_bfe_u32 v9, v1, 4, 1
    v_lshl_add_u32 v8, v9, 3, v8
    v_bfe_u32 v10, v1, 3, 1
    v_lshrrev_b32 v11, 5, v1
    v_lshlrev_b32 v15, 5, v8
    v_lshl_add_u32 v15, v10, 9, v15
    s_add_u32 s51, s50, 992
    v_sub_u32 v39, s51, v15
    v_lshl_add_u32 v39, v11, 4, v39
    v_lshl_add_u32 v15, v11, 4, v15
    v_add_u32 v45, s50, v15
    s_mul_i32 s51, s67, 9216
    s_add_u32 s51, s51, 106816
    v_add_u32 v44, s51, v15
    v_and_b32 v15, 2, v1
    v_lshl_add_u32 v15, v10, 2, v15
    v_bfe_u32 v8, v1, 2, 1
    v_add_u32 v8, v8, v11
    v_lshl_add_u32 v15, v8, 3, v15
    v_mul_u32_u24 v9, 576, v9
    v_lshl_add_u32 v15, v15, 1, v9
    v_and_b32 v14, 1, v1
    v_mul_u32_u24 v40, 4576, v14
    s_mul_i32 s51, s67, 9216
    s_add_u32 s51, s51, 109060
    v_sub_u32 v40, s51, v40
    v_add_u32 v40, v40, v15
    v_add_u32 v41, 1152, v40
    v_add_u32 v42, 2304, v40
    v_add_u32 v43, 3456, v40
    v_mov_b32 v46, 0x5040706
    v_mov_b32 v47, 0x1000302
    v_mov_b32 v48, 0x5040504
    v_mov_b32 v49, 0x3020302
    v_mov_b32 v50, 0x1000302
    s_mov_b32 exec_lo, 0
    v_mov_b32 v46, 0x3020504
    v_mov_b32 v47, 0x1000100
    v_mov_b32 v48, 0x3020302
    v_mov_b32 v50, 0x1000100
    v_mul_u32_u24 v49, 0x101, v14
    v_lshlrev_b32 v49, 17, v49
    v_add_u32 v49, 0x1000302, v49
    v_add_u32 v51, 0x04040404, v49
    s_mov_b32 exec_lo, -1
    v_mov_b32 v8, 0
    v_mov_b32 v9, 0
    v_mov_b32 v10, 0
    v_mov_b32 v11, 0
    v_lshlrev_b32 v52, 3, v1
    v_add_u32 v52, s50, v52
    v_subrev_u32 v37, s50, v37
    v_bfe_u32 v12, v37, 4, 1
    v_mul_u32_u24 v12, 2304, v12
    v_lshrrev_b32 v13, 5, v37
    v_lshl_add_u32 v12, v13, 4, v12
    v_and_b32 v37, 15, v37
    v_add3_u32 v37, v37, v12, s50
    v_subrev_u32 v38, s50, v38
    v_bfe_u32 v12, v38, 4, 1
    v_mul_u32_u24 v12, 2304, v12
    v_lshrrev_b32 v13, 5, v38
    v_lshl_add_u32 v12, v13, 4, v12
    v_and_b32 v38, 15, v38
    v_add3_u32 v38, v38, v12, s50
    v_subrev_u32 v39, s50, v39
    v_bfe_u32 v12, v39, 4, 1
    v_mul_u32_u24 v12, 2304, v12
    v_lshrrev_b32 v13, 5, v39
    v_lshl_add_u32 v12, v13, 4, v12
    v_and_b32 v39, 15, v39
    v_add3_u32 v39, v39, v12, s50
    v_subrev_u32 v52, s50, v52
    v_bfe_u32 v12, v52, 4, 1
    v_mul_u32_u24 v12, 2304, v12
    v_lshrrev_b32 v13, 5, v52
    v_lshl_add_u32 v12, v13, 4, v12
    v_and_b32 v52, 15, v52
    v_add3_u32 v52, v52, v12, s50
    v_mov_b32 v244, 0x3f80
    v_mov_b32 v245, 0x3f80
    s_mov_b32 s7, 0x3fb8aa3b
    s_waitcnt vmcnt(5)
    v_lshlrev_b32 v13, 16, v30
    v_mul_f32 v14, 0x3fb8aa3b, v13
    v_fma_f32 v15, v13, s7, -v14
    v_fmac_f32 v15, 0x32a57060, v13
    v_exp_f32 v14, v14
    v_mul_f32 v15, 0x3f317218, v15
    v_fmac_f32 v14, v14, v15
    v_cvt_pk_bf16_f32 v12, v14, v14
    v_lshlrev_b32 v12, 16, v12
    v_lshlrev_b32 v86, 16, v24
    v_lshlrev_b32 v87, 16, v25
    v_and_b32 v88, 0xffff0000, v24
    v_and_b32 v89, 0xffff0000, v25
    v_mul_f32 v86, v12, v86
    v_mul_f32 v87, v12, v87
    v_mul_f32 v86, 0x3fb8aa3b, v86
    v_mul_f32 v87, 0x3e22f983, v87
    v_mul_f32 v88, v12, v88
    v_mul_f32 v89, v12, v89
    v_mul_f32 v88, 0x3fb8aa3b, v88
    v_mul_f32 v89, 0x3e22f983, v89
    v_mul_f32 v82, 0x41000000, v86
    v_mul_f32 v83, 0x41000000, v87
    v_exp_f32 v82, v82
    v_fract_f32 v83, v83
    v_mul_f32 v84, 0x41000000, v88
    v_mul_f32 v85, 0x41000000, v89
    v_exp_f32 v84, v84
    v_fract_f32 v85, v85
    v_cos_f32 v58, v83
    v_sin_f32 v59, v83
    v_cos_f32 v60, v85
    v_sin_f32 v61, v85
    v_pk_mul_f32 v[58:59], v[58:59], v[82:83] op_sel_hi:[1,0]
    v_pk_mul_f32 v[60:61], v[60:61], v[84:85] op_sel_hi:[1,0]
    v_cvt_pk_bf16_f32 v246, v58, v59
    v_cvt_pk_bf16_f32 v247, v60, v61
    ds_write2_b64 v32, v[244:245], v[246:247] offset0:0 offset1:66
    v_pk_mul_f32 v[74:75], v[58:59], v[58:59] op_sel:[0,0] op_sel_hi:[0,1]
    v_pk_mul_f32 v[76:77], v[60:61], v[60:61] op_sel:[0,0] op_sel_hi:[0,1]
    v_pk_fma_f32 v[74:75], v[58:59], v[58:59], v[74:75] op_sel:[1,1,0] op_sel_hi:[1,0,1] neg_lo:[0,1,0]
    v_pk_fma_f32 v[76:77], v[60:61], v[60:61], v[76:77] op_sel:[1,1,0] op_sel_hi:[1,0,1] neg_lo:[0,1,0]
    v_cvt_pk_bf16_f32 v248, v74, v75
    v_cvt_pk_bf16_f32 v249, v76, v77
    v_pk_mul_f32 v[78:79], v[74:75], v[58:59] op_sel:[0,0] op_sel_hi:[0,1]
    v_pk_mul_f32 v[80:81], v[76:77], v[60:61] op_sel:[0,0] op_sel_hi:[0,1]
    v_pk_fma_f32 v[78:79], v[74:75], v[58:59], v[78:79] op_sel:[1,1,0] op_sel_hi:[1,0,1] neg_lo:[0,1,0]
    v_pk_fma_f32 v[80:81], v[76:77], v[60:61], v[80:81] op_sel:[1,1,0] op_sel_hi:[1,0,1] neg_lo:[0,1,0]
    v_cvt_pk_bf16_f32 v250, v78, v79
    v_cvt_pk_bf16_f32 v251, v80, v81
    ds_write2_b64 v32, v[248:249], v[250:251] offset0:132 offset1:198
    v_pk_mul_f32 v[74:75], v[78:79], v[58:59] op_sel:[0,0] op_sel_hi:[0,1]
    v_pk_mul_f32 v[76:77], v[80:81], v[60:61] op_sel:[0,0] op_sel_hi:[0,1]
    v_pk_fma_f32 v[74:75], v[78:79], v[58:59], v[74:75] op_sel:[1,1,0] op_sel_hi:[1,0,1] neg_lo:[0,1,0]
    v_pk_fma_f32 v[76:77], v[80:81], v[60:61], v[76:77] op_sel:[1,1,0] op_sel_hi:[1,0,1] neg_lo:[0,1,0]
    v_cvt_pk_bf16_f32 v244, v74, v75
    v_cvt_pk_bf16_f32 v245, v76, v77
    v_pk_mul_f32 v[78:79], v[74:75], v[58:59] op_sel:[0,0] op_sel_hi:[0,1]
    v_pk_mul_f32 v[80:81], v[76:77], v[60:61] op_sel:[0,0] op_sel_hi:[0,1]
    v_pk_fma_f32 v[78:79], v[74:75], v[58:59], v[78:79] op_sel:[1,1,0] op_sel_hi:[1,0,1] neg_lo:[0,1,0]
    v_pk_fma_f32 v[80:81], v[76:77], v[60:61], v[80:81] op_sel:[1,1,0] op_sel_hi:[1,0,1] neg_lo:[0,1,0]
    v_cvt_pk_bf16_f32 v246, v78, v79
    v_cvt_pk_bf16_f32 v247, v80, v81
    ds_write2_b64 v33, v[244:245], v[246:247] offset0:0 offset1:66
    v_pk_mul_f32 v[74:75], v[78:79], v[58:59] op_sel:[0,0] op_sel_hi:[0,1]
    v_pk_mul_f32 v[76:77], v[80:81], v[60:61] op_sel:[0,0] op_sel_hi:[0,1]
    v_pk_fma_f32 v[74:75], v[78:79], v[58:59], v[74:75] op_sel:[1,1,0] op_sel_hi:[1,0,1] neg_lo:[0,1,0]
    v_pk_fma_f32 v[76:77], v[80:81], v[60:61], v[76:77] op_sel:[1,1,0] op_sel_hi:[1,0,1] neg_lo:[0,1,0]
    v_cvt_pk_bf16_f32 v248, v74, v75
    v_cvt_pk_bf16_f32 v249, v76, v77
    v_pk_mul_f32 v[78:79], v[74:75], v[58:59] op_sel:[0,0] op_sel_hi:[0,1]
    v_pk_mul_f32 v[80:81], v[76:77], v[60:61] op_sel:[0,0] op_sel_hi:[0,1]
    v_pk_fma_f32 v[78:79], v[74:75], v[58:59], v[78:79] op_sel:[1,1,0] op_sel_hi:[1,0,1] neg_lo:[0,1,0]
    v_pk_fma_f32 v[80:81], v[76:77], v[60:61], v[80:81] op_sel:[1,1,0] op_sel_hi:[1,0,1] neg_lo:[0,1,0]
    v_cvt_pk_bf16_f32 v250, v78, v79
    v_cvt_pk_bf16_f32 v251, v80, v81
    ds_write2_b64 v33, v[248:249], v[250:251] offset0:132 offset1:198
    v_pk_mul_f32 v[74:75], v[78:79], v[58:59] op_sel:[0,0] op_sel_hi:[0,1]
    v_pk_mul_f32 v[76:77], v[80:81], v[60:61] op_sel:[0,0] op_sel_hi:[0,1]
    v_pk_fma_f32 v[74:75], v[78:79], v[58:59], v[74:75] op_sel:[1,1,0] op_sel_hi:[1,0,1] neg_lo:[0,1,0]
    v_pk_fma_f32 v[76:77], v[80:81], v[60:61], v[76:77] op_sel:[1,1,0] op_sel_hi:[1,0,1] neg_lo:[0,1,0]
    v_cvt_pk_bf16_f32 v244, v74, v75
    v_cvt_pk_bf16_f32 v245, v76, v77
    v_pk_mul_f32 v[78:79], v[74:75], v[58:59] op_sel:[0,0] op_sel_hi:[0,1]
    v_pk_mul_f32 v[80:81], v[76:77], v[60:61] op_sel:[0,0] op_sel_hi:[0,1]
    v_pk_fma_f32 v[78:79], v[74:75], v[58:59], v[78:79] op_sel:[1,1,0] op_sel_hi:[1,0,1] neg_lo:[0,1,0]
    v_pk_fma_f32 v[80:81], v[76:77], v[60:61], v[80:81] op_sel:[1,1,0] op_sel_hi:[1,0,1] neg_lo:[0,1,0]
    v_cvt_pk_bf16_f32 v246, v78, v79
    v_cvt_pk_bf16_f32 v247, v80, v81
    ds_write2_b64 v34, v[244:245], v[246:247] offset0:0 offset1:66
    v_pk_mul_f32 v[74:75], v[78:79], v[58:59] op_sel:[0,0] op_sel_hi:[0,1]
    v_pk_mul_f32 v[76:77], v[80:81], v[60:61] op_sel:[0,0] op_sel_hi:[0,1]
    v_pk_fma_f32 v[74:75], v[78:79], v[58:59], v[74:75] op_sel:[1,1,0] op_sel_hi:[1,0,1] neg_lo:[0,1,0]
    v_pk_fma_f32 v[76:77], v[80:81], v[60:61], v[76:77] op_sel:[1,1,0] op_sel_hi:[1,0,1] neg_lo:[0,1,0]
    v_cvt_pk_bf16_f32 v248, v74, v75
    v_cvt_pk_bf16_f32 v249, v76, v77
    v_pk_mul_f32 v[78:79], v[74:75], v[58:59] op_sel:[0,0] op_sel_hi:[0,1]
    v_pk_mul_f32 v[80:81], v[76:77], v[60:61] op_sel:[0,0] op_sel_hi:[0,1]
    v_pk_fma_f32 v[78:79], v[74:75], v[58:59], v[78:79] op_sel:[1,1,0] op_sel_hi:[1,0,1] neg_lo:[0,1,0]
    v_pk_fma_f32 v[80:81], v[76:77], v[60:61], v[80:81] op_sel:[1,1,0] op_sel_hi:[1,0,1] neg_lo:[0,1,0]
    v_cvt_pk_bf16_f32 v250, v78, v79
    v_cvt_pk_bf16_f32 v251, v80, v81
    ds_write2_b64 v34, v[248:249], v[250:251] offset0:132 offset1:198
    v_pk_mul_f32 v[74:75], v[78:79], v[58:59] op_sel:[0,0] op_sel_hi:[0,1]
    v_pk_mul_f32 v[76:77], v[80:81], v[60:61] op_sel:[0,0] op_sel_hi:[0,1]
    v_pk_fma_f32 v[74:75], v[78:79], v[58:59], v[74:75] op_sel:[1,1,0] op_sel_hi:[1,0,1] neg_lo:[0,1,0]
    v_pk_fma_f32 v[76:77], v[80:81], v[60:61], v[76:77] op_sel:[1,1,0] op_sel_hi:[1,0,1] neg_lo:[0,1,0]
    v_cvt_pk_bf16_f32 v244, v74, v75
    v_cvt_pk_bf16_f32 v245, v76, v77
    v_pk_mul_f32 v[78:79], v[74:75], v[58:59] op_sel:[0,0] op_sel_hi:[0,1]
    v_pk_mul_f32 v[80:81], v[76:77], v[60:61] op_sel:[0,0] op_sel_hi:[0,1]
    v_pk_fma_f32 v[78:79], v[74:75], v[58:59], v[78:79] op_sel:[1,1,0] op_sel_hi:[1,0,1] neg_lo:[0,1,0]
    v_pk_fma_f32 v[80:81], v[76:77], v[60:61], v[80:81] op_sel:[1,1,0] op_sel_hi:[1,0,1] neg_lo:[0,1,0]
    v_cvt_pk_bf16_f32 v246, v78, v79
    v_cvt_pk_bf16_f32 v247, v80, v81
    ds_write2_b64 v35, v[244:245], v[246:247] offset0:0 offset1:66
    v_pk_mul_f32 v[74:75], v[78:79], v[58:59] op_sel:[0,0] op_sel_hi:[0,1]
    v_pk_mul_f32 v[76:77], v[80:81], v[60:61] op_sel:[0,0] op_sel_hi:[0,1]
    v_pk_fma_f32 v[74:75], v[78:79], v[58:59], v[74:75] op_sel:[1,1,0] op_sel_hi:[1,0,1] neg_lo:[0,1,0]
    v_pk_fma_f32 v[76:77], v[80:81], v[60:61], v[76:77] op_sel:[1,1,0] op_sel_hi:[1,0,1] neg_lo:[0,1,0]
    v_cvt_pk_bf16_f32 v248, v74, v75
    v_cvt_pk_bf16_f32 v249, v76, v77
    v_pk_mul_f32 v[78:79], v[74:75], v[58:59] op_sel:[0,0] op_sel_hi:[0,1]
    v_pk_mul_f32 v[80:81], v[76:77], v[60:61] op_sel:[0,0] op_sel_hi:[0,1]
    v_pk_fma_f32 v[78:79], v[74:75], v[58:59], v[78:79] op_sel:[1,1,0] op_sel_hi:[1,0,1] neg_lo:[0,1,0]
    v_pk_fma_f32 v[80:81], v[76:77], v[60:61], v[80:81] op_sel:[1,1,0] op_sel_hi:[1,0,1] neg_lo:[0,1,0]
    v_cvt_pk_bf16_f32 v250, v78, v79
    v_cvt_pk_bf16_f32 v251, v80, v81
    ds_write2_b64 v35, v[248:249], v[250:251] offset0:132 offset1:198
    ds_read_b128 v[100:103], v36 offset:0
    ds_read_b128 v[104:107], v36 offset:64
    ds_read_b128 v[108:111], v36 offset:128
    ds_read_b128 v[112:115], v36 offset:192
    ds_read_b128 v[116:119], v36 offset:256
    ds_read_b128 v[120:123], v36 offset:320
    ds_read_b128 v[124:127], v36 offset:384
    ds_read_b128 v[128:131], v36 offset:448
    v_pk_mul_f32 v[74:75], v[78:79], v[58:59] op_sel:[0,0] op_sel_hi:[0,1]
    v_pk_mul_f32 v[76:77], v[80:81], v[60:61] op_sel:[0,0] op_sel_hi:[0,1]
    v_pk_fma_f32 v[74:75], v[78:79], v[58:59], v[74:75] op_sel:[1,1,0] op_sel_hi:[1,0,1] neg_lo:[0,1,0]
    v_pk_fma_f32 v[76:77], v[80:81], v[60:61], v[76:77] op_sel:[1,1,0] op_sel_hi:[1,0,1] neg_lo:[0,1,0]
    v_cvt_pk_bf16_f32 v244, v74, v75
    v_cvt_pk_bf16_f32 v245, v76, v77
    v_pk_mul_f32 v[78:79], v[74:75], v[58:59] op_sel:[0,0] op_sel_hi:[0,1]
    v_pk_mul_f32 v[80:81], v[76:77], v[60:61] op_sel:[0,0] op_sel_hi:[0,1]
    v_pk_fma_f32 v[78:79], v[74:75], v[58:59], v[78:79] op_sel:[1,1,0] op_sel_hi:[1,0,1] neg_lo:[0,1,0]
    v_pk_fma_f32 v[80:81], v[76:77], v[60:61], v[80:81] op_sel:[1,1,0] op_sel_hi:[1,0,1] neg_lo:[0,1,0]
    v_cvt_pk_bf16_f32 v246, v78, v79
    v_cvt_pk_bf16_f32 v247, v80, v81
    ds_write2_b64 v32, v[244:245], v[246:247] offset0:0 offset1:66
    v_pk_mul_f32 v[74:75], v[78:79], v[58:59] op_sel:[0,0] op_sel_hi:[0,1]
    v_pk_mul_f32 v[76:77], v[80:81], v[60:61] op_sel:[0,0] op_sel_hi:[0,1]
    v_pk_fma_f32 v[74:75], v[78:79], v[58:59], v[74:75] op_sel:[1,1,0] op_sel_hi:[1,0,1] neg_lo:[0,1,0]
    v_pk_fma_f32 v[76:77], v[80:81], v[60:61], v[76:77] op_sel:[1,1,0] op_sel_hi:[1,0,1] neg_lo:[0,1,0]
    v_cvt_pk_bf16_f32 v248, v74, v75
    v_cvt_pk_bf16_f32 v249, v76, v77
    v_pk_mul_f32 v[78:79], v[74:75], v[58:59] op_sel:[0,0] op_sel_hi:[0,1]
    v_pk_mul_f32 v[80:81], v[76:77], v[60:61] op_sel:[0,0] op_sel_hi:[0,1]
    v_pk_fma_f32 v[78:79], v[74:75], v[58:59], v[78:79] op_sel:[1,1,0] op_sel_hi:[1,0,1] neg_lo:[0,1,0]
    v_pk_fma_f32 v[80:81], v[76:77], v[60:61], v[80:81] op_sel:[1,1,0] op_sel_hi:[1,0,1] neg_lo:[0,1,0]
    v_cvt_pk_bf16_f32 v250, v78, v79
    v_cvt_pk_bf16_f32 v251, v80, v81
    ds_write2_b64 v32, v[248:249], v[250:251] offset0:132 offset1:198
    v_pk_mul_f32 v[74:75], v[78:79], v[58:59] op_sel:[0,0] op_sel_hi:[0,1]
    v_pk_mul_f32 v[76:77], v[80:81], v[60:61] op_sel:[0,0] op_sel_hi:[0,1]
    v_pk_fma_f32 v[74:75], v[78:79], v[58:59], v[74:75] op_sel:[1,1,0] op_sel_hi:[1,0,1] neg_lo:[0,1,0]
    v_pk_fma_f32 v[76:77], v[80:81], v[60:61], v[76:77] op_sel:[1,1,0] op_sel_hi:[1,0,1] neg_lo:[0,1,0]
    v_cvt_pk_bf16_f32 v244, v74, v75
    v_cvt_pk_bf16_f32 v245, v76, v77
    v_pk_mul_f32 v[78:79], v[74:75], v[58:59] op_sel:[0,0] op_sel_hi:[0,1]
    v_pk_mul_f32 v[80:81], v[76:77], v[60:61] op_sel:[0,0] op_sel_hi:[0,1]
    v_pk_fma_f32 v[78:79], v[74:75], v[58:59], v[78:79] op_sel:[1,1,0] op_sel_hi:[1,0,1] neg_lo:[0,1,0]
    v_pk_fma_f32 v[80:81], v[76:77], v[60:61], v[80:81] op_sel:[1,1,0] op_sel_hi:[1,0,1] neg_lo:[0,1,0]
    v_cvt_pk_bf16_f32 v246, v78, v79
    v_cvt_pk_bf16_f32 v247, v80, v81
    ds_write2_b64 v33, v[244:245], v[246:247] offset0:0 offset1:66
    v_pk_mul_f32 v[74:75], v[78:79], v[58:59] op_sel:[0,0] op_sel_hi:[0,1]
    v_pk_mul_f32 v[76:77], v[80:81], v[60:61] op_sel:[0,0] op_sel_hi:[0,1]
    v_pk_fma_f32 v[74:75], v[78:79], v[58:59], v[74:75] op_sel:[1,1,0] op_sel_hi:[1,0,1] neg_lo:[0,1,0]
    v_pk_fma_f32 v[76:77], v[80:81], v[60:61], v[76:77] op_sel:[1,1,0] op_sel_hi:[1,0,1] neg_lo:[0,1,0]
    v_cvt_pk_bf16_f32 v248, v74, v75
    v_cvt_pk_bf16_f32 v249, v76, v77
    v_pk_mul_f32 v[78:79], v[74:75], v[58:59] op_sel:[0,0] op_sel_hi:[0,1]
    v_pk_mul_f32 v[80:81], v[76:77], v[60:61] op_sel:[0,0] op_sel_hi:[0,1]
    v_pk_fma_f32 v[78:79], v[74:75], v[58:59], v[78:79] op_sel:[1,1,0] op_sel_hi:[1,0,1] neg_lo:[0,1,0]
    v_pk_fma_f32 v[80:81], v[76:77], v[60:61], v[80:81] op_sel:[1,1,0] op_sel_hi:[1,0,1] neg_lo:[0,1,0]
    v_cvt_pk_bf16_f32 v250, v78, v79
    v_cvt_pk_bf16_f32 v251, v80, v81
    ds_write2_b64 v33, v[248:249], v[250:251] offset0:132 offset1:198
    v_pk_mul_f32 v[74:75], v[78:79], v[58:59] op_sel:[0,0] op_sel_hi:[0,1]
    v_pk_mul_f32 v[76:77], v[80:81], v[60:61] op_sel:[0,0] op_sel_hi:[0,1]
    v_pk_fma_f32 v[74:75], v[78:79], v[58:59], v[74:75] op_sel:[1,1,0] op_sel_hi:[1,0,1] neg_lo:[0,1,0]
    v_pk_fma_f32 v[76:77], v[80:81], v[60:61], v[76:77] op_sel:[1,1,0] op_sel_hi:[1,0,1] neg_lo:[0,1,0]
    v_cvt_pk_bf16_f32 v244, v74, v75
    v_cvt_pk_bf16_f32 v245, v76, v77
    v_pk_mul_f32 v[78:79], v[74:75], v[58:59] op_sel:[0,0] op_sel_hi:[0,1]
    v_pk_mul_f32 v[80:81], v[76:77], v[60:61] op_sel:[0,0] op_sel_hi:[0,1]
    v_pk_fma_f32 v[78:79], v[74:75], v[58:59], v[78:79] op_sel:[1,1,0] op_sel_hi:[1,0,1] neg_lo:[0,1,0]
    v_pk_fma_f32 v[80:81], v[76:77], v[60:61], v[80:81] op_sel:[1,1,0] op_sel_hi:[1,0,1] neg_lo:[0,1,0]
    v_cvt_pk_bf16_f32 v246, v78, v79
    v_cvt_pk_bf16_f32 v247, v80, v81
    ds_write2_b64 v34, v[244:245], v[246:247] offset0:0 offset1:66
    v_pk_mul_f32 v[74:75], v[78:79], v[58:59] op_sel:[0,0] op_sel_hi:[0,1]
    v_pk_mul_f32 v[76:77], v[80:81], v[60:61] op_sel:[0,0] op_sel_hi:[0,1]
    v_pk_fma_f32 v[74:75], v[78:79], v[58:59], v[74:75] op_sel:[1,1,0] op_sel_hi:[1,0,1] neg_lo:[0,1,0]
    v_pk_fma_f32 v[76:77], v[80:81], v[60:61], v[76:77] op_sel:[1,1,0] op_sel_hi:[1,0,1] neg_lo:[0,1,0]
    v_cvt_pk_bf16_f32 v248, v74, v75
    v_cvt_pk_bf16_f32 v249, v76, v77
    v_pk_mul_f32 v[78:79], v[74:75], v[58:59] op_sel:[0,0] op_sel_hi:[0,1]
    v_pk_mul_f32 v[80:81], v[76:77], v[60:61] op_sel:[0,0] op_sel_hi:[0,1]
    v_pk_fma_f32 v[78:79], v[74:75], v[58:59], v[78:79] op_sel:[1,1,0] op_sel_hi:[1,0,1] neg_lo:[0,1,0]
    v_pk_fma_f32 v[80:81], v[76:77], v[60:61], v[80:81] op_sel:[1,1,0] op_sel_hi:[1,0,1] neg_lo:[0,1,0]
    v_cvt_pk_bf16_f32 v250, v78, v79
    v_cvt_pk_bf16_f32 v251, v80, v81
    ds_write2_b64 v34, v[248:249], v[250:251] offset0:132 offset1:198
    v_pk_mul_f32 v[74:75], v[78:79], v[58:59] op_sel:[0,0] op_sel_hi:[0,1]
    v_pk_mul_f32 v[76:77], v[80:81], v[60:61] op_sel:[0,0] op_sel_hi:[0,1]
    v_pk_fma_f32 v[74:75], v[78:79], v[58:59], v[74:75] op_sel:[1,1,0] op_sel_hi:[1,0,1] neg_lo:[0,1,0]
    v_pk_fma_f32 v[76:77], v[80:81], v[60:61], v[76:77] op_sel:[1,1,0] op_sel_hi:[1,0,1] neg_lo:[0,1,0]
    v_cvt_pk_bf16_f32 v244, v74, v75
    v_cvt_pk_bf16_f32 v245, v76, v77
    v_pk_mul_f32 v[78:79], v[74:75], v[58:59] op_sel:[0,0] op_sel_hi:[0,1]
    v_pk_mul_f32 v[80:81], v[76:77], v[60:61] op_sel:[0,0] op_sel_hi:[0,1]
    v_pk_fma_f32 v[78:79], v[74:75], v[58:59], v[78:79] op_sel:[1,1,0] op_sel_hi:[1,0,1] neg_lo:[0,1,0]
    v_pk_fma_f32 v[80:81], v[76:77], v[60:61], v[80:81] op_sel:[1,1,0] op_sel_hi:[1,0,1] neg_lo:[0,1,0]
    v_cvt_pk_bf16_f32 v246, v78, v79
    v_cvt_pk_bf16_f32 v247, v80, v81
    ds_write2_b64 v35, v[244:245], v[246:247] offset0:0 offset1:66
    v_pk_mul_f32 v[74:75], v[78:79], v[58:59] op_sel:[0,0] op_sel_hi:[0,1]
    v_pk_mul_f32 v[76:77], v[80:81], v[60:61] op_sel:[0,0] op_sel_hi:[0,1]
    v_pk_fma_f32 v[74:75], v[78:79], v[58:59], v[74:75] op_sel:[1,1,0] op_sel_hi:[1,0,1] neg_lo:[0,1,0]
    v_pk_fma_f32 v[76:77], v[80:81], v[60:61], v[76:77] op_sel:[1,1,0] op_sel_hi:[1,0,1] neg_lo:[0,1,0]
    v_cvt_pk_bf16_f32 v248, v74, v75
    v_cvt_pk_bf16_f32 v249, v76, v77
    v_pk_mul_f32 v[78:79], v[74:75], v[58:59] op_sel:[0,0] op_sel_hi:[0,1]
    v_pk_mul_f32 v[80:81], v[76:77], v[60:61] op_sel:[0,0] op_sel_hi:[0,1]
    v_pk_fma_f32 v[78:79], v[74:75], v[58:59], v[78:79] op_sel:[1,1,0] op_sel_hi:[1,0,1] neg_lo:[0,1,0]
    v_pk_fma_f32 v[80:81], v[76:77], v[60:61], v[80:81] op_sel:[1,1,0] op_sel_hi:[1,0,1] neg_lo:[0,1,0]
    v_cvt_pk_bf16_f32 v250, v78, v79
    v_cvt_pk_bf16_f32 v251, v80, v81
    ds_write2_b64 v35, v[248:249], v[250:251] offset0:132 offset1:198
    s_setprio 0
    ds_read_b128 v[132:135], v36 offset:0
    ds_read_b128 v[136:139], v36 offset:64
    ds_read_b128 v[140:143], v36 offset:128
    ds_read_b128 v[144:147], v36 offset:192
    ds_read_b128 v[148:151], v36 offset:256
    ds_read_b128 v[152:155], v36 offset:320
    ds_read_b128 v[156:159], v36 offset:384
    ds_read_b128 v[160:163], v36 offset:448
    v_pk_mul_f32 v[62:63], v[78:79], v[58:59] op_sel:[0,0] op_sel_hi:[0,1]
    v_pk_mul_f32 v[64:65], v[80:81], v[60:61] op_sel:[0,0] op_sel_hi:[0,1]
    v_pk_fma_f32 v[62:63], v[78:79], v[58:59], v[62:63] op_sel:[1,1,0] op_sel_hi:[1,0,1] neg_lo:[0,1,0]
    v_pk_fma_f32 v[64:65], v[80:81], v[60:61], v[64:65] op_sel:[1,1,0] op_sel_hi:[1,0,1] neg_lo:[0,1,0]
    v_exp_f32 v82, v86
    v_fract_f32 v83, v87
    v_exp_f32 v84, v88
    v_fract_f32 v85, v89
    v_cos_f32 v54, v83
    v_sin_f32 v55, v83
    v_cos_f32 v56, v85
    v_sin_f32 v57, v85
    v_pk_mul_f32 v[54:55], v[54:55], v[82:83] op_sel_hi:[1,0]
    v_pk_mul_f32 v[56:57], v[56:57], v[84:85] op_sel_hi:[1,0]
    s_waitcnt vmcnt(0)
    v_lshlrev_b32 v90, 16, v26
    v_lshlrev_b32 v94, 16, v28
    v_lshlrev_b32 v91, 16, v27
    v_lshlrev_b32 v95, 16, v29
    v_and_b32 v92, 0xffff0000, v26
    v_and_b32 v96, 0xffff0000, v28
    v_and_b32 v93, 0xffff0000, v27
    v_and_b32 v97, 0xffff0000, v29
    v_pk_mul_f32 v[90:91], v[90:91], v[12:13] op_sel_hi:[1,0]
    v_pk_mul_f32 v[92:93], v[92:93], v[12:13] op_sel_hi:[1,0]
    v_pk_mul_f32 v[66:67], v[94:95], v[90:91] op_sel:[0,0] op_sel_hi:[0,1]
    v_pk_mul_f32 v[68:69], v[96:97], v[92:93] op_sel:[0,0] op_sel_hi:[0,1]
    v_pk_fma_f32 v[66:67], v[94:95], v[90:91], v[66:67] op_sel:[1,1,0] op_sel_hi:[1,0,1] neg_lo:[0,1,0]
    v_pk_fma_f32 v[68:69], v[96:97], v[92:93], v[68:69] op_sel:[1,1,0] op_sel_hi:[1,0,1] neg_lo:[0,1,0]
    v_cvt_pk_bf16_f32 v244, v66, -v67
    v_cvt_pk_bf16_f32 v245, v68, -v69
    v_pk_mul_f32 v[78:79], v[66:67], v[54:55] op_sel:[0,0] op_sel_hi:[0,1]
    v_pk_mul_f32 v[80:81], v[68:69], v[56:57] op_sel:[0,0] op_sel_hi:[0,1]
    v_pk_fma_f32 v[78:79], v[66:67], v[54:55], v[78:79] op_sel:[1,1,0] op_sel_hi:[1,0,1] neg_lo:[0,1,0]
    v_pk_fma_f32 v[80:81], v[68:69], v[56:57], v[80:81] op_sel:[1,1,0] op_sel_hi:[1,0,1] neg_lo:[0,1,0]
    v_cvt_pk_bf16_f32 v246, v78, -v79
    v_cvt_pk_bf16_f32 v247, v80, -v81
    ds_write2_b64 v32, v[244:245], v[246:247] offset0:0 offset1:66
    v_pk_mul_f32 v[74:75], v[78:79], v[54:55] op_sel:[0,0] op_sel_hi:[0,1]
    v_pk_mul_f32 v[76:77], v[80:81], v[56:57] op_sel:[0,0] op_sel_hi:[0,1]
    v_pk_fma_f32 v[74:75], v[78:79], v[54:55], v[74:75] op_sel:[1,1,0] op_sel_hi:[1,0,1] neg_lo:[0,1,0]
    v_pk_fma_f32 v[76:77], v[80:81], v[56:57], v[76:77] op_sel:[1,1,0] op_sel_hi:[1,0,1] neg_lo:[0,1,0]
    v_cvt_pk_bf16_f32 v248, v74, -v75
    v_cvt_pk_bf16_f32 v249, v76, -v77
    v_pk_mul_f32 v[78:79], v[74:75], v[54:55] op_sel:[0,0] op_sel_hi:[0,1]
    v_pk_mul_f32 v[80:81], v[76:77], v[56:57] op_sel:[0,0] op_sel_hi:[0,1]
    v_pk_fma_f32 v[78:79], v[74:75], v[54:55], v[78:79] op_sel:[1,1,0] op_sel_hi:[1,0,1] neg_lo:[0,1,0]
    v_pk_fma_f32 v[80:81], v[76:77], v[56:57], v[80:81] op_sel:[1,1,0] op_sel_hi:[1,0,1] neg_lo:[0,1,0]
    v_cvt_pk_bf16_f32 v250, v78, -v79
    v_cvt_pk_bf16_f32 v251, v80, -v81
    ds_write2_b64 v32, v[248:249], v[250:251] offset0:132 offset1:198
    v_pk_mul_f32 v[74:75], v[78:79], v[54:55] op_sel:[0,0] op_sel_hi:[0,1]
    v_pk_mul_f32 v[76:77], v[80:81], v[56:57] op_sel:[0,0] op_sel_hi:[0,1]
    v_pk_fma_f32 v[74:75], v[78:79], v[54:55], v[74:75] op_sel:[1,1,0] op_sel_hi:[1,0,1] neg_lo:[0,1,0]
    v_pk_fma_f32 v[76:77], v[80:81], v[56:57], v[76:77] op_sel:[1,1,0] op_sel_hi:[1,0,1] neg_lo:[0,1,0]
    v_cvt_pk_bf16_f32 v244, v74, -v75
    v_cvt_pk_bf16_f32 v245, v76, -v77
    v_pk_mul_f32 v[78:79], v[74:75], v[54:55] op_sel:[0,0] op_sel_hi:[0,1]
    v_pk_mul_f32 v[80:81], v[76:77], v[56:57] op_sel:[0,0] op_sel_hi:[0,1]
    v_pk_fma_f32 v[78:79], v[74:75], v[54:55], v[78:79] op_sel:[1,1,0] op_sel_hi:[1,0,1] neg_lo:[0,1,0]
    v_pk_fma_f32 v[80:81], v[76:77], v[56:57], v[80:81] op_sel:[1,1,0] op_sel_hi:[1,0,1] neg_lo:[0,1,0]
    v_cvt_pk_bf16_f32 v246, v78, -v79
    v_cvt_pk_bf16_f32 v247, v80, -v81
    ds_write2_b64 v33, v[244:245], v[246:247] offset0:0 offset1:66
    v_pk_mul_f32 v[74:75], v[78:79], v[54:55] op_sel:[0,0] op_sel_hi:[0,1]
    v_pk_mul_f32 v[76:77], v[80:81], v[56:57] op_sel:[0,0] op_sel_hi:[0,1]
    v_pk_fma_f32 v[74:75], v[78:79], v[54:55], v[74:75] op_sel:[1,1,0] op_sel_hi:[1,0,1] neg_lo:[0,1,0]
    v_pk_fma_f32 v[76:77], v[80:81], v[56:57], v[76:77] op_sel:[1,1,0] op_sel_hi:[1,0,1] neg_lo:[0,1,0]
    v_cvt_pk_bf16_f32 v248, v74, -v75
    v_cvt_pk_bf16_f32 v249, v76, -v77
    v_pk_mul_f32 v[78:79], v[74:75], v[54:55] op_sel:[0,0] op_sel_hi:[0,1]
    v_pk_mul_f32 v[80:81], v[76:77], v[56:57] op_sel:[0,0] op_sel_hi:[0,1]
    v_pk_fma_f32 v[78:79], v[74:75], v[54:55], v[78:79] op_sel:[1,1,0] op_sel_hi:[1,0,1] neg_lo:[0,1,0]
    v_pk_fma_f32 v[80:81], v[76:77], v[56:57], v[80:81] op_sel:[1,1,0] op_sel_hi:[1,0,1] neg_lo:[0,1,0]
    v_cvt_pk_bf16_f32 v250, v78, -v79
    v_cvt_pk_bf16_f32 v251, v80, -v81
    ds_write2_b64 v33, v[248:249], v[250:251] offset0:132 offset1:198
    v_pk_mul_f32 v[94:95], v[54:55], v[54:55] op_sel:[0,0] op_sel_hi:[0,1]
    v_pk_mul_f32 v[96:97], v[56:57], v[56:57] op_sel:[0,0] op_sel_hi:[0,1]
    v_pk_fma_f32 v[94:95], v[54:55], v[54:55], v[94:95] op_sel:[1,1,0] op_sel_hi:[1,0,1] neg_lo:[0,1,0]
    v_pk_fma_f32 v[96:97], v[56:57], v[56:57], v[96:97] op_sel:[1,1,0] op_sel_hi:[1,0,1] neg_lo:[0,1,0]
    v_pk_mul_f32 v[70:71], v[66:67], v[62:63] op_sel:[0,0] op_sel_hi:[0,1]
    v_pk_mul_f32 v[72:73], v[68:69], v[64:65] op_sel:[0,0] op_sel_hi:[0,1]
    v_pk_fma_f32 v[70:71], v[66:67], v[62:63], v[70:71] op_sel:[1,1,0] op_sel_hi:[1,0,1] neg_lo:[0,1,0]
    v_pk_fma_f32 v[72:73], v[68:69], v[64:65], v[72:73] op_sel:[1,1,0] op_sel_hi:[1,0,1] neg_lo:[0,1,0]
    v_cvt_pk_bf16_f32 v244, v70, -v71
    v_cvt_pk_bf16_f32 v245, v72, -v73
    v_pk_mul_f32 v[74:75], v[70:71], v[94:95] op_sel:[0,0] op_sel_hi:[0,1]
    v_pk_mul_f32 v[76:77], v[72:73], v[96:97] op_sel:[0,0] op_sel_hi:[0,1]
    v_pk_fma_f32 v[74:75], v[70:71], v[94:95], v[74:75] op_sel:[1,1,0] op_sel_hi:[1,0,1] neg_lo:[0,1,0]
    v_pk_fma_f32 v[76:77], v[72:73], v[96:97], v[76:77] op_sel:[1,1,0] op_sel_hi:[1,0,1] neg_lo:[0,1,0]
    v_cvt_pk_bf16_f32 v246, v74, -v75
    v_cvt_pk_bf16_f32 v247, v76, -v77
    ds_write2_b64 v34, v[244:245], v[246:247] offset0:0 offset1:66
    v_pk_mul_f32 v[78:79], v[74:75], v[94:95] op_sel:[0,0] op_sel_hi:[0,1]
    v_pk_mul_f32 v[80:81], v[76:77], v[96:97] op_sel:[0,0] op_sel_hi:[0,1]
    v_pk_fma_f32 v[78:79], v[74:75], v[94:95], v[78:79] op_sel:[1,1,0] op_sel_hi:[1,0,1] neg_lo:[0,1,0]
    v_pk_fma_f32 v[80:81], v[76:77], v[96:97], v[80:81] op_sel:[1,1,0] op_sel_hi:[1,0,1] neg_lo:[0,1,0]
    v_cvt_pk_bf16_f32 v248, v78, -v79
    v_cvt_pk_bf16_f32 v249, v80, -v81
    ds_write_b64 v32, v[248:249] offset:5280
    v_pk_mul_f32 v[74:75], v[78:79], v[94:95] op_sel:[0,0] op_sel_hi:[0,1]
    v_pk_mul_f32 v[76:77], v[80:81], v[96:97] op_sel:[0,0] op_sel_hi:[0,1]
    v_pk_fma_f32 v[74:75], v[78:79], v[94:95], v[74:75] op_sel:[1,1,0] op_sel_hi:[1,0,1] neg_lo:[0,1,0]
    v_pk_fma_f32 v[76:77], v[80:81], v[96:97], v[76:77] op_sel:[1,1,0] op_sel_hi:[1,0,1] neg_lo:[0,1,0]
    v_cvt_pk_bf16_f32 v250, v74, -v75
    v_cvt_pk_bf16_f32 v251, v76, -v77
    ds_write2_b64 v35, v[248:249], v[250:251] offset0:0 offset1:66
    v_pk_mul_f32 v[78:79], v[74:75], v[94:95] op_sel:[0,0] op_sel_hi:[0,1]
    v_pk_mul_f32 v[80:81], v[76:77], v[96:97] op_sel:[0,0] op_sel_hi:[0,1]
    v_pk_fma_f32 v[78:79], v[74:75], v[94:95], v[78:79] op_sel:[1,1,0] op_sel_hi:[1,0,1] neg_lo:[0,1,0]
    v_pk_fma_f32 v[80:81], v[76:77], v[96:97], v[80:81] op_sel:[1,1,0] op_sel_hi:[1,0,1] neg_lo:[0,1,0]
    v_cvt_pk_bf16_f32 v244, v78, -v79
    v_cvt_pk_bf16_f32 v245, v80, -v81
    ds_write_b64 v32, v[244:245] offset:7392
    ds_read_b128 v[164:167], v36 offset:0
    ds_read_b128 v[168:171], v36 offset:64
    ds_read_b128 v[172:175], v36 offset:128
    ds_read_b128 v[176:179], v36 offset:192
    ds_read_b128 v[180:183], v36 offset:256
    ds_read_b128 v[184:187], v36 offset:320
    ds_read_b128 v[188:191], v36 offset:384
    ds_read_b128 v[192:195], v36 offset:448
    v_pk_mul_f32 v[90:91], v[94:95], v[94:95] op_sel:[0,0] op_sel_hi:[0,1]
    v_pk_mul_f32 v[92:93], v[96:97], v[96:97] op_sel:[0,0] op_sel_hi:[0,1]
    v_pk_fma_f32 v[90:91], v[94:95], v[94:95], v[90:91] op_sel:[1,1,0] op_sel_hi:[1,0,1] neg_lo:[0,1,0]
    v_pk_fma_f32 v[92:93], v[96:97], v[96:97], v[92:93] op_sel:[1,1,0] op_sel_hi:[1,0,1] neg_lo:[0,1,0]
    v_pk_mul_f32 v[66:67], v[70:71], v[62:63] op_sel:[0,0] op_sel_hi:[0,1]
    v_pk_mul_f32 v[68:69], v[72:73], v[64:65] op_sel:[0,0] op_sel_hi:[0,1]
    v_pk_fma_f32 v[66:67], v[70:71], v[62:63], v[66:67] op_sel:[1,1,0] op_sel_hi:[1,0,1] neg_lo:[0,1,0]
    v_pk_fma_f32 v[68:69], v[72:73], v[64:65], v[68:69] op_sel:[1,1,0] op_sel_hi:[1,0,1] neg_lo:[0,1,0]
    v_cvt_pk_bf16_f32 v246, v66, -v67
    v_cvt_pk_bf16_f32 v247, v68, -v69
    v_pk_mul_f32 v[74:75], v[66:67], v[90:91] op_sel:[0,0] op_sel_hi:[0,1]
    v_pk_mul_f32 v[76:77], v[68:69], v[92:93] op_sel:[0,0] op_sel_hi:[0,1]
    v_pk_fma_f32 v[74:75], v[66:67], v[90:91], v[74:75] op_sel:[1,1,0] op_sel_hi:[1,0,1] neg_lo:[0,1,0]
    v_pk_fma_f32 v[76:77], v[68:69], v[92:93], v[76:77] op_sel:[1,1,0] op_sel_hi:[1,0,1] neg_lo:[0,1,0]
    v_cvt_pk_bf16_f32 v248, v74, -v75
    v_cvt_pk_bf16_f32 v249, v76, -v77
    ds_write2_b64 v32, v[246:247], v[248:249] offset0:0 offset1:66
    v_pk_mul_f32 v[78:79], v[74:75], v[90:91] op_sel:[0,0] op_sel_hi:[0,1]
    v_pk_mul_f32 v[80:81], v[76:77], v[92:93] op_sel:[0,0] op_sel_hi:[0,1]
    v_pk_fma_f32 v[78:79], v[74:75], v[90:91], v[78:79] op_sel:[1,1,0] op_sel_hi:[1,0,1] neg_lo:[0,1,0]
    v_pk_fma_f32 v[80:81], v[76:77], v[92:93], v[80:81] op_sel:[1,1,0] op_sel_hi:[1,0,1] neg_lo:[0,1,0]
    v_cvt_pk_bf16_f32 v250, v78, -v79
    v_cvt_pk_bf16_f32 v251, v80, -v81
    s_waitcnt lgkmcnt(1)
    v_pk_mul_f32 v[70:71], v[66:67], v[62:63] op_sel:[0,0] op_sel_hi:[0,1]
    v_pk_mul_f32 v[72:73], v[68:69], v[64:65] op_sel:[0,0] op_sel_hi:[0,1]
    v_pk_fma_f32 v[70:71], v[66:67], v[62:63], v[70:71] op_sel:[1,1,0] op_sel_hi:[1,0,1] neg_lo:[0,1,0]
    v_pk_fma_f32 v[72:73], v[68:69], v[64:65], v[72:73] op_sel:[1,1,0] op_sel_hi:[1,0,1] neg_lo:[0,1,0]
    v_cvt_pk_bf16_f32 v244, v70, -v71
    v_cvt_pk_bf16_f32 v245, v72, -v73
    v_mfma_f32_16x16x32_bf16 v[228:231], v[164:167], v[100:103], 0
    ds_write_b64 v32, v[250:251] offset:1056
    v_mfma_f32_16x16x32_bf16 v[232:235], v[164:167], v[132:135], 0
    v_pk_mul_f32 v[74:75], v[70:71], v[90:91] op_sel:[0,0] op_sel_hi:[0,1]
    v_pk_mul_f32 v[76:77], v[72:73], v[92:93] op_sel:[0,0] op_sel_hi:[0,1]
    v_pk_fma_f32 v[74:75], v[70:71], v[90:91], v[74:75] op_sel:[1,1,0] op_sel_hi:[1,0,1] neg_lo:[0,1,0]
    v_pk_fma_f32 v[76:77], v[72:73], v[92:93], v[76:77] op_sel:[1,1,0] op_sel_hi:[1,0,1] neg_lo:[0,1,0]
    v_cvt_pk_bf16_f32 v246, v74, -v75
    v_cvt_pk_bf16_f32 v247, v76, -v77
    v_mfma_f32_16x16x32_bf16 v[228:231], v[168:171], v[104:107], v[228:231]
    ds_write2_b64 v33, v[244:245], v[246:247] offset0:0 offset1:66
    v_mfma_f32_16x16x32_bf16 v[232:235], v[168:171], v[136:139], v[232:235]
    v_pk_mul_f32 v[78:79], v[74:75], v[90:91] op_sel:[0,0] op_sel_hi:[0,1]
    v_pk_mul_f32 v[80:81], v[76:77], v[92:93] op_sel:[0,0] op_sel_hi:[0,1]
    v_pk_fma_f32 v[78:79], v[74:75], v[90:91], v[78:79] op_sel:[1,1,0] op_sel_hi:[1,0,1] neg_lo:[0,1,0]
    v_pk_fma_f32 v[80:81], v[76:77], v[92:93], v[80:81] op_sel:[1,1,0] op_sel_hi:[1,0,1] neg_lo:[0,1,0]
    v_cvt_pk_bf16_f32 v248, v78, -v79
    v_cvt_pk_bf16_f32 v249, v80, -v81
    v_mfma_f32_16x16x32_bf16 v[228:231], v[172:175], v[108:111], v[228:231]
    v_mfma_f32_16x16x32_bf16 v[232:235], v[172:175], v[140:143], v[232:235]
    v_pk_mul_f32 v[66:67], v[70:71], v[62:63] op_sel:[0,0] op_sel_hi:[0,1]
    v_pk_mul_f32 v[68:69], v[72:73], v[64:65] op_sel:[0,0] op_sel_hi:[0,1]
    v_pk_fma_f32 v[66:67], v[70:71], v[62:63], v[66:67] op_sel:[1,1,0] op_sel_hi:[1,0,1] neg_lo:[0,1,0]
    v_pk_fma_f32 v[68:69], v[72:73], v[64:65], v[68:69] op_sel:[1,1,0] op_sel_hi:[1,0,1] neg_lo:[0,1,0]
    v_cvt_pk_bf16_f32 v250, v66, -v67
    v_cvt_pk_bf16_f32 v251, v68, -v69
    v_mfma_f32_16x16x32_bf16 v[228:231], v[176:179], v[112:115], v[228:231]
    ds_write_b64 v32, v[248:249] offset:3168
    v_mfma_f32_16x16x32_bf16 v[232:235], v[176:179], v[144:147], v[232:235]
    v_pk_mul_f32 v[74:75], v[66:67], v[58:59] op_sel:[0,0] op_sel_hi:[0,1]
    v_pk_mul_f32 v[76:77], v[68:69], v[60:61] op_sel:[0,0] op_sel_hi:[0,1]
    v_pk_fma_f32 v[74:75], v[66:67], v[58:59], v[74:75] op_sel:[1,1,0] op_sel_hi:[1,0,1] neg_lo:[0,1,0]
    v_pk_fma_f32 v[76:77], v[68:69], v[60:61], v[76:77] op_sel:[1,1,0] op_sel_hi:[1,0,1] neg_lo:[0,1,0]
    v_cvt_pk_bf16_f32 v244, v74, -v75
    v_cvt_pk_bf16_f32 v245, v76, -v77
    v_mfma_f32_16x16x32_bf16 v[228:231], v[180:183], v[116:119], v[228:231]
    ds_write2_b64 v34, v[250:251], v[244:245] offset0:0 offset1:66
    v_mfma_f32_16x16x32_bf16 v[232:235], v[180:183], v[148:151], v[232:235]
    v_pk_mul_f32 v[70:71], v[66:67], v[62:63] op_sel:[0,0] op_sel_hi:[0,1]
    v_pk_mul_f32 v[72:73], v[68:69], v[64:65] op_sel:[0,0] op_sel_hi:[0,1]
    v_pk_fma_f32 v[70:71], v[66:67], v[62:63], v[70:71] op_sel:[1,1,0] op_sel_hi:[1,0,1] neg_lo:[0,1,0]
    v_pk_fma_f32 v[72:73], v[68:69], v[64:65], v[72:73] op_sel:[1,1,0] op_sel_hi:[1,0,1] neg_lo:[0,1,0]
    v_cvt_pk_bf16_f32 v246, v70, -v71
    v_cvt_pk_bf16_f32 v247, v72, -v73
    v_mfma_f32_16x16x32_bf16 v[228:231], v[184:187], v[120:123], v[228:231]
    v_mfma_f32_16x16x32_bf16 v[232:235], v[184:187], v[152:155], v[232:235]
    v_pk_mul_f32 v[74:75], v[70:71], v[58:59] op_sel:[0,0] op_sel_hi:[0,1]
    v_pk_mul_f32 v[76:77], v[72:73], v[60:61] op_sel:[0,0] op_sel_hi:[0,1]
    v_pk_fma_f32 v[74:75], v[70:71], v[58:59], v[74:75] op_sel:[1,1,0] op_sel_hi:[1,0,1] neg_lo:[0,1,0]
    v_pk_fma_f32 v[76:77], v[72:73], v[60:61], v[76:77] op_sel:[1,1,0] op_sel_hi:[1,0,1] neg_lo:[0,1,0]
    v_cvt_pk_bf16_f32 v248, v74, -v75
    v_cvt_pk_bf16_f32 v249, v76, -v77
    v_mfma_f32_16x16x32_bf16 v[228:231], v[188:191], v[124:127], v[228:231]
    ds_write2_b64 v34, v[246:247], v[248:249] offset0:132 offset1:198
    v_mfma_f32_16x16x32_bf16 v[232:235], v[188:191], v[156:159], v[232:235]
    v_pk_mul_f32 v[66:67], v[70:71], v[62:63] op_sel:[0,0] op_sel_hi:[0,1]
    v_pk_mul_f32 v[68:69], v[72:73], v[64:65] op_sel:[0,0] op_sel_hi:[0,1]
    v_pk_fma_f32 v[66:67], v[70:71], v[62:63], v[66:67] op_sel:[1,1,0] op_sel_hi:[1,0,1] neg_lo:[0,1,0]
    v_pk_fma_f32 v[68:69], v[72:73], v[64:65], v[68:69] op_sel:[1,1,0] op_sel_hi:[1,0,1] neg_lo:[0,1,0]
    v_cvt_pk_bf16_f32 v250, v66, -v67
    v_cvt_pk_bf16_f32 v251, v68, -v69
    v_mfma_f32_16x16x32_bf16 v[228:231], v[192:195], v[128:131], v[228:231]
    v_mfma_f32_16x16x32_bf16 v[232:235], v[192:195], v[160:163], v[232:235]
    v_pk_mul_f32 v[74:75], v[66:67], v[58:59] op_sel:[0,0] op_sel_hi:[0,1]
    v_pk_mul_f32 v[76:77], v[68:69], v[60:61] op_sel:[0,0] op_sel_hi:[0,1]
    v_pk_fma_f32 v[74:75], v[66:67], v[58:59], v[74:75] op_sel:[1,1,0] op_sel_hi:[1,0,1] neg_lo:[0,1,0]
    v_pk_fma_f32 v[76:77], v[68:69], v[60:61], v[76:77] op_sel:[1,1,0] op_sel_hi:[1,0,1] neg_lo:[0,1,0]
    v_cvt_pk_bf16_f32 v244, v74, -v75
    v_cvt_pk_bf16_f32 v245, v76, -v77
    ds_write2_b64 v35, v[250:251], v[244:245] offset0:0 offset1:66
    v_pk_mul_f32 v[70:71], v[66:67], v[62:63] op_sel:[0,0] op_sel_hi:[0,1]
    v_pk_mul_f32 v[72:73], v[68:69], v[64:65] op_sel:[0,0] op_sel_hi:[0,1]
    v_pk_fma_f32 v[70:71], v[66:67], v[62:63], v[70:71] op_sel:[1,1,0] op_sel_hi:[1,0,1] neg_lo:[0,1,0]
    v_pk_fma_f32 v[72:73], v[68:69], v[64:65], v[72:73] op_sel:[1,1,0] op_sel_hi:[1,0,1] neg_lo:[0,1,0]
    v_cvt_pk_bf16_f32 v246, v70, -v71
    v_cvt_pk_bf16_f32 v247, v72, -v73
    v_pk_mul_f32 v[74:75], v[70:71], v[58:59] op_sel:[0,0] op_sel_hi:[0,1]
    v_pk_mul_f32 v[76:77], v[72:73], v[60:61] op_sel:[0,0] op_sel_hi:[0,1]
    v_pk_fma_f32 v[74:75], v[70:71], v[58:59], v[74:75] op_sel:[1,1,0] op_sel_hi:[1,0,1] neg_lo:[0,1,0]
    v_pk_fma_f32 v[76:77], v[72:73], v[60:61], v[76:77] op_sel:[1,1,0] op_sel_hi:[1,0,1] neg_lo:[0,1,0]
    v_cvt_pk_bf16_f32 v248, v74, -v75
    v_cvt_pk_bf16_f32 v249, v76, -v77
    ds_write2_b64 v35, v[246:247], v[248:249] offset0:132 offset1:198
    ds_read_b128 v[196:199], v36 offset:0
    ds_read_b128 v[200:203], v36 offset:64
    ds_read_b128 v[204:207], v36 offset:128
    ds_read_b128 v[208:211], v36 offset:192
    ds_read_b128 v[212:215], v36 offset:256
    ds_read_b128 v[216:219], v36 offset:320
    ds_read_b128 v[220:223], v36 offset:384
    ds_read_b128 v[224:227], v36 offset:448
    v_lshlrev_b32 v13, 16, v31
    s_mov_b64 exec, 1
    v_add_f32 v228, v228, v13
    s_mov_b64 exec, -1
    v_cvt_pk_bf16_f32 v228, v228, v229
    v_cvt_pk_bf16_f32 v229, v230, v231
    v_perm_b32 v230, v229, v228, v46
    v_perm_b32 v231, v229, v228, v47
    v_cvt_pk_bf16_f32 v232, v232, v233
    v_cvt_pk_bf16_f32 v233, v234, v235
    v_perm_b32 v234, v233, v232, v46
    v_perm_b32 v235, v233, v232, v47
    s_waitcnt lgkmcnt(7)
    v_mfma_f32_16x16x32_bf16 v[236:239], v[196:199], v[100:103], 0
    v_mfma_f32_16x16x32_bf16 v[240:243], v[196:199], v[132:135], 0
    s_waitcnt lgkmcnt(6)
    v_mfma_f32_16x16x32_bf16 v[236:239], v[200:203], v[104:107], v[236:239]
    v_mfma_f32_16x16x32_bf16 v[240:243], v[200:203], v[136:139], v[240:243]
    s_waitcnt lgkmcnt(5)
    v_mfma_f32_16x16x32_bf16 v[236:239], v[204:207], v[108:111], v[236:239]
    v_mfma_f32_16x16x32_bf16 v[240:243], v[204:207], v[140:143], v[240:243]
    s_waitcnt lgkmcnt(4)
    v_mfma_f32_16x16x32_bf16 v[236:239], v[208:211], v[112:115], v[236:239]
    v_mfma_f32_16x16x32_bf16 v[240:243], v[208:211], v[144:147], v[240:243]
    s_waitcnt lgkmcnt(3)
    v_mfma_f32_16x16x32_bf16 v[236:239], v[212:215], v[116:119], v[236:239]
    v_mfma_f32_16x16x32_bf16 v[240:243], v[212:215], v[148:151], v[240:243]
    s_waitcnt lgkmcnt(2)
    v_mfma_f32_16x16x32_bf16 v[236:239], v[216:219], v[120:123], v[236:239]
    v_mfma_f32_16x16x32_bf16 v[240:243], v[216:219], v[152:155], v[240:243]
    s_waitcnt lgkmcnt(1)
    v_mfma_f32_16x16x32_bf16 v[236:239], v[220:223], v[124:127], v[236:239]
    v_mfma_f32_16x16x32_bf16 v[240:243], v[220:223], v[156:159], v[240:243]
    s_waitcnt lgkmcnt(0)
    v_mfma_f32_16x16x32_bf16 v[236:239], v[224:227], v[128:131], v[236:239]
    v_mfma_f32_16x16x32_bf16 v[240:243], v[224:227], v[160:163], v[240:243]
    s_mov_b32 s7, 0x1000100
    s_mov_b32 s50, 0x7060706
    s_mov_b32 s51, 0x5040504
    s_nop 3
    v_cvt_pk_bf16_f32 v236, v236, v237
    v_cvt_pk_bf16_f32 v237, v238, v239
    v_perm_b32 v164, v237, v236, v48
    v_perm_b32 v165, v237, v236, v49
    v_perm_b32 v166, v237, v236, v50
    v_perm_b32 v167, v237, v236, s7
    v_perm_b32 v168, v237, v236, s50
    v_perm_b32 v169, v237, v236, v51
    v_perm_b32 v170, v237, v236, s51
    v_perm_b32 v171, v237, v236, s51
    v_cvt_pk_bf16_f32 v240, v240, v241
    v_cvt_pk_bf16_f32 v241, v242, v243
    v_perm_b32 v172, v241, v240, v48
    v_perm_b32 v173, v241, v240, v49
    v_perm_b32 v174, v241, v240, v50
    v_perm_b32 v175, v241, v240, s7
    v_perm_b32 v176, v241, v240, s50
    v_perm_b32 v177, v241, v240, v51
    v_perm_b32 v178, v241, v240, s51
    v_perm_b32 v179, v241, v240, s51
    s_mul_i32 s6, s6, 1664525
    s_add_u32 s6, s6, 1013904223
    s_mov_b32 s8, s26
    s_and_b32 s9, s27, 0xffff
    s_mov_b32 s10, 0x280000
    s_mov_b32 s11, 0x20000
    v_mul_u32_u24 v236, 10240, v1
    v_lshrrev_b32 v8, 5, v1
    v_mul_u32_u24 v8, 576, v8
    v_and_b32 v9, 31, v1
    s_mul_i32 s7, s67, 1152
    s_add_u32 s7, s7, 104512
    v_lshl_add_u32 v8, v9, 4, v8
    v_add_u32 v237, s7, v8
    v_and_b32 v8, 3, v1
    v_mul_u32_u24 v8, 9216, v8
    v_bfe_u32 v9, v1, 2, 1
    v_mul_u32_u24 v9, 4576, v9
    v_add3_u32 v241, v8, v9, s7
    v_and_b32 v8, 8, v1
    v_mul_u32_u24 v8, 72, v8
    v_and_b32 v9, 16, v1
    v_add3_u32 v241, v241, v8, v9
    s_lshl_b32 s7, s67, 8
    v_lshl_add_u32 v8, v1, 2, s7
    v_add_u32 v238, 106816, v8
    v_add_u32 v239, 145408, v8
    v_mul_u32_u24 v240, 5120, v1
    s_mov_b32 s60, 0x05040100
    s_mov_b32 s65, 0x07060302
    v_mov_b32 v12, 103424
    v_mov_b32 v13, 1
    s_mov_b64 exec, 1
    ds_add_u32 v12, v13 offset:16
    s_mov_b64 exec, -1
    v_mov_b32 v8, 0
    v_mov_b32 v9, 0
    v_mov_b32 v12, 103424
    s_mov_b32 s64, 800000
tw_94:
    s_sleep 2
    ds_read_b32 v13, v12 offset:52
    s_sub_u32 s64, s64, 1
    s_cbranch_scc1 twd_95
    s_waitcnt lgkmcnt(0)
    v_cmp_gt_u32 vcc, 4, v13
    s_cbranch_vccnz tw_94
twd_95:
    s_setprio 3
    ds_write_b64 v37, v[230:231] offset:128
    ds_write_b64 v37, v[234:235] offset:0
    ds_write_b64 v52, v[8:9] offset:2048
    ds_write_b128 v38, v[164:167] offset:384
    ds_write_b128 v38, v[172:175] offset:256
    s_mov_b32 exec_lo, 0
    ds_write_b128 v38, v[168:171] offset:128
    ds_write_b128 v38, v[176:179] offset:0
    s_mov_b32 exec_lo, -1
    s_mov_b32 s56, s44
    s_and_b32 s57, s45, 0xffff
    s_mov_b32 s58, 0x500000
    s_mov_b32 s59, 0x20000
    s_cmp_lg_u32 s67, 3
    s_cbranch_scc1 nopoll_96
    v_lshlrev_b32 v12, 7, v1
    s_mov_b32 s69, 4096
    s_mov_b32 s64, 200000
    s_branch poll0_99
poll_97:
    s_sleep 8
poll0_99:
    buffer_load_dwordx4 v[8:11], v12, s[52:55], s69 offen sc1
    s_sub_u32 s64, s64, 1
    s_cbranch_scc1 pdone_98
    s_waitcnt vmcnt(0)
    v_xor_b32 v8, s6, v8
    v_xor_b32 v9, s6, v9
    v_xor_b32 v10, s6, v10
    v_xor_b32 v11, s6, v11
    v_or3_b32 v8, v8, v9, v10
    v_or_b32 v8, v8, v11
    v_cmp_ne_u32 vcc, 0, v8
    s_cbranch_vccnz poll_97
pdone_98:
    v_mov_b32 v12, 103424
    v_mov_b32 v13, 1
    s_mov_b64 exec, 1
    ds_add_u32 v12, v13 offset:12
    s_mov_b64 exec, -1
nopoll_96:
    v_mov_b32 v12, 103424
    s_mov_b32 s64, 800000
tw_100:
    s_sleep 2
    ds_read_b32 v13, v12 offset:16
    s_sub_u32 s64, s64, 1
    s_cbranch_scc1 twd_101
    s_waitcnt lgkmcnt(0)
    v_cmp_gt_u32 vcc, 8, v13
    s_cbranch_vccnz tw_100
twd_101:
    v_mov_b32 v12, 103424
    s_mov_b32 s64, 800000
tw_102:
    s_sleep 2
    ds_read_b32 v13, v12 offset:12
    s_sub_u32 s64, s64, 1
    s_cbranch_scc1 twd_103
    s_waitcnt lgkmcnt(0)
    v_cmp_gt_u32 vcc, 1, v13
    s_cbranch_vccnz tw_102
twd_103:
    s_mul_i32 s7, s67, 3072
    s_add_u32 m0, s7, s63
    s_add_u32 s7, s7, s62
    buffer_load_dwordx4 v16, s[52:55], s7 offen offset:0 sc1 lds
    buffer_load_dwordx4 v16, s[52:55], s7 offen offset:1024 sc1 lds
    buffer_load_dwordx4 v16, s[52:55], s7 offen offset:2048 sc1 lds
    s_cmp_ge_u32 s67, 3
    s_cbranch_scc1 dma_105
    s_mul_i32 s7, s67, 3072
    s_add_u32 s7, s7, 12288
    s_add_u32 m0, s7, s63
    s_add_u32 s7, s7, s62
    buffer_load_dwordx4 v16, s[52:55], s7 offen offset:0 sc1 lds
    buffer_load_dwordx4 v16, s[52:55], s7 offen offset:1024 sc1 lds
    buffer_load_dwordx4 v16, s[52:55], s7 offen offset:2048 sc1 lds
dma_105:
    s_add_u32 s62, s62, 21504
    s_cmp_eq_u32 s62, 303104
    s_cselect_b32 s62, 131072, s62
    s_xor_b32 s63, s63, 21504
    s_cmp_ge_u32 s67, 2
    s_cbranch_scc1 ux_106
    s_mul_i32 s7, s67, 655360
    s_lshl_b32 s50, s66, 3
    s_add_u32 s7, s7, s50
    buffer_load_dwordx2 v[218:219], v236, s[8:11], s7 offen offset:0
    buffer_load_dwordx2 v[220:221], v236, s[8:11], s7 offen offset:1280
    buffer_load_dwordx2 v[222:223], v236, s[8:11], s7 offen offset:2560
    buffer_load_dwordx2 v[224:225], v236, s[8:11], s7 offen offset:3840
    s_sub_u32 s7, s7, 1280
    s_cmp_eq_u32 s67, 0
    s_cselect_b32 s7, 0x10000000, s7
    v_mov_b32 v8, s7
    s_mov_b64 exec, 1
    buffer_load_dwordx2 v[216:217], v8, s[8:11], 0 offen
    s_mov_b64 exec, -1
ux_106:
    s_setprio 0
    s_cmp_ge_u32 s67, 2
    s_cbranch_scc1 ux_107
    s_waitcnt vmcnt(5) lgkmcnt(0)
    s_barrier
    s_branch L_seg1
ux_107:
    s_waitcnt vmcnt(0) lgkmcnt(0)
    s_barrier
L_seg1:
    s_mul_i32 s7, s67, 3072
    s_add_u32 m0, s7, s63
    s_add_u32 s7, s7, s62
    buffer_load_dwordx4 v16, s[52:55], s7 offen offset:0 sc1 lds
    buffer_load_dwordx4 v16, s[52:55], s7 offen offset:1024 sc1 lds
    buffer_load_dwordx4 v16, s[52:55], s7 offen offset:2048 sc1 lds
    s_cmp_ge_u32 s67, 3
    s_cbranch_scc1 dma_109
    s_mul_i32 s7, s67, 3072
    s_add_u32 s7, s7, 12288
    s_add_u32 m0, s7, s63
    s_add_u32 s7, s7, s62
    buffer_load_dwordx4 v16, s[52:55], s7 offen offset:0 sc1 lds
    buffer_load_dwordx4 v16, s[52:55], s7 offen offset:1024 sc1 lds
    buffer_load_dwordx4 v16, s[52:55], s7 offen offset:2048 sc1 lds
dma_109:
    s_add_u32 s62, s62, 21504
    s_cmp_eq_u32 s62, 303104
    s_cselect_b32 s62, 131072, s62
    s_xor_b32 s63, s63, 21504
    s_mov_b32 m0, s61
    s_add_u32 s61, s61, 5120
    s_sub_u32 s7, s68, 819200
    s_cselect_b32 s68, s68, s7
    buffer_load_dwordx4 v18, s[12:15], s68 offen offset:0 lds
    buffer_load_dwordx4 v19, s[12:15], s68 offen offset:1024 lds
    buffer_load_dwordx4 v20, s[12:15], s68 offen offset:2048 lds
    buffer_load_dwordx4 v21, s[12:15], s68 offen offset:3072 lds
    s_add_u32 m0, m0, 4096
    s_nop 0
    buffer_load_dwordx4 v22, s[12:15], s68 offen lds
    s_add_u32 m0, m0, 1024
    s_add_u32 s68, s68, 40960
    s_mul_i32 s7, s67, 9216
    s_add_u32 s7, s7, 104448
    v_add_u32 v12, s7, v16
    v_mov_b32 v8, 0
    v_mov_b32 v9, 0
    v_mov_b32 v10, 0
    v_mov_b32 v11, 0
    s_mov_b64 exec, 15
    ds_write_b128 v12, v[8:11]
    s_mov_b64 exec, 3
    ds_write_b128 v12, v[8:11] offset:4608
    s_mov_b64 exec, -1
    s_cmp_ge_u32 s67, 2
    s_cbranch_scc1 ux_110
    s_mul_i32 s7, s67, 655360
    s_lshl_b32 s50, s66, 3
    s_add_u32 s7, s7, s50
    s_add_u32 s7, s7, 5120
    buffer_load_dwordx2 v[226:227], v236, s[8:11], s7 offen offset:0
    buffer_load_dwordx2 v[228:229], v236, s[8:11], s7 offen offset:1280
    buffer_load_dwordx2 v[230:231], v236, s[8:11], s7 offen offset:2560
    buffer_load_dwordx2 v[232:233], v236, s[8:11], s7 offen offset:3840
ux_110:
    s_cmp_ge_u32 s67, 2
    s_cbranch_scc1 ux_111
    s_waitcnt vmcnt(4) lgkmcnt(0)
    s_barrier
    s_branch L_seg2
ux_111:
    s_waitcnt vmcnt(0) lgkmcnt(0)
    s_barrier
L_seg2:
    s_mul_i32 s7, s67, 3072
    s_add_u32 m0, s7, s63
    s_add_u32 s7, s7, s62
    buffer_load_dwordx4 v16, s[52:55], s7 offen offset:0 sc1 lds
    buffer_load_dwordx4 v16, s[52:55], s7 offen offset:1024 sc1 lds
    buffer_load_dwordx4 v16, s[52:55], s7 offen offset:2048 sc1 lds
    s_cmp_ge_u32 s67, 3
    s_cbranch_scc1 dma_113
    s_mul_i32 s7, s67, 3072
    s_add_u32 s7, s7, 12288
    s_add_u32 m0, s7, s63
    s_add_u32 s7, s7, s62
    buffer_load_dwordx4 v16, s[52:55], s7 offen offset:0 sc1 lds
    buffer_load_dwordx4 v16, s[52:55], s7 offen offset:1024 sc1 lds
    buffer_load_dwordx4 v16, s[52:55], s7 offen offset:2048 sc1 lds
dma_113:
    s_add_u32 s62, s62, 21504
    s_cmp_eq_u32 s62, 303104
    s_cselect_b32 s62, 131072, s62
    s_xor_b32 s63, s63, 21504
    s_mov_b32 m0, s61
    s_add_u32 s61, s61, 5120
    s_sub_u32 s7, s68, 819200
    s_cselect_b32 s68, s68, s7
    buffer_load_dwordx4 v18, s[12:15], s68 offen offset:0 lds
    buffer_load_dwordx4 v19, s[12:15], s68 offen offset:1024 lds
    buffer_load_dwordx4 v20, s[12:15], s68 offen offset:2048 lds
    buffer_load_dwordx4 v21, s[12:15], s68 offen offset:3072 lds
    s_add_u32 m0, m0, 4096
    s_nop 0
    buffer_load_dwordx4 v22, s[12:15], s68 offen lds
    s_add_u32 m0, m0, 1024
    s_add_u32 s68, s68, 40960
    s_cmp_ge_u32 s67, 2
    s_cbranch_scc1 uw_114
    s_waitcnt vmcnt(11)
    s_setprio 3
    v_mov_b32_dpp v216, v232 wave_shr:1 row_mask:0xf bank_mask:0xf
    v_mov_b32_dpp v217, v233 wave_shr:1 row_mask:0xf bank_mask:0xf
    v_perm_b32 v184, v220, v218, s60
    v_perm_b32 v185, v224, v222, s60
    v_perm_b32 v186, v228, v226, s60
    v_perm_b32 v187, v232, v230, s60
    ds_write_b128 v237, v[184:187] offset:0
    v_perm_b32 v188, v218, v216, s60
    v_perm_b32 v189, v222, v220, s60
    v_perm_b32 v190, v226, v224, s60
    v_perm_b32 v191, v230, v228, s60
    ds_write_b128 v237, v[188:191] offset:4576
    v_perm_b32 v192, v220, v218, s65
    v_perm_b32 v193, v224, v222, s65
    v_perm_b32 v194, v228, v226, s65
    v_perm_b32 v195, v232, v230, s65
    ds_write_b128 v237, v[192:195] offset:9216
    v_perm_b32 v196, v218, v216, s65
    v_perm_b32 v197, v222, v220, s65
    v_perm_b32 v198, v226, v224, s65
    v_perm_b32 v199, v230, v228, s65
    ds_write_b128 v237, v[196:199] offset:13792
    v_perm_b32 v200, v221, v219, s60
    v_perm_b32 v201, v225, v223, s60
    v_perm_b32 v202, v229, v227, s60
    v_perm_b32 v203, v233, v231, s60
    ds_write_b128 v237, v[200:203] offset:18432
    v_perm_b32 v204, v219, v217, s60
    v_perm_b32 v205, v223, v221, s60
    v_perm_b32 v206, v227, v225, s60
    v_perm_b32 v207, v231, v229, s60
    ds_write_b128 v237, v[204:207] offset:23008
    v_perm_b32 v208, v221, v219, s65
    v_perm_b32 v209, v225, v223, s65
    v_perm_b32 v210, v229, v227, s65
    v_perm_b32 v211, v233, v231, s65
    ds_write_b128 v237, v[208:211] offset:27648
    v_perm_b32 v212, v219, v217, s65
    v_perm_b32 v213, v223, v221, s65
    v_perm_b32 v214, v227, v225, s65
    v_perm_b32 v215, v231, v229, s65
    ds_write_b128 v237, v[212:215] offset:32224
    s_cmp_eq_u32 s67, 3
    s_cselect_b32 exec_lo, 0x00ff00ff, -1
    s_mov_b32 exec_hi, 0
    ds_read_b128 v[216:219], v241 offset:480
    s_waitcnt lgkmcnt(0)
    ds_write_b128 v241, v[216:219] offset:544
    s_mov_b64 exec, -1
    s_setprio 0
uw_114:
    s_waitcnt vmcnt(0) lgkmcnt(0)
    s_barrier
L_seg3:
    s_mul_i32 s7, s67, 3072
    s_add_u32 m0, s7, s63
    s_add_u32 s7, s7, s62
    buffer_load_dwordx4 v16, s[52:55], s7 offen offset:0 sc1 lds
    buffer_load_dwordx4 v16, s[52:55], s7 offen offset:1024 sc1 lds
    buffer_load_dwordx4 v16, s[52:55], s7 offen offset:2048 sc1 lds
    s_cmp_ge_u32 s67, 3
    s_cbranch_scc1 dma_117
    s_mul_i32 s7, s67, 3072
    s_add_u32 s7, s7, 12288
    s_add_u32 m0, s7, s63
    s_add_u32 s7, s7, s62
    buffer_load_dwordx4 v16, s[52:55], s7 offen offset:0 sc1 lds
    buffer_load_dwordx4 v16, s[52:55], s7 offen offset:1024 sc1 lds
    buffer_load_dwordx4 v16, s[52:55], s7 offen offset:2048 sc1 lds
dma_117:
    s_add_u32 s62, s62, 21504
    s_cmp_eq_u32 s62, 303104
    s_cselect_b32 s62, 131072, s62
    s_xor_b32 s63, s63, 21504
    s_mov_b32 m0, s61
    s_add_u32 s61, s61, 5120
    s_sub_u32 s7, s68, 819200
    s_cselect_b32 s68, s68, s7
    buffer_load_dwordx4 v18, s[12:15], s68 offen offset:0 lds
    buffer_load_dwordx4 v19, s[12:15], s68 offen offset:1024 lds
    buffer_load_dwordx4 v20, s[12:15], s68 offen offset:2048 lds
    buffer_load_dwordx4 v21, s[12:15], s68 offen offset:3072 lds
    s_add_u32 m0, m0, 4096
    s_nop 0
    buffer_load_dwordx4 v22, s[12:15], s68 offen lds
    s_add_u32 m0, m0, 1024
    s_add_u32 s68, s68, 40960
    s_cmp_ge_u32 s67, 2
    s_cbranch_scc0 ux_118
    s_mul_i32 s7, s67, 655360
    s_lshl_b32 s50, s66, 3
    s_add_u32 s7, s7, s50
    buffer_load_dwordx2 v[218:219], v236, s[8:11], s7 offen offset:0
    buffer_load_dwordx2 v[220:221], v236, s[8:11], s7 offen offset:1280
    buffer_load_dwordx2 v[222:223], v236, s[8:11], s7 offen offset:2560
    buffer_load_dwordx2 v[224:225], v236, s[8:11], s7 offen offset:3840
    s_sub_u32 s7, s7, 1280
    s_cmp_eq_u32 s67, 0
    s_cselect_b32 s7, 0x10000000, s7
    v_mov_b32 v8, s7
    s_mov_b64 exec, 1
    buffer_load_dwordx2 v[216:217], v8, s[8:11], 0 offen
    s_mov_b64 exec, -1
ux_118:
    ds_read2_b32 v[120:121], v40 offset0:0 offset1:1
    ds_read2_b32 v[122:123], v40 offset0:2 offset1:3
    ds_read_b128 v[152:155], v39 offset:1536
    s_waitcnt lgkmcnt(0)
    v_mfma_f32_32x32x16_bf16 v[56:71], v[120:123], v[152:155], 0
    ds_read_b128 v[156:159], v39 offset:1024
    s_waitcnt lgkmcnt(0)
    v_mfma_f32_32x32x16_bf16 v[72:87], v[120:123], v[156:159], 0
    ds_read2_b32 v[124:125], v41 offset0:0 offset1:1
    ds_read2_b32 v[126:127], v41 offset0:2 offset1:3
    s_waitcnt lgkmcnt(0)
    v_mfma_f32_32x32x16_bf16 v[72:87], v[124:127], v[152:155], v[72:87]
    ds_read2_b32 v[136:137], v40 offset0:8 offset1:9
    ds_read2_b32 v[138:139], v40 offset0:10 offset1:11
    ds_read_b128 v[168:171], v39 offset:1552
    s_waitcnt lgkmcnt(0)
    v_mfma_f32_32x32x16_bf16 v[56:71], v[136:139], v[168:171], v[56:71]
    ds_read_b128 v[172:175], v39 offset:1040
    s_waitcnt lgkmcnt(0)
    v_mfma_f32_32x32x16_bf16 v[72:87], v[136:139], v[172:175], v[72:87]
    ds_read2_b32 v[140:141], v41 offset0:8 offset1:9
    ds_read2_b32 v[142:143], v41 offset0:10 offset1:11
    s_waitcnt lgkmcnt(0)
    v_mfma_f32_32x32x16_bf16 v[72:87], v[140:143], v[168:171], v[72:87]
    ds_read2_b32 v[120:121], v40 offset0:16 offset1:17
    ds_read2_b32 v[122:123], v40 offset0:18 offset1:19
    ds_read_b128 v[152:155], v39 offset:1568
    s_waitcnt lgkmcnt(0)
    v_mfma_f32_32x32x16_bf16 v[56:71], v[120:123], v[152:155], v[56:71]
    ds_read_b128 v[156:159], v39 offset:1056
    s_waitcnt lgkmcnt(0)
    v_mfma_f32_32x32x16_bf16 v[72:87], v[120:123], v[156:159], v[72:87]
    ds_read2_b32 v[124:125], v41 offset0:16 offset1:17
    ds_read2_b32 v[126:127], v41 offset0:18 offset1:19
    s_waitcnt lgkmcnt(0)
    v_mfma_f32_32x32x16_bf16 v[72:87], v[124:127], v[152:155], v[72:87]
    ds_read2_b32 v[136:137], v40 offset0:24 offset1:25
    ds_read2_b32 v[138:139], v40 offset0:26 offset1:27
    ds_read_b128 v[168:171], v39 offset:1584
    s_waitcnt lgkmcnt(0)
    v_mfma_f32_32x32x16_bf16 v[56:71], v[136:139], v[168:171], v[56:71]
    ds_read_b128 v[172:175], v39 offset:1072
    s_waitcnt lgkmcnt(0)
    v_mfma_f32_32x32x16_bf16 v[72:87], v[136:139], v[172:175], v[72:87]
    ds_read2_b32 v[140:141], v41 offset0:24 offset1:25
    ds_read2_b32 v[142:143], v41 offset0:26 offset1:27
    s_waitcnt lgkmcnt(0)
    v_mfma_f32_32x32x16_bf16 v[72:87], v[140:143], v[168:171], v[72:87]
    ds_read2_b32 v[120:121], v40 offset0:32 offset1:33
    ds_read2_b32 v[122:123], v40 offset0:34 offset1:35
    ds_read_b128 v[152:155], v39 offset:1600
    s_waitcnt lgkmcnt(0)
    v_mfma_f32_32x32x16_bf16 v[56:71], v[120:123], v[152:155], v[56:71]
    ds_read_b128 v[156:159], v39 offset:1088
    s_waitcnt lgkmcnt(0)
    v_mfma_f32_32x32x16_bf16 v[72:87], v[120:123], v[156:159], v[72:87]
    ds_read2_b32 v[124:125], v41 offset0:32 offset1:33
    ds_read2_b32 v[126:127], v41 offset0:34 offset1:35
    s_waitcnt lgkmcnt(0)
    v_mfma_f32_32x32x16_bf16 v[72:87], v[124:127], v[152:155], v[72:87]
    ds_read2_b32 v[136:137], v40 offset0:40 offset1:41
    ds_read2_b32 v[138:139], v40 offset0:42 offset1:43
    ds_read_b128 v[168:171], v39 offset:1616
    s_waitcnt lgkmcnt(0)
    v_mfma_f32_32x32x16_bf16 v[56:71], v[136:139], v[168:171], v[56:71]
    s_cmp_ge_u32 s67, 2
    s_cbranch_scc0 ux_119
    s_waitcnt vmcnt(5) lgkmcnt(0)
    s_barrier
    s_branch L_seg4
ux_119:
    s_waitcnt vmcnt(0) lgkmcnt(0)
    s_barrier
L_seg4:
    s_mul_i32 s7, s67, 3072
    s_add_u32 m0, s7, s63
    s_add_u32 s7, s7, s62
    buffer_load_dwordx4 v16, s[52:55], s7 offen offset:0 sc1 lds
    buffer_load_dwordx4 v16, s[52:55], s7 offen offset:1024 sc1 lds
    buffer_load_dwordx4 v16, s[52:55], s7 offen offset:2048 sc1 lds
    s_cmp_ge_u32 s67, 3
    s_cbranch_scc1 dma_121
    s_mul_i32 s7, s67, 3072
    s_add_u32 s7, s7, 12288
    s_add_u32 m0, s7, s63
    s_add_u32 s7, s7, s62
    buffer_load_dwordx4 v16, s[52:55], s7 offen offset:0 sc1 lds
    buffer_load_dwordx4 v16, s[52:55], s7 offen offset:1024 sc1 lds
    buffer_load_dwordx4 v16, s[52:55], s7 offen offset:2048 sc1 lds
dma_121:
    s_add_u32 s62, s62, 21504
    s_cmp_eq_u32 s62, 303104
    s_cselect_b32 s62, 131072, s62
    s_xor_b32 s63, s63, 21504
    s_lshr_b32 s7, s2, 3
    s_lshl_b32 s7, s7, 2
    s_add_u32 s7, s7, s67
    s_mul_i32 s7, s7, 2560
    s_add_u32 s7, s7, 409600
    v_lshlrev_b32 v8, 7, v1
    s_mov_b64 exec, 0xfffff
    buffer_load_dword v8, v8, s[12:15], s7 offen
    s_mov_b64 exec, -1
    s_cmp_ge_u32 s67, 2
    s_cbranch_scc0 ux_122
    s_mul_i32 s7, s67, 655360
    s_lshl_b32 s50, s66, 3
    s_add_u32 s7, s7, s50
    s_add_u32 s7, s7, 5120
    buffer_load_dwordx2 v[226:227], v236, s[8:11], s7 offen offset:0
    buffer_load_dwordx2 v[228:229], v236, s[8:11], s7 offen offset:1280
    buffer_load_dwordx2 v[230:231], v236, s[8:11], s7 offen offset:2560
    buffer_load_dwordx2 v[232:233], v236, s[8:11], s7 offen offset:3840
ux_122:
    ds_read_b128 v[172:175], v39 offset:1104
    s_waitcnt lgkmcnt(0)
    v_mfma_f32_32x32x16_bf16 v[72:87], v[136:139], v[172:175], v[72:87]
    ds_read2_b32 v[140:141], v41 offset0:40 offset1:41
    ds_read2_b32 v[142:143], v41 offset0:42 offset1:43
    s_waitcnt lgkmcnt(0)
    v_mfma_f32_32x32x16_bf16 v[72:87], v[140:143], v[168:171], v[72:87]
    ds_read2_b32 v[120:121], v40 offset0:48 offset1:49
    ds_read2_b32 v[122:123], v40 offset0:50 offset1:51
    ds_read_b128 v[152:155], v39 offset:1632
    s_waitcnt lgkmcnt(0)
    v_mfma_f32_32x32x16_bf16 v[56:71], v[120:123], v[152:155], v[56:71]
    ds_read_b128 v[156:159], v39 offset:1120
    s_waitcnt lgkmcnt(0)
    v_mfma_f32_32x32x16_bf16 v[72:87], v[120:123], v[156:159], v[72:87]
    ds_read2_b32 v[124:125], v41 offset0:48 offset1:49
    ds_read2_b32 v[126:127], v41 offset0:50 offset1:51
    s_waitcnt lgkmcnt(0)
    v_mfma_f32_32x32x16_bf16 v[72:87], v[124:127], v[152:155], v[72:87]
    ds_read2_b32 v[136:137], v40 offset0:56 offset1:57
    ds_read2_b32 v[138:139], v40 offset0:58 offset1:59
    ds_read_b128 v[168:171], v39 offset:1648
    s_waitcnt lgkmcnt(0)
    v_mfma_f32_32x32x16_bf16 v[56:71], v[136:139], v[168:171], v[56:71]
    ds_read_b128 v[172:175], v39 offset:1136
    s_waitcnt lgkmcnt(0)
    v_mfma_f32_32x32x16_bf16 v[72:87], v[136:139], v[172:175], v[72:87]
    ds_read2_b32 v[140:141], v41 offset0:56 offset1:57
    ds_read2_b32 v[142:143], v41 offset0:58 offset1:59
    s_waitcnt lgkmcnt(0)
    v_mfma_f32_32x32x16_bf16 v[72:87], v[140:143], v[168:171], v[72:87]
    ds_read2_b32 v[120:121], v40 offset0:64 offset1:65
    ds_read2_b32 v[122:123], v40 offset0:66 offset1:67
    ds_read_b128 v[152:155], v39 offset:1664
    s_waitcnt lgkmcnt(0)
    v_mfma_f32_32x32x16_bf16 v[56:71], v[120:123], v[152:155], v[56:71]
    ds_read_b128 v[156:159], v39 offset:1152
    s_waitcnt lgkmcnt(0)
    v_mfma_f32_32x32x16_bf16 v[72:87], v[120:123], v[156:159], v[72:87]
    ds_read2_b32 v[124:125], v41 offset0:64 offset1:65
    ds_read2_b32 v[126:127], v41 offset0:66 offset1:67
    s_waitcnt lgkmcnt(0)
    v_mfma_f32_32x32x16_bf16 v[72:87], v[124:127], v[152:155], v[72:87]
    ds_read2_b32 v[136:137], v40 offset0:72 offset1:73
    ds_read2_b32 v[138:139], v40 offset0:74 offset1:75
    ds_read_b128 v[168:171], v39 offset:1680
    s_waitcnt lgkmcnt(0)
    v_mfma_f32_32x32x16_bf16 v[56:71], v[136:139], v[168:171], v[56:71]
    ds_read_b128 v[172:175], v39 offset:1168
    s_waitcnt lgkmcnt(0)
    v_mfma_f32_32x32x16_bf16 v[72:87], v[136:139], v[172:175], v[72:87]
    ds_read2_b32 v[140:141], v41 offset0:72 offset1:73
    ds_read2_b32 v[142:143], v41 offset0:74 offset1:75
    s_waitcnt lgkmcnt(0)
    v_mfma_f32_32x32x16_bf16 v[72:87], v[140:143], v[168:171], v[72:87]
    ds_read2_b32 v[120:121], v40 offset0:80 offset1:81
    ds_read2_b32 v[122:123], v40 offset0:82 offset1:83
    ds_read_b128 v[152:155], v39 offset:1696
    s_waitcnt lgkmcnt(0)
    v_mfma_f32_32x32x16_bf16 v[56:71], v[120:123], v[152:155], v[56:71]
    ds_read_b128 v[156:159], v39 offset:1184
    s_waitcnt lgkmcnt(0)
    v_mfma_f32_32x32x16_bf16 v[72:87], v[120:123], v[156:159], v[72:87]
    s_cmp_ge_u32 s67, 2
    s_cbranch_scc0 ux_123
    s_waitcnt vmcnt(4) lgkmcnt(0)
    s_barrier
    s_branch L_seg5
ux_123:
    s_waitcnt vmcnt(0) lgkmcnt(0)
    s_barrier
L_seg5:
    s_mul_i32 s7, s67, 3072
    s_add_u32 m0, s7, s63
    s_add_u32 s7, s7, s62
    buffer_load_dwordx4 v16, s[52:55], s7 offen offset:0 sc1 lds
    buffer_load_dwordx4 v16, s[52:55], s7 offen offset:1024 sc1 lds
    buffer_load_dwordx4 v16, s[52:55], s7 offen offset:2048 sc1 lds
    s_cmp_ge_u32 s67, 3
    s_cbranch_scc1 dma_125
    s_mul_i32 s7, s67, 3072
    s_add_u32 s7, s7, 12288
    s_add_u32 m0, s7, s63
    s_add_u32 s7, s7, s62
    buffer_load_dwordx4 v16, s[52:55], s7 offen offset:0 sc1 lds
    buffer_load_dwordx4 v16, s[52:55], s7 offen offset:1024 sc1 lds
    buffer_load_dwordx4 v16, s[52:55], s7 offen offset:2048 sc1 lds
dma_125:
    s_add_u32 s62, s62, 21504
    s_cmp_eq_u32 s62, 303104
    s_cselect_b32 s62, 131072, s62
    s_xor_b32 s63, s63, 21504
    s_lshl_b32 s7, s4, 3
    s_add_u32 s7, s7, s5
    s_lshl_b32 s7, s7, 2
    s_add_u32 s7, s7, s67
    s_mul_i32 s7, s7, 2560
    s_add_u32 s7, s7, 4194304
    v_mov_b32 v8, -1
    v_mov_b32 v9, -1
    v_mov_b32 v10, -1
    v_mov_b32 v11, -1
    s_add_u32 s50, s7, 4194304
    buffer_store_dwordx4 v[8:11], v16, s[52:55], s7 offen offset:0 sc1
    buffer_store_dwordx4 v[8:11], v16, s[52:55], s50 offen offset:0 sc1
    buffer_store_dwordx4 v[8:11], v16, s[52:55], s7 offen offset:1024 sc1
    buffer_store_dwordx4 v[8:11], v16, s[52:55], s50 offen offset:1024 sc1
    s_mov_b32 exec_hi, 0
    buffer_store_dwordx4 v[8:11], v16, s[52:55], s7 offen offset:2048 sc1
    buffer_store_dwordx4 v[8:11], v16, s[52:55], s50 offen offset:2048 sc1
    s_mov_b32 exec_hi, -1
    ds_read2_b32 v[124:125], v41 offset0:80 offset1:81
    ds_read2_b32 v[126:127], v41 offset0:82 offset1:83
    s_waitcnt lgkmcnt(0)
    v_mfma_f32_32x32x16_bf16 v[72:87], v[124:127], v[152:155], v[72:87]
    ds_read2_b32 v[136:137], v40 offset0:88 offset1:89
    ds_read2_b32 v[138:139], v40 offset0:90 offset1:91
    ds_read_b128 v[168:171], v39 offset:1712
    s_waitcnt lgkmcnt(0)
    v_mfma_f32_32x32x16_bf16 v[56:71], v[136:139], v[168:171], v[56:71]
    ds_read_b128 v[172:175], v39 offset:1200
    s_waitcnt lgkmcnt(0)
    v_mfma_f32_32x32x16_bf16 v[72:87], v[136:139], v[172:175], v[72:87]
    ds_read2_b32 v[140:141], v41 offset0:88 offset1:89
    ds_read2_b32 v[142:143], v41 offset0:90 offset1:91
    s_waitcnt lgkmcnt(0)
    v_mfma_f32_32x32x16_bf16 v[72:87], v[140:143], v[168:171], v[72:87]
    ds_read2_b32 v[120:121], v40 offset0:96 offset1:97
    ds_read2_b32 v[122:123], v40 offset0:98 offset1:99
    ds_read_b128 v[152:155], v39 offset:1728
    s_waitcnt lgkmcnt(0)
    v_mfma_f32_32x32x16_bf16 v[56:71], v[120:123], v[152:155], v[56:71]
    ds_read_b128 v[156:159], v39 offset:1216
    s_waitcnt lgkmcnt(0)
    v_mfma_f32_32x32x16_bf16 v[72:87], v[120:123], v[156:159], v[72:87]
    ds_read2_b32 v[124:125], v41 offset0:96 offset1:97
    ds_read2_b32 v[126:127], v41 offset0:98 offset1:99
    s_waitcnt lgkmcnt(0)
    v_mfma_f32_32x32x16_bf16 v[72:87], v[124:127], v[152:155], v[72:87]
    ds_read2_b32 v[136:137], v40 offset0:104 offset1:105
    ds_read2_b32 v[138:139], v40 offset0:106 offset1:107
    ds_read_b128 v[168:171], v39 offset:1744
    s_waitcnt lgkmcnt(0)
    v_mfma_f32_32x32x16_bf16 v[56:71], v[136:139], v[168:171], v[56:71]
    ds_read_b128 v[172:175], v39 offset:1232
    s_waitcnt lgkmcnt(0)
    v_mfma_f32_32x32x16_bf16 v[72:87], v[136:139], v[172:175], v[72:87]
    ds_read2_b32 v[140:141], v41 offset0:104 offset1:105
    ds_read2_b32 v[142:143], v41 offset0:106 offset1:107
    s_waitcnt lgkmcnt(0)
    v_mfma_f32_32x32x16_bf16 v[72:87], v[140:143], v[168:171], v[72:87]
    ds_read2_b32 v[120:121], v40 offset0:112 offset1:113
    ds_read2_b32 v[122:123], v40 offset0:114 offset1:115
    ds_read_b128 v[152:155], v39 offset:1760
    s_waitcnt lgkmcnt(0)
    v_mfma_f32_32x32x16_bf16 v[56:71], v[120:123], v[152:155], v[56:71]
    ds_read_b128 v[156:159], v39 offset:1248
    s_waitcnt lgkmcnt(0)
    v_mfma_f32_32x32x16_bf16 v[72:87], v[120:123], v[156:159], v[72:87]
    ds_read2_b32 v[124:125], v41 offset0:112 offset1:113
    ds_read2_b32 v[126:127], v41 offset0:114 offset1:115
    s_waitcnt lgkmcnt(0)
    v_mfma_f32_32x32x16_bf16 v[72:87], v[124:127], v[152:155], v[72:87]
    ds_read2_b32 v[136:137], v40 offset0:120 offset1:121
    ds_read2_b32 v[138:139], v40 offset0:122 offset1:123
    ds_read_b128 v[168:171], v39 offset:1776
    s_waitcnt lgkmcnt(0)
    v_mfma_f32_32x32x16_bf16 v[56:71], v[136:139], v[168:171], v[56:71]
    ds_read_b128 v[172:175], v39 offset:1264
    s_waitcnt lgkmcnt(0)
    v_mfma_f32_32x32x16_bf16 v[72:87], v[136:139], v[172:175], v[72:87]
    ds_read2_b32 v[140:141], v41 offset0:120 offset1:121
    ds_read2_b32 v[142:143], v41 offset0:122 offset1:123
    s_waitcnt lgkmcnt(0)
    v_mfma_f32_32x32x16_bf16 v[72:87], v[140:143], v[168:171], v[72:87]
    s_nop 15
    s_setprio 3
    v_add_f32_dpp v56, v64, v56 row_ror:8 row_mask:0xf bank_mask:0xc
    v_add_f32_dpp v57, v65, v57 row_ror:8 row_mask:0xf bank_mask:0xc
    v_add_f32_dpp v58, v66, v58 row_ror:8 row_mask:0xf bank_mask:0xc
    v_add_f32_dpp v59, v67, v59 row_ror:8 row_mask:0xf bank_mask:0xc
    v_add_f32_dpp v60, v68, v60 row_ror:8 row_mask:0xf bank_mask:0xc
    v_add_f32_dpp v61, v69, v61 row_ror:8 row_mask:0xf bank_mask:0xc
    v_add_f32_dpp v62, v70, v62 row_ror:8 row_mask:0xf bank_mask:0xc
    v_add_f32_dpp v63, v71, v63 row_ror:8 row_mask:0xf bank_mask:0xc
    v_cvt_pk_bf16_f32 v56, v56, v57
    v_cvt_pk_bf16_f32 v57, v58, v59
    v_cvt_pk_bf16_f32 v58, v60, v61
    v_cvt_pk_bf16_f32 v59, v62, v63
    ds_write_b128 v44, v[56:59] offset:0
    v_add_f32_dpp v72, v80, v72 row_ror:8 row_mask:0xf bank_mask:0xc
    v_add_f32_dpp v73, v81, v73 row_ror:8 row_mask:0xf bank_mask:0xc
    v_add_f32_dpp v74, v82, v74 row_ror:8 row_mask:0xf bank_mask:0xc
    v_add_f32_dpp v75, v83, v75 row_ror:8 row_mask:0xf bank_mask:0xc
    v_add_f32_dpp v76, v84, v76 row_ror:8 row_mask:0xf bank_mask:0xc
    v_add_f32_dpp v77, v85, v77 row_ror:8 row_mask:0xf bank_mask:0xc
    v_add_f32_dpp v78, v86, v78 row_ror:8 row_mask:0xf bank_mask:0xc
    v_add_f32_dpp v79, v87, v79 row_ror:8 row_mask:0xf bank_mask:0xc
    v_add_f32_dpp v72, v64, v72 row_ror:8 row_mask:0xf bank_mask:0x3
    v_add_f32_dpp v73, v65, v73 row_ror:8 row_mask:0xf bank_mask:0x3
    v_add_f32_dpp v74, v66, v74 row_ror:8 row_mask:0xf bank_mask:0x3
    v_add_f32_dpp v75, v67, v75 row_ror:8 row_mask:0xf bank_mask:0x3
    v_add_f32_dpp v76, v68, v76 row_ror:8 row_mask:0xf bank_mask:0x3
    v_add_f32_dpp v77, v69, v77 row_ror:8 row_mask:0xf bank_mask:0x3
    v_add_f32_dpp v78, v70, v78 row_ror:8 row_mask:0xf bank_mask:0x3
    v_add_f32_dpp v79, v71, v79 row_ror:8 row_mask:0xf bank_mask:0x3
    v_cvt_pk_bf16_f32 v72, v72, v73
    v_cvt_pk_bf16_f32 v73, v74, v75
    v_cvt_pk_bf16_f32 v74, v76, v77
    v_cvt_pk_bf16_f32 v75, v78, v79
    ds_write_b128 v44, v[72:75] offset:1024
    s_setprio 0
    s_waitcnt vmcnt(6) lgkmcnt(0)
    s_barrier
L_seg6:
    s_mul_i32 s7, s67, 3072
    s_add_u32 m0, s7, s63
    s_add_u32 s7, s7, s62
    buffer_load_dwordx4 v16, s[52:55], s7 offen offset:0 sc1 lds
    buffer_load_dwordx4 v16, s[52:55], s7 offen offset:1024 sc1 lds
    buffer_load_dwordx4 v16, s[52:55], s7 offen offset:2048 sc1 lds
    s_cmp_ge_u32 s67, 3
    s_cbranch_scc1 dma_127
    s_mul_i32 s7, s67, 3072
    s_add_u32 s7, s7, 12288
    s_add_u32 m0, s7, s63
    s_add_u32 s7, s7, s62
    buffer_load_dwordx4 v16, s[52:55], s7 offen offset:0 sc1 lds
    buffer_load_dwordx4 v16, s[52:55], s7 offen offset:1024 sc1 lds
    buffer_load_dwordx4 v16, s[52:55], s7 offen offset:2048 sc1 lds
dma_127:
    s_add_u32 s62, s62, 21504
    s_cmp_eq_u32 s62, 303104
    s_cselect_b32 s62, 131072, s62
    s_xor_b32 s63, s63, 21504
    ds_read2st64_b32 v[184:185], v238 offset0:0 offset1:36
    ds_read2st64_b32 v[186:187], v238 offset0:72 offset1:108
    ds_read2st64_b32 v[192:193], v238 offset0:4 offset1:40
    ds_read2st64_b32 v[194:195], v238 offset0:76 offset1:112
    s_waitcnt lgkmcnt(2)
    s_mul_i32 s7, s67, 327680
    s_lshl_b32 s50, s66, 3
    s_add_u32 s7, s7, s50
    s_add_u32 s7, s7, 1280
    v_perm_b32 v188, v185, v184, s60
    v_perm_b32 v189, v187, v186, s60
    buffer_store_dwordx2 v[188:189], v240, s[56:59], s7 offen offset:0
    v_perm_b32 v190, v185, v184, s65
    v_perm_b32 v191, v187, v186, s65
    buffer_store_dwordx2 v[190:191], v240, s[56:59], s7 offen offset:2560
    s_waitcnt lgkmcnt(0)
    s_mul_i32 s7, s67, 327680
    s_lshl_b32 s50, s66, 3
    s_add_u32 s7, s7, s50
    s_add_u32 s7, s7, 1312000
    v_perm_b32 v196, v193, v192, s60
    v_perm_b32 v197, v195, v194, s60
    buffer_store_dwordx2 v[196:197], v240, s[56:59], s7 offen offset:0
    v_perm_b32 v198, v193, v192, s65
    v_perm_b32 v199, v195, v194, s65
    buffer_store_dwordx2 v[198:199], v240, s[56:59], s7 offen offset:2560
    ds_read2_b32 v[120:121], v40 offset0:0 offset1:1
    ds_read2_b32 v[122:123], v40 offset0:2 offset1:3
    ds_read_b128 v[164:167], v39 offset:0
    s_waitcnt lgkmcnt(0)
    v_mfma_f32_32x32x16_bf16 v[104:119], v[120:123], v[164:167], 0
    ds_read_b128 v[160:163], v39 offset:512
    s_waitcnt lgkmcnt(0)
    v_mfma_f32_32x32x16_bf16 v[88:103], v[120:123], v[160:163], 0
    ds_read2_b32 v[136:137], v40 offset0:8 offset1:9
    ds_read2_b32 v[138:139], v40 offset0:10 offset1:11
    ds_read_b128 v[180:183], v39 offset:16
    s_waitcnt lgkmcnt(0)
    v_mfma_f32_32x32x16_bf16 v[104:119], v[136:139], v[180:183], v[104:119]
    ds_read_b128 v[176:179], v39 offset:528
    s_waitcnt lgkmcnt(0)
    v_mfma_f32_32x32x16_bf16 v[88:103], v[136:139], v[176:179], v[88:103]
    ds_read2_b32 v[120:121], v40 offset0:16 offset1:17
    ds_read2_b32 v[122:123], v40 offset0:18 offset1:19
    ds_read_b128 v[164:167], v39 offset:32
    s_waitcnt lgkmcnt(0)
    v_mfma_f32_32x32x16_bf16 v[104:119], v[120:123], v[164:167], v[104:119]
    ds_read_b128 v[160:163], v39 offset:544
    s_waitcnt lgkmcnt(0)
    v_mfma_f32_32x32x16_bf16 v[88:103], v[120:123], v[160:163], v[88:103]
    ds_read2_b32 v[136:137], v40 offset0:24 offset1:25
    ds_read2_b32 v[138:139], v40 offset0:26 offset1:27
    ds_read_b128 v[180:183], v39 offset:48
    s_waitcnt lgkmcnt(0)
    v_mfma_f32_32x32x16_bf16 v[104:119], v[136:139], v[180:183], v[104:119]
    ds_read_b128 v[176:179], v39 offset:560
    s_waitcnt lgkmcnt(0)
    v_mfma_f32_32x32x16_bf16 v[88:103], v[136:139], v[176:179], v[88:103]
    ds_read2_b32 v[120:121], v40 offset0:32 offset1:33
    ds_read2_b32 v[122:123], v40 offset0:34 offset1:35
    ds_read_b128 v[164:167], v39 offset:64
    s_waitcnt lgkmcnt(0)
    v_mfma_f32_32x32x16_bf16 v[104:119], v[120:123], v[164:167], v[104:119]
    ds_read_b128 v[160:163], v39 offset:576
    s_waitcnt lgkmcnt(0)
    v_mfma_f32_32x32x16_bf16 v[88:103], v[120:123], v[160:163], v[88:103]
    ds_read2_b32 v[136:137], v40 offset0:40 offset1:41
    ds_read2_b32 v[138:139], v40 offset0:42 offset1:43
    ds_read_b128 v[180:183], v39 offset:80
    s_waitcnt lgkmcnt(0)
    v_mfma_f32_32x32x16_bf16 v[104:119], v[136:139], v[180:183], v[104:119]
    ds_read_b128 v[176:179], v39 offset:592
    s_waitcnt lgkmcnt(0)
    v_mfma_f32_32x32x16_bf16 v[88:103], v[136:139], v[176:179], v[88:103]
    ds_read2_b32 v[120:121], v40 offset0:48 offset1:49
    ds_read2_b32 v[122:123], v40 offset0:50 offset1:51
    ds_read_b128 v[164:167], v39 offset:96
    s_waitcnt lgkmcnt(0)
    v_mfma_f32_32x32x16_bf16 v[104:119], v[120:123], v[164:167], v[104:119]
    ds_read_b128 v[160:163], v39 offset:608
    s_waitcnt lgkmcnt(0)
    v_mfma_f32_32x32x16_bf16 v[88:103], v[120:123], v[160:163], v[88:103]
    ds_read2_b32 v[136:137], v40 offset0:56 offset1:57
    ds_read2_b32 v[138:139], v40 offset0:58 offset1:59
    ds_read_b128 v[180:183], v39 offset:112
    s_waitcnt lgkmcnt(0)
    v_mfma_f32_32x32x16_bf16 v[104:119], v[136:139], v[180:183], v[104:119]
    ds_read_b128 v[176:179], v39 offset:624
    s_waitcnt lgkmcnt(0)
    v_mfma_f32_32x32x16_bf16 v[88:103], v[136:139], v[176:179], v[88:103]
    s_waitcnt vmcnt(4) lgkmcnt(0)
    s_barrier
L_seg7:
    s_cmp_eq_u32 s67, 3
    s_cbranch_scc1 w7_128
    s_mul_i32 s7, s67, 1
    s_mul_i32 s61, s7, 5120
    s_add_u32 s61, s61, 2048
    s_mul_i32 s68, s7, 40960
    s_mul_i32 s7, s5, 160
    s_add_u32 s68, s68, s7
    s_add_u32 s68, s68, 409600
    s_mov_b32 m0, s61
    s_add_u32 s61, s61, 5120
    s_sub_u32 s7, s68, 819200
    s_cselect_b32 s68, s68, s7
    buffer_load_dwordx4 v18, s[12:15], s68 offen offset:0 lds
    buffer_load_dwordx4 v19, s[12:15], s68 offen offset:1024 lds
    buffer_load_dwordx4 v20, s[12:15], s68 offen offset:2048 lds
    buffer_load_dwordx4 v21, s[12:15], s68 offen offset:3072 lds
    s_add_u32 m0, m0, 4096
    s_nop 0
    buffer_load_dwordx4 v22, s[12:15], s68 offen lds
    s_add_u32 m0, m0, 1024
    s_add_u32 s68, s68, 40960
w7_128:
    s_cmp_ge_u32 s67, 2
    s_cbranch_scc0 uw_129
    s_setprio 3
    v_mov_b32_dpp v216, v232 wave_shr:1 row_mask:0xf bank_mask:0xf
    v_mov_b32_dpp v217, v233 wave_shr:1 row_mask:0xf bank_mask:0xf
    v_perm_b32 v184, v220, v218, s60
    v_perm_b32 v185, v224, v222, s60
    v_perm_b32 v186, v228, v226, s60
    v_perm_b32 v187, v232, v230, s60
    ds_write_b128 v237, v[184:187] offset:0
    v_perm_b32 v188, v218, v216, s60
    v_perm_b32 v189, v222, v220, s60
    v_perm_b32 v190, v226, v224, s60
    v_perm_b32 v191, v230, v228, s60
    ds_write_b128 v237, v[188:191] offset:4576
    v_perm_b32 v192, v220, v218, s65
    v_perm_b32 v193, v224, v222, s65
    v_perm_b32 v194, v228, v226, s65
    v_perm_b32 v195, v232, v230, s65
    ds_write_b128 v237, v[192:195] offset:9216
    v_perm_b32 v196, v218, v216, s65
    v_perm_b32 v197, v222, v220, s65
    v_perm_b32 v198, v226, v224, s65
    v_perm_b32 v199, v230, v228, s65
    ds_write_b128 v237, v[196:199] offset:13792
    v_perm_b32 v200, v221, v219, s60
    v_perm_b32 v201, v225, v223, s60
    v_perm_b32 v202, v229, v227, s60
    v_perm_b32 v203, v233, v231, s60
    ds_write_b128 v237, v[200:203] offset:18432
    v_perm_b32 v204, v219, v217, s60
    v_perm_b32 v205, v223, v221, s60
    v_perm_b32 v206, v227, v225, s60
    v_perm_b32 v207, v231, v229, s60
    ds_write_b128 v237, v[204:207] offset:23008
    v_perm_b32 v208, v221, v219, s65
    v_perm_b32 v209, v225, v223, s65
    v_perm_b32 v210, v229, v227, s65
    v_perm_b32 v211, v233, v231, s65
    ds_write_b128 v237, v[208:211] offset:27648
    v_perm_b32 v212, v219, v217, s65
    v_perm_b32 v213, v223, v221, s65
    v_perm_b32 v214, v227, v225, s65
    v_perm_b32 v215, v231, v229, s65
    ds_write_b128 v237, v[212:215] offset:32224
    s_cmp_eq_u32 s67, 3
    s_cselect_b32 exec_lo, 0x00ff00ff, -1
    s_mov_b32 exec_hi, 0
    ds_read_b128 v[216:219], v241 offset:480
    s_waitcnt lgkmcnt(0)
    ds_write_b128 v241, v[216:219] offset:544
    s_mov_b64 exec, -1
    s_setprio 0
uw_129:
    ds_read2_b32 v[120:121], v40 offset0:64 offset1:65
    ds_read2_b32 v[122:123], v40 offset0:66 offset1:67
    ds_read_b128 v[164:167], v39 offset:128
    s_waitcnt lgkmcnt(0)
    v_mfma_f32_32x32x16_bf16 v[104:119], v[120:123], v[164:167], v[104:119]
    ds_read_b128 v[160:163], v39 offset:640
    s_waitcnt lgkmcnt(0)
    v_mfma_f32_32x32x16_bf16 v[88:103], v[120:123], v[160:163], v[88:103]
    ds_read2_b32 v[136:137], v40 offset0:72 offset1:73
    ds_read2_b32 v[138:139], v40 offset0:74 offset1:75
    ds_read_b128 v[180:183], v39 offset:144
    s_waitcnt lgkmcnt(0)
    v_mfma_f32_32x32x16_bf16 v[104:119], v[136:139], v[180:183], v[104:119]
    ds_read_b128 v[176:179], v39 offset:656
    s_waitcnt lgkmcnt(0)
    v_mfma_f32_32x32x16_bf16 v[88:103], v[136:139], v[176:179], v[88:103]
    ds_read2_b32 v[120:121], v40 offset0:80 offset1:81
    ds_read2_b32 v[122:123], v40 offset0:82 offset1:83
    ds_read_b128 v[164:167], v39 offset:160
    s_waitcnt lgkmcnt(0)
    v_mfma_f32_32x32x16_bf16 v[104:119], v[120:123], v[164:167], v[104:119]
    ds_read_b128 v[160:163], v39 offset:672
    s_waitcnt lgkmcnt(0)
    v_mfma_f32_32x32x16_bf16 v[88:103], v[120:123], v[160:163], v[88:103]
    ds_read2_b32 v[136:137], v40 offset0:88 offset1:89
    ds_read2_b32 v[138:139], v40 offset0:90 offset1:91
    ds_read_b128 v[180:183], v39 offset:176
    s_waitcnt lgkmcnt(0)
    v_mfma_f32_32x32x16_bf16 v[104:119], v[136:139], v[180:183], v[104:119]
    ds_read_b128 v[176:179], v39 offset:688
    s_waitcnt lgkmcnt(0)
    v_mfma_f32_32x32x16_bf16 v[88:103], v[136:139], v[176:179], v[88:103]
    ds_read2_b32 v[120:121], v40 offset0:96 offset1:97
    ds_read2_b32 v[122:123], v40 offset0:98 offset1:99
    ds_read_b128 v[164:167], v39 offset:192
    s_waitcnt lgkmcnt(0)
    v_mfma_f32_32x32x16_bf16 v[104:119], v[120:123], v[164:167], v[104:119]
    ds_read_b128 v[160:163], v39 offset:704
    s_waitcnt lgkmcnt(0)
    v_mfma_f32_32x32x16_bf16 v[88:103], v[120:123], v[160:163], v[88:103]
    ds_read2_b32 v[136:137], v40 offset0:104 offset1:105
    ds_read2_b32 v[138:139], v40 offset0:106 offset1:107
    ds_read_b128 v[180:183], v39 offset:208
    s_waitcnt lgkmcnt(0)
    v_mfma_f32_32x32x16_bf16 v[104:119], v[136:139], v[180:183], v[104:119]
    ds_read_b128 v[176:179], v39 offset:720
    s_waitcnt lgkmcnt(0)
    v_mfma_f32_32x32x16_bf16 v[88:103], v[136:139], v[176:179], v[88:103]
    ds_read2_b32 v[120:121], v40 offset0:112 offset1:113
    ds_read2_b32 v[122:123], v40 offset0:114 offset1:115
    ds_read_b128 v[164:167], v39 offset:224
    s_waitcnt lgkmcnt(0)
    v_mfma_f32_32x32x16_bf16 v[104:119], v[120:123], v[164:167], v[104:119]
    ds_read_b128 v[160:163], v39 offset:736
    s_waitcnt lgkmcnt(0)
    v_mfma_f32_32x32x16_bf16 v[88:103], v[120:123], v[160:163], v[88:103]
    ds_read2_b32 v[136:137], v40 offset0:120 offset1:121
    ds_read2_b32 v[138:139], v40 offset0:122 offset1:123
    ds_read_b128 v[180:183], v39 offset:240
    s_waitcnt lgkmcnt(0)
    v_mfma_f32_32x32x16_bf16 v[104:119], v[136:139], v[180:183], v[104:119]
    ds_read_b128 v[176:179], v39 offset:752
    s_waitcnt lgkmcnt(0)
    v_mfma_f32_32x32x16_bf16 v[88:103], v[136:139], v[176:179], v[88:103]
    s_waitcnt vmcnt(0) lgkmcnt(0)
    s_cmp_lg_u32 s67, 0
    s_cbranch_scc1 f8_131
    s_lshl_b32 s7, s2, 7
    s_lshl_b32 s50, s67, 2
    s_add_u32 s7, s7, s50
    s_add_u32 s7, s7, 65536
    v_mov_b32 v8, s6
    s_mov_b64 exec, 1
    buffer_store_dword v8, off, s[52:55], s7 sc1
    s_mov_b64 exec, -1
f8_131:
    s_barrier
L_seg8:
    ds_read_b128 v[160:163], v39 offset:512
    ds_read2_b32 v[124:125], v41 offset0:0 offset1:1
    ds_read2_b32 v[126:127], v41 offset0:2 offset1:3
    ds_read_b128 v[156:159], v39 offset:1024
    ds_read2_b32 v[128:129], v42 offset0:0 offset1:1
    ds_read2_b32 v[130:131], v42 offset0:2 offset1:3
    ds_read_b128 v[152:155], v39 offset:1536
    s_mul_i32 s7, s67, 1
    s_add_u32 s7, s7, 3
    s_mul_i32 s61, s7, 5120
    s_add_u32 s61, s61, 2048
    s_mul_i32 s68, s7, 40960
    s_mul_i32 s7, s5, 160
    s_add_u32 s68, s68, s7
    s_add_u32 s68, s68, 409600
    s_mov_b32 m0, s61
    s_add_u32 s61, s61, 5120
    s_sub_u32 s7, s68, 819200
    s_cselect_b32 s68, s68, s7
    buffer_load_dwordx4 v18, s[12:15], s68 offen offset:0 lds
    buffer_load_dwordx4 v19, s[12:15], s68 offen offset:1024 lds
    buffer_load_dwordx4 v20, s[12:15], s68 offen offset:2048 lds
    buffer_load_dwordx4 v21, s[12:15], s68 offen offset:3072 lds
    s_add_u32 m0, m0, 4096
    s_nop 0
    buffer_load_dwordx4 v22, s[12:15], s68 offen lds
    s_add_u32 m0, m0, 1024
    s_add_u32 s68, s68, 40960
    s_cmp_lg_u32 s67, 3
    s_cbranch_scc1 w8_132
    s_mov_b32 m0, s61
    s_add_u32 s61, s61, 5120
    s_sub_u32 s7, s68, 819200
    s_cselect_b32 s68, s68, s7
    buffer_load_dwordx4 v18, s[12:15], s68 offen offset:0 lds
    buffer_load_dwordx4 v19, s[12:15], s68 offen offset:1024 lds
    buffer_load_dwordx4 v20, s[12:15], s68 offen offset:2048 lds
    buffer_load_dwordx4 v21, s[12:15], s68 offen offset:3072 lds
    s_add_u32 m0, m0, 4096
    s_nop 0
    buffer_load_dwordx4 v22, s[12:15], s68 offen lds
    s_add_u32 m0, m0, 1024
    s_add_u32 s68, s68, 40960
w8_132:
    s_setprio 1
    s_waitcnt lgkmcnt(4)
    v_mfma_f32_32x32x16_bf16 v[104:119], v[124:127], v[160:163], v[104:119]
    ds_read_b128 v[176:179], v39 offset:528
    ds_read2_b32 v[140:141], v41 offset0:8 offset1:9
    ds_read2_b32 v[142:143], v41 offset0:10 offset1:11
    s_waitcnt lgkmcnt(6)
    v_mfma_f32_32x32x16_bf16 v[88:103], v[124:127], v[156:159], v[88:103]
    ds_read_b128 v[172:175], v39 offset:1040
    ds_read2_b32 v[144:145], v42 offset0:8 offset1:9
    ds_read2_b32 v[146:147], v42 offset0:10 offset1:11
    s_waitcnt lgkmcnt(7)
    v_mfma_f32_32x32x16_bf16 v[104:119], v[128:131], v[156:159], v[104:119]
    ds_read_b128 v[168:171], v39 offset:1552
    s_waitcnt lgkmcnt(7)
    v_mfma_f32_32x32x16_bf16 v[88:103], v[128:131], v[152:155], v[88:103]
    s_waitcnt lgkmcnt(4)
    v_mfma_f32_32x32x16_bf16 v[104:119], v[140:143], v[176:179], v[104:119]
    ds_read_b128 v[160:163], v39 offset:544
    ds_read2_b32 v[124:125], v41 offset0:16 offset1:17
    ds_read2_b32 v[126:127], v41 offset0:18 offset1:19
    s_waitcnt lgkmcnt(6)
    v_mfma_f32_32x32x16_bf16 v[88:103], v[140:143], v[172:175], v[88:103]
    ds_read_b128 v[156:159], v39 offset:1056
    ds_read2_b32 v[128:129], v42 offset0:16 offset1:17
    ds_read2_b32 v[130:131], v42 offset0:18 offset1:19
    s_waitcnt lgkmcnt(7)
    v_mfma_f32_32x32x16_bf16 v[104:119], v[144:147], v[172:175], v[104:119]
    ds_read_b128 v[152:155], v39 offset:1568
    s_waitcnt lgkmcnt(7)
    v_mfma_f32_32x32x16_bf16 v[88:103], v[144:147], v[168:171], v[88:103]
    s_waitcnt lgkmcnt(4)
    v_mfma_f32_32x32x16_bf16 v[104:119], v[124:127], v[160:163], v[104:119]
    ds_read_b128 v[176:179], v39 offset:560
    ds_read2_b32 v[140:141], v41 offset0:24 offset1:25
    ds_read2_b32 v[142:143], v41 offset0:26 offset1:27
    s_waitcnt lgkmcnt(6)
    v_mfma_f32_32x32x16_bf16 v[88:103], v[124:127], v[156:159], v[88:103]
    ds_read_b128 v[172:175], v39 offset:1072
    ds_read2_b32 v[144:145], v42 offset0:24 offset1:25
    ds_read2_b32 v[146:147], v42 offset0:26 offset1:27
    s_waitcnt lgkmcnt(7)
    v_mfma_f32_32x32x16_bf16 v[104:119], v[128:131], v[156:159], v[104:119]
    ds_read_b128 v[168:171], v39 offset:1584
    s_waitcnt lgkmcnt(7)
    v_mfma_f32_32x32x16_bf16 v[88:103], v[128:131], v[152:155], v[88:103]
    s_waitcnt lgkmcnt(4)
    v_mfma_f32_32x32x16_bf16 v[104:119], v[140:143], v[176:179], v[104:119]
    ds_read_b128 v[160:163], v39 offset:576
    ds_read2_b32 v[124:125], v41 offset0:32 offset1:33
    ds_read2_b32 v[126:127], v41 offset0:34 offset1:35
    s_waitcnt lgkmcnt(6)
    v_mfma_f32_32x32x16_bf16 v[88:103], v[140:143], v[172:175], v[88:103]
    ds_read_b128 v[156:159], v39 offset:1088
    ds_read2_b32 v[128:129], v42 offset0:32 offset1:33
    ds_read2_b32 v[130:131], v42 offset0:34 offset1:35
    s_waitcnt lgkmcnt(7)
    v_mfma_f32_32x32x16_bf16 v[104:119], v[144:147], v[172:175], v[104:119]
    ds_read_b128 v[152:155], v39 offset:1600
    s_waitcnt lgkmcnt(7)
    v_mfma_f32_32x32x16_bf16 v[88:103], v[144:147], v[168:171], v[88:103]
    s_waitcnt lgkmcnt(4)
    v_mfma_f32_32x32x16_bf16 v[104:119], v[124:127], v[160:163], v[104:119]
    ds_read_b128 v[176:179], v39 offset:592
    ds_read2_b32 v[140:141], v41 offset0:40 offset1:41
    ds_read2_b32 v[142:143], v41 offset0:42 offset1:43
    s_waitcnt lgkmcnt(6)
    v_mfma_f32_32x32x16_bf16 v[88:103], v[124:127], v[156:159], v[88:103]
    ds_read_b128 v[172:175], v39 offset:1104
    ds_read2_b32 v[144:145], v42 offset0:40 offset1:41
    ds_read2_b32 v[146:147], v42 offset0:42 offset1:43
    s_waitcnt lgkmcnt(7)
    v_mfma_f32_32x32x16_bf16 v[104:119], v[128:131], v[156:159], v[104:119]
    ds_read_b128 v[168:171], v39 offset:1616
    s_waitcnt lgkmcnt(7)
    v_mfma_f32_32x32x16_bf16 v[88:103], v[128:131], v[152:155], v[88:103]
    s_waitcnt lgkmcnt(4)
    v_mfma_f32_32x32x16_bf16 v[104:119], v[140:143], v[176:179], v[104:119]
    ds_read_b128 v[160:163], v39 offset:608
    ds_read2_b32 v[124:125], v41 offset0:48 offset1:49
    ds_read2_b32 v[126:127], v41 offset0:50 offset1:51
    s_waitcnt lgkmcnt(6)
    v_mfma_f32_32x32x16_bf16 v[88:103], v[140:143], v[172:175], v[88:103]
    ds_read_b128 v[156:159], v39 offset:1120
    ds_read2_b32 v[128:129], v42 offset0:48 offset1:49
    ds_read2_b32 v[130:131], v42 offset0:50 offset1:51
    s_waitcnt lgkmcnt(7)
    v_mfma_f32_32x32x16_bf16 v[104:119], v[144:147], v[172:175], v[104:119]
    ds_read_b128 v[152:155], v39 offset:1632
    s_waitcnt lgkmcnt(7)
    v_mfma_f32_32x32x16_bf16 v[88:103], v[144:147], v[168:171], v[88:103]
    s_waitcnt lgkmcnt(4)
    v_mfma_f32_32x32x16_bf16 v[104:119], v[124:127], v[160:163], v[104:119]
    ds_read_b128 v[176:179], v39 offset:624
    ds_read2_b32 v[140:141], v41 offset0:56 offset1:57
    ds_read2_b32 v[142:143], v41 offset0:58 offset1:59
    s_waitcnt lgkmcnt(6)
    v_mfma_f32_32x32x16_bf16 v[88:103], v[124:127], v[156:159], v[88:103]
    ds_read_b128 v[172:175], v39 offset:1136
    ds_read2_b32 v[144:145], v42 offset0:56 offset1:57
    ds_read2_b32 v[146:147], v42 offset0:58 offset1:59
    s_waitcnt lgkmcnt(7)
    v_mfma_f32_32x32x16_bf16 v[104:119], v[128:131], v[156:159], v[104:119]
    ds_read_b128 v[168:171], v39 offset:1648
    s_waitcnt lgkmcnt(7)
    v_mfma_f32_32x32x16_bf16 v[88:103], v[128:131], v[152:155], v[88:103]
    s_waitcnt lgkmcnt(4)
    v_mfma_f32_32x32x16_bf16 v[104:119], v[140:143], v[176:179], v[104:119]
    ds_read_b128 v[160:163], v39 offset:640
    ds_read2_b32 v[124:125], v41 offset0:64 offset1:65
    ds_read2_b32 v[126:127], v41 offset0:66 offset1:67
    s_waitcnt lgkmcnt(6)
    v_mfma_f32_32x32x16_bf16 v[88:103], v[140:143], v[172:175], v[88:103]
    ds_read_b128 v[156:159], v39 offset:1152
    ds_read2_b32 v[128:129], v42 offset0:64 offset1:65
    ds_read2_b32 v[130:131], v42 offset0:66 offset1:67
    s_waitcnt lgkmcnt(7)
    v_mfma_f32_32x32x16_bf16 v[104:119], v[144:147], v[172:175], v[104:119]
    ds_read_b128 v[152:155], v39 offset:1664
    s_waitcnt lgkmcnt(7)
    v_mfma_f32_32x32x16_bf16 v[88:103], v[144:147], v[168:171], v[88:103]
    s_waitcnt lgkmcnt(4)
    v_mfma_f32_32x32x16_bf16 v[104:119], v[124:127], v[160:163], v[104:119]
    ds_read_b128 v[176:179], v39 offset:656
    ds_read2_b32 v[140:141], v41 offset0:72 offset1:73
    ds_read2_b32 v[142:143], v41 offset0:74 offset1:75
    s_waitcnt lgkmcnt(6)
    v_mfma_f32_32x32x16_bf16 v[88:103], v[124:127], v[156:159], v[88:103]
    ds_read_b128 v[172:175], v39 offset:1168
    ds_read2_b32 v[144:145], v42 offset0:72 offset1:73
    ds_read2_b32 v[146:147], v42 offset0:74 offset1:75
    s_waitcnt lgkmcnt(7)
    v_mfma_f32_32x32x16_bf16 v[104:119], v[128:131], v[156:159], v[104:119]
    ds_read_b128 v[168:171], v39 offset:1680
    s_waitcnt lgkmcnt(7)
    v_mfma_f32_32x32x16_bf16 v[88:103], v[128:131], v[152:155], v[88:103]
    s_waitcnt vmcnt(0)
    v_mov_b32 v12, 104448
    v_mov_b32 v13, 1
    s_mov_b64 exec, 1
    ds_add_u32 v12, v13 offset:0
    s_mov_b64 exec, -1
    s_waitcnt lgkmcnt(5)
    v_mfma_f32_32x32x16_bf16 v[104:119], v[140:143], v[176:179], v[104:119]
    ds_read_b128 v[160:163], v39 offset:672
    ds_read2_b32 v[124:125], v41 offset0:80 offset1:81
    ds_read2_b32 v[126:127], v41 offset0:82 offset1:83
    s_waitcnt lgkmcnt(7)
    v_mfma_f32_32x32x16_bf16 v[88:103], v[140:143], v[172:175], v[88:103]
    ds_read_b128 v[156:159], v39 offset:1184
    ds_read2_b32 v[128:129], v42 offset0:80 offset1:81
    ds_read2_b32 v[130:131], v42 offset0:82 offset1:83
    s_waitcnt lgkmcnt(8)
    v_mfma_f32_32x32x16_bf16 v[104:119], v[144:147], v[172:175], v[104:119]
    ds_read_b128 v[152:155], v39 offset:1696
    s_waitcnt lgkmcnt(8)
    v_mfma_f32_32x32x16_bf16 v[88:103], v[144:147], v[168:171], v[88:103]
    s_waitcnt lgkmcnt(4)
    v_mfma_f32_32x32x16_bf16 v[104:119], v[124:127], v[160:163], v[104:119]
    ds_read_b128 v[176:179], v39 offset:688
    ds_read2_b32 v[140:141], v41 offset0:88 offset1:89
    ds_read2_b32 v[142:143], v41 offset0:90 offset1:91
    s_waitcnt lgkmcnt(6)
    v_mfma_f32_32x32x16_bf16 v[88:103], v[124:127], v[156:159], v[88:103]
    ds_read_b128 v[172:175], v39 offset:1200
    ds_read2_b32 v[144:145], v42 offset0:88 offset1:89
    ds_read2_b32 v[146:147], v42 offset0:90 offset1:91
    s_waitcnt lgkmcnt(7)
    v_mfma_f32_32x32x16_bf16 v[104:119], v[128:131], v[156:159], v[104:119]
    ds_read_b128 v[168:171], v39 offset:1712
    s_waitcnt lgkmcnt(7)
    v_mfma_f32_32x32x16_bf16 v[88:103], v[128:131], v[152:155], v[88:103]
    s_waitcnt lgkmcnt(4)
    v_mfma_f32_32x32x16_bf16 v[104:119], v[140:143], v[176:179], v[104:119]
    ds_read_b128 v[160:163], v39 offset:704
    ds_read2_b32 v[124:125], v41 offset0:96 offset1:97
    ds_read2_b32 v[126:127], v41 offset0:98 offset1:99
    s_waitcnt lgkmcnt(6)
    v_mfma_f32_32x32x16_bf16 v[88:103], v[140:143], v[172:175], v[88:103]
    ds_read_b128 v[156:159], v39 offset:1216
    ds_read2_b32 v[128:129], v42 offset0:96 offset1:97
    ds_read2_b32 v[130:131], v42 offset0:98 offset1:99
    s_waitcnt lgkmcnt(7)
    v_mfma_f32_32x32x16_bf16 v[104:119], v[144:147], v[172:175], v[104:119]
    ds_read_b128 v[152:155], v39 offset:1728
    s_waitcnt lgkmcnt(7)
    v_mfma_f32_32x32x16_bf16 v[88:103], v[144:147], v[168:171], v[88:103]
    s_waitcnt lgkmcnt(4)
    v_mfma_f32_32x32x16_bf16 v[104:119], v[124:127], v[160:163], v[104:119]
    ds_read_b128 v[176:179], v39 offset:720
    ds_read2_b32 v[140:141], v41 offset0:104 offset1:105
    ds_read2_b32 v[142:143], v41 offset0:106 offset1:107
    s_waitcnt lgkmcnt(6)
    v_mfma_f32_32x32x16_bf16 v[88:103], v[124:127], v[156:159], v[88:103]
    ds_read_b128 v[172:175], v39 offset:1232
    ds_read2_b32 v[144:145], v42 offset0:104 offset1:105
    ds_read2_b32 v[146:147], v42 offset0:106 offset1:107
    s_waitcnt lgkmcnt(7)
    v_mfma_f32_32x32x16_bf16 v[104:119], v[128:131], v[156:159], v[104:119]
    ds_read_b128 v[168:171], v39 offset:1744
    s_waitcnt lgkmcnt(7)
    v_mfma_f32_32x32x16_bf16 v[88:103], v[128:131], v[152:155], v[88:103]
    s_waitcnt lgkmcnt(4)
    v_mfma_f32_32x32x16_bf16 v[104:119], v[140:143], v[176:179], v[104:119]
    ds_read_b128 v[160:163], v39 offset:736
    ds_read2_b32 v[124:125], v41 offset0:112 offset1:113
    ds_read2_b32 v[126:127], v41 offset0:114 offset1:115
    s_waitcnt lgkmcnt(6)
    v_mfma_f32_32x32x16_bf16 v[88:103], v[140:143], v[172:175], v[88:103]
    ds_read_b128 v[156:159], v39 offset:1248
    ds_read2_b32 v[128:129], v42 offset0:112 offset1:113
    ds_read2_b32 v[130:131], v42 offset0:114 offset1:115
    s_waitcnt lgkmcnt(7)
    v_mfma_f32_32x32x16_bf16 v[104:119], v[144:147], v[172:175], v[104:119]
    ds_read_b128 v[152:155], v39 offset:1760
    s_waitcnt lgkmcnt(7)
    v_mfma_f32_32x32x16_bf16 v[88:103], v[144:147], v[168:171], v[88:103]
    s_waitcnt lgkmcnt(4)
    v_mfma_f32_32x32x16_bf16 v[104:119], v[124:127], v[160:163], v[104:119]
    ds_read_b128 v[172:175], v39 offset:1264
    ds_read2_b32 v[140:141], v41 offset0:120 offset1:121
    ds_read2_b32 v[142:143], v41 offset0:122 offset1:123
    s_waitcnt lgkmcnt(6)
    v_mfma_f32_32x32x16_bf16 v[88:103], v[124:127], v[156:159], v[88:103]
    ds_read_b128 v[168:171], v39 offset:1776
    ds_read2_b32 v[144:145], v42 offset0:120 offset1:121
    ds_read2_b32 v[146:147], v42 offset0:122 offset1:123
    s_waitcnt lgkmcnt(7)
    v_mfma_f32_32x32x16_bf16 v[104:119], v[128:131], v[156:159], v[104:119]
    ds_read_b128 v[176:179], v39 offset:752
    s_waitcnt lgkmcnt(7)
    v_mfma_f32_32x32x16_bf16 v[88:103], v[128:131], v[152:155], v[88:103]
    s_waitcnt lgkmcnt(4)
    v_mfma_f32_32x32x16_bf16 v[88:103], v[140:143], v[172:175], v[88:103]
    ds_read_b128 v[152:155], v39 offset:1536
    ds_read2_b32 v[120:121], v43 offset0:0 offset1:1
    ds_read2_b32 v[122:123], v43 offset0:2 offset1:3
    s_waitcnt lgkmcnt(4)
    v_mfma_f32_32x32x16_bf16 v[88:103], v[144:147], v[168:171], v[88:103]
    ds_read_b128 v[156:159], v39 offset:1552
    ds_read2_b32 v[124:125], v43 offset0:8 offset1:9
    ds_read2_b32 v[126:127], v43 offset0:10 offset1:11
    s_waitcnt lgkmcnt(6)
    v_mfma_f32_32x32x16_bf16 v[104:119], v[140:143], v[176:179], v[104:119]
    ds_read_b128 v[160:163], v39 offset:1568
    ds_read2_b32 v[128:129], v43 offset0:16 offset1:17
    ds_read2_b32 v[130:131], v43 offset0:18 offset1:19
    v_mfma_f32_32x32x16_bf16 v[104:119], v[144:147], v[172:175], v[104:119]
    ds_read_b128 v[164:167], v39 offset:1584
    ds_read2_b32 v[132:133], v43 offset0:24 offset1:25
    ds_read2_b32 v[134:135], v43 offset0:26 offset1:27
    s_waitcnt lgkmcnt(9)
    v_mfma_f32_32x32x16_bf16 v[104:119], v[120:123], v[152:155], v[104:119]
    ds_read_b128 v[168:171], v39 offset:1600
    ds_read2_b32 v[136:137], v43 offset0:32 offset1:33
    ds_read2_b32 v[138:139], v43 offset0:34 offset1:35
    v_add_f32_dpp v88, v96, v88 row_ror:8 row_mask:0xf bank_mask:0xc
    v_add_f32_dpp v89, v97, v89 row_ror:8 row_mask:0xf bank_mask:0xc
    v_add_f32_dpp v90, v98, v90 row_ror:8 row_mask:0xf bank_mask:0xc
    v_add_f32_dpp v91, v99, v91 row_ror:8 row_mask:0xf bank_mask:0xc
    v_add_f32_dpp v92, v100, v92 row_ror:8 row_mask:0xf bank_mask:0xc
    s_waitcnt lgkmcnt(9)
    v_mfma_f32_32x32x16_bf16 v[104:119], v[124:127], v[156:159], v[104:119]
    ds_read_b128 v[172:175], v39 offset:1616
    ds_read2_b32 v[140:141], v43 offset0:40 offset1:41
    ds_read2_b32 v[142:143], v43 offset0:42 offset1:43
    v_add_f32_dpp v93, v101, v93 row_ror:8 row_mask:0xf bank_mask:0xc
    v_add_f32_dpp v94, v102, v94 row_ror:8 row_mask:0xf bank_mask:0xc
    v_add_f32_dpp v95, v103, v95 row_ror:8 row_mask:0xf bank_mask:0xc
    v_add_f32_dpp v88, v80, v88 row_ror:8 row_mask:0xf bank_mask:0x3
    v_add_f32_dpp v89, v81, v89 row_ror:8 row_mask:0xf bank_mask:0x3
    s_waitcnt lgkmcnt(9)
    v_mfma_f32_32x32x16_bf16 v[104:119], v[128:131], v[160:163], v[104:119]
    ds_read_b128 v[176:179], v39 offset:1632
    ds_read2_b32 v[144:145], v43 offset0:48 offset1:49
    ds_read2_b32 v[146:147], v43 offset0:50 offset1:51
    v_add_f32_dpp v90, v82, v90 row_ror:8 row_mask:0xf bank_mask:0x3
    v_add_f32_dpp v91, v83, v91 row_ror:8 row_mask:0xf bank_mask:0x3
    v_add_f32_dpp v92, v84, v92 row_ror:8 row_mask:0xf bank_mask:0x3
    v_add_f32_dpp v93, v85, v93 row_ror:8 row_mask:0xf bank_mask:0x3
    v_add_f32_dpp v94, v86, v94 row_ror:8 row_mask:0xf bank_mask:0x3
    s_waitcnt lgkmcnt(9)
    v_mfma_f32_32x32x16_bf16 v[104:119], v[132:135], v[164:167], v[104:119]
    ds_read_b128 v[180:183], v39 offset:1648
    ds_read2_b32 v[148:149], v43 offset0:56 offset1:57
    ds_read2_b32 v[150:151], v43 offset0:58 offset1:59
    v_add_f32_dpp v95, v87, v95 row_ror:8 row_mask:0xf bank_mask:0x3
    v_cvt_pk_bf16_f32 v88, v88, v89
    v_cvt_pk_bf16_f32 v89, v90, v91
    v_cvt_pk_bf16_f32 v90, v92, v93
    v_cvt_pk_bf16_f32 v91, v94, v95
    ds_write_b128 v45, v[88:91] offset:0
    v_mov_b32 v12, 104448
    v_mov_b32 v13, 1
    s_mov_b64 exec, 1
    ds_add_u32 v12, v13 offset:4
    s_mov_b64 exec, -1
    s_waitcnt lgkmcnt(11)
    v_mfma_f32_32x32x16_bf16 v[104:119], v[136:139], v[168:171], v[104:119]
    ds_read_b128 v[152:155], v39 offset:1664
    ds_read2_b32 v[120:121], v43 offset0:64 offset1:65
    ds_read2_b32 v[122:123], v43 offset0:66 offset1:67
    s_waitcnt lgkmcnt(11)
    v_mfma_f32_32x32x16_bf16 v[104:119], v[140:143], v[172:175], v[104:119]
    ds_read_b128 v[156:159], v39 offset:1680
    ds_read2_b32 v[124:125], v43 offset0:72 offset1:73
    ds_read2_b32 v[126:127], v43 offset0:74 offset1:75
    s_waitcnt lgkmcnt(11)
    v_mfma_f32_32x32x16_bf16 v[104:119], v[144:147], v[176:179], v[104:119]
    ds_read_b128 v[160:163], v39 offset:1696
    ds_read2_b32 v[128:129], v43 offset0:80 offset1:81
    ds_read2_b32 v[130:131], v43 offset0:82 offset1:83
    s_waitcnt lgkmcnt(11)
    v_mfma_f32_32x32x16_bf16 v[104:119], v[148:151], v[180:183], v[104:119]
    ds_read_b128 v[164:167], v39 offset:1712
    ds_read2_b32 v[132:133], v43 offset0:88 offset1:89
    ds_read2_b32 v[134:135], v43 offset0:90 offset1:91
    s_waitcnt lgkmcnt(9)
    v_mfma_f32_32x32x16_bf16 v[104:119], v[120:123], v[152:155], v[104:119]
    ds_read_b128 v[168:171], v39 offset:1728
    ds_read2_b32 v[136:137], v43 offset0:96 offset1:97
    ds_read2_b32 v[138:139], v43 offset0:98 offset1:99
    s_waitcnt lgkmcnt(9)
    v_mfma_f32_32x32x16_bf16 v[104:119], v[124:127], v[156:159], v[104:119]
    ds_read_b128 v[172:175], v39 offset:1744
    ds_read2_b32 v[140:141], v43 offset0:104 offset1:105
    ds_read2_b32 v[142:143], v43 offset0:106 offset1:107
    s_waitcnt lgkmcnt(9)
    v_mfma_f32_32x32x16_bf16 v[104:119], v[128:131], v[160:163], v[104:119]
    ds_read_b128 v[176:179], v39 offset:1760
    ds_read2_b32 v[144:145], v43 offset0:112 offset1:113
    ds_read2_b32 v[146:147], v43 offset0:114 offset1:115
    s_waitcnt lgkmcnt(9)
    v_mfma_f32_32x32x16_bf16 v[104:119], v[132:135], v[164:167], v[104:119]
    ds_read_b128 v[180:183], v39 offset:1776
    ds_read2_b32 v[148:149], v43 offset0:120 offset1:121
    ds_read2_b32 v[150:151], v43 offset0:122 offset1:123
    s_waitcnt lgkmcnt(9)
    v_mfma_f32_32x32x16_bf16 v[104:119], v[136:139], v[168:171], v[104:119]
    s_waitcnt lgkmcnt(6)
    v_mfma_f32_32x32x16_bf16 v[104:119], v[140:143], v[172:175], v[104:119]
    s_waitcnt lgkmcnt(3)
    v_mfma_f32_32x32x16_bf16 v[104:119], v[144:147], v[176:179], v[104:119]
    s_waitcnt lgkmcnt(0)
    v_mfma_f32_32x32x16_bf16 v[104:119], v[148:151], v[180:183], v[104:119]
    v_mov_b32 v12, 104448
    s_mov_b32 s64, 800000
tw_133:
    ds_read_b32 v13, v12 offset:4
    s_sub_u32 s64, s64, 1
    s_cbranch_scc1 twd_134
    s_waitcnt lgkmcnt(0)
    v_cmp_gt_u32 vcc, 4, v13
    s_cbranch_vccnz tw_133
twd_134:
    ds_read2st64_b32 v[184:185], v239 offset0:0 offset1:18
    ds_read2st64_b32 v[186:187], v239 offset0:36 offset1:54
    s_waitcnt lgkmcnt(0)
    s_mul_i32 s7, s67, 327680
    s_lshl_b32 s50, s66, 3
    s_add_u32 s7, s7, s50
    s_add_u32 s7, s7, 2622720
    v_perm_b32 v188, v185, v184, s60
    v_perm_b32 v189, v187, v186, s60
    buffer_store_dwordx2 v[188:189], v240, s[56:59], s7 offen offset:0
    v_perm_b32 v190, v185, v184, s65
    v_perm_b32 v191, v187, v186, s65
    buffer_store_dwordx2 v[190:191], v240, s[56:59], s7 offen offset:2560
    s_setprio 1
    v_add_f32_dpp v104, v112, v104 row_ror:8 row_mask:0xf bank_mask:0xc
    v_add_f32_dpp v105, v113, v105 row_ror:8 row_mask:0xf bank_mask:0xc
    v_add_f32_dpp v106, v114, v106 row_ror:8 row_mask:0xf bank_mask:0xc
    v_add_f32_dpp v107, v115, v107 row_ror:8 row_mask:0xf bank_mask:0xc
    v_add_f32_dpp v108, v116, v108 row_ror:8 row_mask:0xf bank_mask:0xc
    v_add_f32_dpp v109, v117, v109 row_ror:8 row_mask:0xf bank_mask:0xc
    v_add_f32_dpp v110, v118, v110 row_ror:8 row_mask:0xf bank_mask:0xc
    v_add_f32_dpp v111, v119, v111 row_ror:8 row_mask:0xf bank_mask:0xc
    v_add_f32_dpp v104, v96, v104 row_ror:8 row_mask:0xf bank_mask:0x3
    v_add_f32_dpp v105, v97, v105 row_ror:8 row_mask:0xf bank_mask:0x3
    v_add_f32_dpp v106, v98, v106 row_ror:8 row_mask:0xf bank_mask:0x3
    v_add_f32_dpp v107, v99, v107 row_ror:8 row_mask:0xf bank_mask:0x3
    v_add_f32_dpp v108, v100, v108 row_ror:8 row_mask:0xf bank_mask:0x3
    v_add_f32_dpp v109, v101, v109 row_ror:8 row_mask:0xf bank_mask:0x3
    v_add_f32_dpp v110, v102, v110 row_ror:8 row_mask:0xf bank_mask:0x3
    v_add_f32_dpp v111, v103, v111 row_ror:8 row_mask:0xf bank_mask:0x3
    v_cvt_pk_bf16_f32 v104, v104, v105
    v_cvt_pk_bf16_f32 v105, v106, v107
    v_cvt_pk_bf16_f32 v106, v108, v109
    v_cvt_pk_bf16_f32 v107, v110, v111
    ds_write_b128 v45, v[104:107] offset:2304
    v_mov_b32 v12, 104448
    v_mov_b32 v13, 1
    s_mov_b64 exec, 1
    ds_add_u32 v12, v13 offset:8
    s_mov_b64 exec, -1
    v_mov_b32 v12, 104448
    s_mov_b32 s64, 800000
tw_135:
    ds_read_b32 v13, v12 offset:8
    s_sub_u32 s64, s64, 1
    s_cbranch_scc1 twd_136
    s_waitcnt lgkmcnt(0)
    v_cmp_gt_u32 vcc, 4, v13
    s_cbranch_vccnz tw_135
twd_136:
    ds_read2st64_b32 v[128:129], v239 offset0:9 offset1:27
    ds_read2st64_b32 v[130:131], v239 offset0:45 offset1:63
    s_waitcnt lgkmcnt(0)
    s_mul_i32 s7, s67, 327680
    s_lshl_b32 s50, s66, 3
    s_add_u32 s7, s7, s50
    s_add_u32 s7, s7, 3933440
    v_perm_b32 v132, v129, v128, s60
    v_perm_b32 v133, v131, v130, s60
    buffer_store_dwordx2 v[132:133], v240, s[56:59], s7 offen offset:0
    v_perm_b32 v134, v129, v128, s65
    v_perm_b32 v135, v131, v130, s65
    buffer_store_dwordx2 v[134:135], v240, s[56:59], s7 offen offset:2560
    s_branch L_h_end
L_h_tr:
    s_setprio 0
    s_waitcnt lgkmcnt(0)
    s_mul_i32 s6, s6, 1664525
    s_add_u32 s6, s6, 1013904223
    s_cmp_ge_u32 s5, 2
    s_cbranch_scc1 L_h_now
    v_add_u32 v8, 0, v1
    v_mul_u32_u24 v9, 205, v8
    v_lshrrev_b32 v9, 11, v9
    v_mul_u32_u24 v10, 10, v9
    v_sub_u32 v8, v8, v10
    v_lshrrev_b32 v10, 1, v9
    v_and_b32 v10, 4, v10
    v_xor_b32 v9, v9, v10
    v_mul_u32_u24 v9, 80, v9
    v_add_u32 v8, v8, v9
    v_lshlrev_b32 v54, 4, v8
    v_add_u32 v8, 64, v1
    v_mul_u32_u24 v9, 205, v8
    v_lshrrev_b32 v9, 11, v9
    v_mul_u32_u24 v10, 10, v9
    v_sub_u32 v8, v8, v10
    v_lshrrev_b32 v10, 1, v9
    v_and_b32 v10, 4, v10
    v_xor_b32 v9, v9, v10
    v_mul_u32_u24 v9, 80, v9
    v_add_u32 v8, v8, v9
    v_subrev_u32 v8, 64, v8
    v_lshlrev_b32 v55, 4, v8
    v_add_u32 v8, 128, v1
    v_mul_u32_u24 v9, 205, v8
    v_lshrrev_b32 v9, 11, v9
    v_mul_u32_u24 v10, 10, v9
    v_sub_u32 v8, v8, v10
    v_lshrrev_b32 v10, 1, v9
    v_and_b32 v10, 4, v10
    v_xor_b32 v9, v9, v10
    v_mul_u32_u24 v9, 80, v9
    v_add_u32 v8, v8, v9
    v_subrev_u32 v8, 128, v8
    v_lshlrev_b32 v56, 4, v8
    v_add_u32 v8, 192, v1
    v_mul_u32_u24 v9, 205, v8
    v_lshrrev_b32 v9, 11, v9
    v_mul_u32_u24 v10, 10, v9
    v_sub_u32 v8, v8, v10
    v_lshrrev_b32 v10, 1, v9
    v_and_b32 v10, 4, v10
    v_xor_b32 v9, v9, v10
    v_mul_u32_u24 v9, 80, v9
    v_add_u32 v8, v8, v9
    v_subrev_u32 v8, 192, v8
    v_lshlrev_b32 v57, 4, v8
    v_add_u32 v8, 256, v1
    v_mul_u32_u24 v9, 205, v8
    v_lshrrev_b32 v9, 11, v9
    v_mul_u32_u24 v10, 10, v9
    v_sub_u32 v8, v8, v10
    v_lshrrev_b32 v10, 1, v9
    v_and_b32 v10, 4, v10
    v_xor_b32 v9, v9, v10
    v_mul_u32_u24 v9, 80, v9
    v_add_u32 v8, v8, v9
    v_lshlrev_b32 v58, 4, v8
    s_mov_b32 s8, s18
    s_and_b32 s9, s19, 0xffff
    s_mov_b32 s10, 0xc8000
    s_mov_b32 s11, 0x20000
    s_mul_i32 s51, s5, 160
    s_add_u32 s60, s67, 16
    s_mul_i32 s60, s60, 40960
    s_add_u32 s60, s60, s51
    s_mul_i32 s65, s67, 163840
    s_add_u32 s65, s65, s51
    s_lshl_b32 s69, s67, 2
    s_add_u32 s69, s69, 103424
    s_waitcnt vmcnt(0)
    v_mov_b32 v12, 103424
    v_mov_b32 v13, 1
    s_mov_b64 exec, 1
    ds_add_u32 v12, v13 offset:0
    s_mov_b64 exec, -1
    v_mov_b32 v12, s69
    s_mov_b32 s64, 800000
tw_137:
    s_sleep 1
    ds_read_b32 v13, v12 offset:32
    s_sub_u32 s64, s64, 1
    s_cbranch_scc1 twd_138
    s_waitcnt lgkmcnt(0)
    v_cmp_gt_u32 vcc, 1, v13
    s_cbranch_vccnz tw_137
twd_138:
    s_mul_i32 m0, s67, 5120
    s_nop 0
    buffer_load_dwordx4 v54, s[8:11], s60 offen offset:0 lds
    buffer_load_dwordx4 v55, s[8:11], s60 offen offset:1024 lds
    buffer_load_dwordx4 v56, s[8:11], s60 offen offset:2048 lds
    buffer_load_dwordx4 v57, s[8:11], s60 offen offset:3072 lds
    s_add_u32 m0, m0, 4096
    s_nop 0
    buffer_load_dwordx4 v58, s[8:11], s60 offen lds
    s_add_u32 m0, m0, 1024
    s_mul_i32 s7, s67, 20480
    s_add_u32 m0, s7, 21504
    s_nop 0
    buffer_load_dwordx4 v54, s[8:11], s65 offen offset:0 lds
    buffer_load_dwordx4 v55, s[8:11], s65 offen offset:1024 lds
    buffer_load_dwordx4 v56, s[8:11], s65 offen offset:2048 lds
    buffer_load_dwordx4 v57, s[8:11], s65 offen offset:3072 lds
    s_add_u32 m0, m0, 4096
    s_nop 0
    buffer_load_dwordx4 v58, s[8:11], s65 offen lds
    s_add_u32 m0, m0, 1024
    s_add_u32 s65, s65, 40960
    buffer_load_dwordx4 v54, s[8:11], s65 offen offset:0 lds
    buffer_load_dwordx4 v55, s[8:11], s65 offen offset:1024 lds
    buffer_load_dwordx4 v56, s[8:11], s65 offen offset:2048 lds
    buffer_load_dwordx4 v57, s[8:11], s65 offen offset:3072 lds
    s_add_u32 m0, m0, 4096
    s_nop 0
    buffer_load_dwordx4 v58, s[8:11], s65 offen lds
    s_add_u32 m0, m0, 1024
    s_add_u32 s65, s65, 40960
    s_waitcnt vmcnt(10)
    v_mov_b32 v12, 103424
    v_mov_b32 v13, 1
    s_mov_b64 exec, 1
    ds_add_u32 v12, v13 offset:4
    s_mov_b64 exec, -1
    buffer_load_dwordx4 v54, s[8:11], s65 offen offset:0 lds
    buffer_load_dwordx4 v55, s[8:11], s65 offen offset:1024 lds
    buffer_load_dwordx4 v56, s[8:11], s65 offen offset:2048 lds
    buffer_load_dwordx4 v57, s[8:11], s65 offen offset:3072 lds
    s_add_u32 m0, m0, 4096
    s_nop 0
    buffer_load_dwordx4 v58, s[8:11], s65 offen lds
    s_add_u32 m0, m0, 1024
    s_add_u32 s65, s65, 40960
    s_waitcnt vmcnt(10)
    v_mov_b32 v12, 103424
    v_mov_b32 v13, 1
    s_mov_b64 exec, 1
    ds_add_u32 v12, v13 offset:8
    s_mov_b64 exec, -1
    buffer_load_dwordx4 v54, s[8:11], s65 offen offset:0 lds
    buffer_load_dwordx4 v55, s[8:11], s65 offen offset:1024 lds
    buffer_load_dwordx4 v56, s[8:11], s65 offen offset:2048 lds
    buffer_load_dwordx4 v57, s[8:11], s65 offen offset:3072 lds
    s_add_u32 m0, m0, 4096
    s_nop 0
    buffer_load_dwordx4 v58, s[8:11], s65 offen lds
    s_add_u32 m0, m0, 1024
    s_add_u32 s65, s65, 40960
    s_waitcnt vmcnt(10)
    v_mov_b32 v12, 103424
    v_mov_b32 v13, 1
    s_mov_b64 exec, 1
    ds_add_u32 v12, v13 offset:20
    s_mov_b64 exec, -1
    s_waitcnt vmcnt(5)
    v_mov_b32 v12, 103424
    v_mov_b32 v13, 1
    s_mov_b64 exec, 1
    ds_add_u32 v12, v13 offset:24
    s_mov_b64 exec, -1
    s_waitcnt vmcnt(0)
    v_mov_b32 v12, 103424
    v_mov_b32 v13, 1
    s_mov_b64 exec, 1
    ds_add_u32 v12, v13 offset:28
    s_mov_b64 exec, -1
L_h_now:
    v_mov_b32 v12, 103424
    v_mov_b32 v13, 1
    s_mov_b64 exec, 1
    ds_add_u32 v12, v13 offset:16
    s_mov_b64 exec, -1
    s_cmp_lg_u32 s67, 3
    s_cbranch_scc1 nopoll_139
    v_mov_b32 v12, 103424
    s_mov_b32 s64, 800000
tw_140:
    s_sleep 8
    ds_read_b32 v13, v12 offset:16
    s_sub_u32 s64, s64, 1
    s_cbranch_scc1 twd_141
    s_waitcnt lgkmcnt(0)
    v_cmp_gt_u32 vcc, 8, v13
    s_cbranch_vccnz tw_140
twd_141:
    v_lshlrev_b32 v12, 7, v1
    s_mov_b32 s69, 4096
    s_mov_b32 s64, 200000
    s_branch poll0_144
poll_142:
    s_sleep 8
poll0_144:
    buffer_load_dwordx4 v[8:11], v12, s[52:55], s69 offen sc1
    s_sub_u32 s64, s64, 1
    s_cbranch_scc1 pdone_143
    s_waitcnt vmcnt(0)
    v_xor_b32 v8, s6, v8
    v_xor_b32 v9, s6, v9
    v_xor_b32 v10, s6, v10
    v_xor_b32 v11, s6, v11
    v_or3_b32 v8, v8, v9, v10
    v_or_b32 v8, v8, v11
    v_cmp_ne_u32 vcc, 0, v8
    s_cbranch_vccnz poll_142
pdone_143:
    v_mov_b32 v12, 103424
    v_mov_b32 v13, 1
    s_mov_b64 exec, 1
    ds_add_u32 v12, v13 offset:12
    s_mov_b64 exec, -1
nopoll_139:
    v_mov_b32 v12, 103424
    s_mov_b32 s64, 800000
tw_145:
    s_sleep 4
    ds_read_b32 v13, v12 offset:16
    s_sub_u32 s64, s64, 1
    s_cbranch_scc1 twd_146
    s_waitcnt lgkmcnt(0)
    v_cmp_gt_u32 vcc, 8, v13
    s_cbranch_vccnz tw_145
twd_146:
    v_mov_b32 v12, 103424
    s_mov_b32 s64, 800000
tw_147:
    s_sleep 2
    ds_read_b32 v13, v12 offset:12
    s_sub_u32 s64, s64, 1
    s_cbranch_scc1 twd_148
    s_waitcnt lgkmcnt(0)
    v_cmp_gt_u32 vcc, 1, v13
    s_cbranch_vccnz tw_147
twd_148:
    s_mul_i32 s7, s67, 3072
    s_add_u32 m0, s7, s63
    s_add_u32 s7, s7, s62
    buffer_load_dwordx4 v16, s[52:55], s7 offen offset:0 sc1 lds
    buffer_load_dwordx4 v16, s[52:55], s7 offen offset:1024 sc1 lds
    buffer_load_dwordx4 v16, s[52:55], s7 offen offset:2048 sc1 lds
    s_cmp_ge_u32 s67, 3
    s_cbranch_scc1 dma_150
    s_mul_i32 s7, s67, 3072
    s_add_u32 s7, s7, 12288
    s_add_u32 m0, s7, s63
    s_add_u32 s7, s7, s62
    buffer_load_dwordx4 v16, s[52:55], s7 offen offset:0 sc1 lds
    buffer_load_dwordx4 v16, s[52:55], s7 offen offset:1024 sc1 lds
    buffer_load_dwordx4 v16, s[52:55], s7 offen offset:2048 sc1 lds
dma_150:
    s_add_u32 s62, s62, 21504
    s_cmp_eq_u32 s62, 303104
    s_cselect_b32 s62, 131072, s62
    s_xor_b32 s63, s63, 21504
    s_waitcnt vmcnt(0)
    s_barrier
    s_mul_i32 s7, s67, 3072
    s_add_u32 m0, s7, s63
    s_add_u32 s7, s7, s62
    buffer_load_dwordx4 v16, s[52:55], s7 offen offset:0 sc1 lds
    buffer_load_dwordx4 v16, s[52:55], s7 offen offset:1024 sc1 lds
    buffer_load_dwordx4 v16, s[52:55], s7 offen offset:2048 sc1 lds
    s_cmp_ge_u32 s67, 3
    s_cbranch_scc1 dma_152
    s_mul_i32 s7, s67, 3072
    s_add_u32 s7, s7, 12288
    s_add_u32 m0, s7, s63
    s_add_u32 s7, s7, s62
    buffer_load_dwordx4 v16, s[52:55], s7 offen offset:0 sc1 lds
    buffer_load_dwordx4 v16, s[52:55], s7 offen offset:1024 sc1 lds
    buffer_load_dwordx4 v16, s[52:55], s7 offen offset:2048 sc1 lds
dma_152:
    s_add_u32 s62, s62, 21504
    s_cmp_eq_u32 s62, 303104
    s_cselect_b32 s62, 131072, s62
    s_xor_b32 s63, s63, 21504
    s_mov_b32 m0, s61
    s_add_u32 s61, s61, 5120
    s_sub_u32 s7, s68, 819200
    s_cselect_b32 s68, s68, s7
    buffer_load_dwordx4 v18, s[12:15], s68 offen offset:0 lds
    buffer_load_dwordx4 v19, s[12:15], s68 offen offset:1024 lds
    buffer_load_dwordx4 v20, s[12:15], s68 offen offset:2048 lds
    buffer_load_dwordx4 v21, s[12:15], s68 offen offset:3072 lds
    s_add_u32 m0, m0, 4096
    s_nop 0
    buffer_load_dwordx4 v22, s[12:15], s68 offen lds
    s_add_u32 m0, m0, 1024
    s_add_u32 s68, s68, 40960
    s_mul_i32 s7, s67, 9216
    s_add_u32 s7, s7, 104448
    v_add_u32 v12, s7, v16
    v_mov_b32 v8, 0
    v_mov_b32 v9, 0
    v_mov_b32 v10, 0
    v_mov_b32 v11, 0
    s_mov_b64 exec, 15
    ds_write_b128 v12, v[8:11]
    s_mov_b64 exec, -1
    s_mov_b32 s8, s26
    s_and_b32 s9, s27, 0xffff
    s_mov_b32 s10, 0x280000
    s_mov_b32 s11, 0x20000
    s_and_b32 s7, s2, 7
    s_lshl_b32 s7, s7, 3
    s_mov_b32 s50, 0x08050200
    s_mov_b32 s51, 0x120f0c0a
    s_lshr_b64 s[50:51], s[50:51], s7
    s_and_b32 s50, s50, 0xff
    s_lshl_b32 s50, s50, 6
    s_lshr_b32 s7, s2, 3
    s_lshl_b32 s7, s7, 2
    s_add_u32 s7, s7, s67
    s_add_u32 s7, s7, 32
    s_mul_i32 s7, s7, 40960
    s_add_u32 s7, s7, s50
    v_lshrrev_b32 v14, 1, v1
    v_mul_u32_u24 v14, 10, v14
    v_and_b32 v15, 1, v1
    v_add_lshl_u32 v14, v14, v15, 7
    v_add_u32 v14, s7, v14
    buffer_load_dword v15, v14, s[8:11], 0 offen
    s_waitcnt vmcnt(1) lgkmcnt(0)
    s_barrier
    s_mul_i32 s7, s67, 3072
    s_add_u32 m0, s7, s63
    s_add_u32 s7, s7, s62
    buffer_load_dwordx4 v16, s[52:55], s7 offen offset:0 sc1 lds
    buffer_load_dwordx4 v16, s[52:55], s7 offen offset:1024 sc1 lds
    buffer_load_dwordx4 v16, s[52:55], s7 offen offset:2048 sc1 lds
    s_cmp_ge_u32 s67, 3
    s_cbranch_scc1 dma_154
    s_mul_i32 s7, s67, 3072
    s_add_u32 s7, s7, 12288
    s_add_u32 m0, s7, s63
    s_add_u32 s7, s7, s62
    buffer_load_dwordx4 v16, s[52:55], s7 offen offset:0 sc1 lds
    buffer_load_dwordx4 v16, s[52:55], s7 offen offset:1024 sc1 lds
    buffer_load_dwordx4 v16, s[52:55], s7 offen offset:2048 sc1 lds
dma_154:
    s_add_u32 s62, s62, 21504
    s_cmp_eq_u32 s62, 303104
    s_cselect_b32 s62, 131072, s62
    s_xor_b32 s63, s63, 21504
    s_mov_b32 m0, s61
    s_add_u32 s61, s61, 5120
    s_sub_u32 s7, s68, 819200
    s_cselect_b32 s68, s68, s7
    buffer_load_dwordx4 v18, s[12:15], s68 offen offset:0 lds
    buffer_load_dwordx4 v19, s[12:15], s68 offen offset:1024 lds
    buffer_load_dwordx4 v20, s[12:15], s68 offen offset:2048 lds
    buffer_load_dwordx4 v21, s[12:15], s68 offen offset:3072 lds
    s_add_u32 m0, m0, 4096
    s_nop 0
    buffer_load_dwordx4 v22, s[12:15], s68 offen lds
    s_add_u32 m0, m0, 1024
    s_add_u32 s68, s68, 40960
    s_waitcnt vmcnt(0) lgkmcnt(0)
    s_barrier
    s_mul_i32 s7, s67, 3072
    s_add_u32 m0, s7, s63
    s_add_u32 s7, s7, s62
    buffer_load_dwordx4 v16, s[52:55], s7 offen offset:0 sc1 lds
    buffer_load_dwordx4 v16, s[52:55], s7 offen offset:1024 sc1 lds
    buffer_load_dwordx4 v16, s[52:55], s7 offen offset:2048 sc1 lds
    s_cmp_ge_u32 s67, 3
    s_cbranch_scc1 dma_156
    s_mul_i32 s7, s67, 3072
    s_add_u32 s7, s7, 12288
    s_add_u32 m0, s7, s63
    s_add_u32 s7, s7, s62
    buffer_load_dwordx4 v16, s[52:55], s7 offen offset:0 sc1 lds
    buffer_load_dwordx4 v16, s[52:55], s7 offen offset:1024 sc1 lds
    buffer_load_dwordx4 v16, s[52:55], s7 offen offset:2048 sc1 lds
dma_156:
    s_add_u32 s62, s62, 21504
    s_cmp_eq_u32 s62, 303104
    s_cselect_b32 s62, 131072, s62
    s_xor_b32 s63, s63, 21504
    s_mov_b32 m0, s61
    s_add_u32 s61, s61, 5120
    s_sub_u32 s7, s68, 819200
    s_cselect_b32 s68, s68, s7
    buffer_load_dwordx4 v18, s[12:15], s68 offen offset:0 lds
    buffer_load_dwordx4 v19, s[12:15], s68 offen offset:1024 lds
    buffer_load_dwordx4 v20, s[12:15], s68 offen offset:2048 lds
    buffer_load_dwordx4 v21, s[12:15], s68 offen offset:3072 lds
    s_add_u32 m0, m0, 4096
    s_nop 0
    buffer_load_dwordx4 v22, s[12:15], s68 offen lds
    s_add_u32 m0, m0, 1024
    s_add_u32 s68, s68, 40960
    s_waitcnt vmcnt(0) lgkmcnt(0)
    s_barrier
    s_mul_i32 s7, s67, 3072
    s_add_u32 m0, s7, s63
    s_add_u32 s7, s7, s62
    buffer_load_dwordx4 v16, s[52:55], s7 offen offset:0 sc1 lds
    buffer_load_dwordx4 v16, s[52:55], s7 offen offset:1024 sc1 lds
    buffer_load_dwordx4 v16, s[52:55], s7 offen offset:2048 sc1 lds
    s_cmp_ge_u32 s67, 3
    s_cbranch_scc1 dma_158
    s_mul_i32 s7, s67, 3072
    s_add_u32 s7, s7, 12288
    s_add_u32 m0, s7, s63
    s_add_u32 s7, s7, s62
    buffer_load_dwordx4 v16, s[52:55], s7 offen offset:0 sc1 lds
    buffer_load_dwordx4 v16, s[52:55], s7 offen offset:1024 sc1 lds
    buffer_load_dwordx4 v16, s[52:55], s7 offen offset:2048 sc1 lds
dma_158:
    s_add_u32 s62, s62, 21504
    s_cmp_eq_u32 s62, 303104
    s_cselect_b32 s62, 131072, s62
    s_xor_b32 s63, s63, 21504
    s_lshr_b32 s7, s2, 3
    s_lshl_b32 s7, s7, 2
    s_add_u32 s7, s7, s67
    s_mul_i32 s7, s7, 2560
    s_add_u32 s7, s7, 409600
    v_lshlrev_b32 v8, 7, v1
    s_mov_b64 exec, 0xfffff
    buffer_load_dword v8, v8, s[12:15], s7 offen
    s_mov_b64 exec, -1
    s_waitcnt vmcnt(0) lgkmcnt(0)
    s_barrier
    s_mul_i32 s7, s67, 3072
    s_add_u32 m0, s7, s63
    s_add_u32 s7, s7, s62
    buffer_load_dwordx4 v16, s[52:55], s7 offen offset:0 sc1 lds
    buffer_load_dwordx4 v16, s[52:55], s7 offen offset:1024 sc1 lds
    buffer_load_dwordx4 v16, s[52:55], s7 offen offset:2048 sc1 lds
    s_cmp_ge_u32 s67, 3
    s_cbranch_scc1 dma_160
    s_mul_i32 s7, s67, 3072
    s_add_u32 s7, s7, 12288
    s_add_u32 m0, s7, s63
    s_add_u32 s7, s7, s62
    buffer_load_dwordx4 v16, s[52:55], s7 offen offset:0 sc1 lds
    buffer_load_dwordx4 v16, s[52:55], s7 offen offset:1024 sc1 lds
    buffer_load_dwordx4 v16, s[52:55], s7 offen offset:2048 sc1 lds
dma_160:
    s_add_u32 s62, s62, 21504
    s_cmp_eq_u32 s62, 303104
    s_cselect_b32 s62, 131072, s62
    s_xor_b32 s63, s63, 21504
    s_lshl_b32 s7, s4, 3
    s_add_u32 s7, s7, s5
    s_lshl_b32 s7, s7, 2
    s_add_u32 s7, s7, s67
    s_mul_i32 s7, s7, 2560
    s_add_u32 s7, s7, 4194304
    v_mov_b32 v8, -1
    v_mov_b32 v9, -1
    v_mov_b32 v10, -1
    v_mov_b32 v11, -1
    s_add_u32 s50, s7, 4194304
    buffer_store_dwordx4 v[8:11], v16, s[52:55], s7 offen offset:0 sc1
    buffer_store_dwordx4 v[8:11], v16, s[52:55], s50 offen offset:0 sc1
    buffer_store_dwordx4 v[8:11], v16, s[52:55], s7 offen offset:1024 sc1
    buffer_store_dwordx4 v[8:11], v16, s[52:55], s50 offen offset:1024 sc1
    s_mov_b32 exec_hi, 0
    buffer_store_dwordx4 v[8:11], v16, s[52:55], s7 offen offset:2048 sc1
    buffer_store_dwordx4 v[8:11], v16, s[52:55], s50 offen offset:2048 sc1
    s_mov_b32 exec_hi, -1
    s_waitcnt vmcnt(6) lgkmcnt(0)
    s_barrier
    s_mul_i32 s7, s67, 3072
    s_add_u32 m0, s7, s63
    s_add_u32 s7, s7, s62
    buffer_load_dwordx4 v16, s[52:55], s7 offen offset:0 sc1 lds
    buffer_load_dwordx4 v16, s[52:55], s7 offen offset:1024 sc1 lds
    buffer_load_dwordx4 v16, s[52:55], s7 offen offset:2048 sc1 lds
    s_cmp_ge_u32 s67, 3
    s_cbranch_scc1 dma_162
    s_mul_i32 s7, s67, 3072
    s_add_u32 s7, s7, 12288
    s_add_u32 m0, s7, s63
    s_add_u32 s7, s7, s62
    buffer_load_dwordx4 v16, s[52:55], s7 offen offset:0 sc1 lds
    buffer_load_dwordx4 v16, s[52:55], s7 offen offset:1024 sc1 lds
    buffer_load_dwordx4 v16, s[52:55], s7 offen offset:2048 sc1 lds
dma_162:
    s_add_u32 s62, s62, 21504
    s_cmp_eq_u32 s62, 303104
    s_cselect_b32 s62, 131072, s62
    s_xor_b32 s63, s63, 21504
    s_waitcnt vmcnt(0) lgkmcnt(0)
    s_barrier
    s_cmp_eq_u32 s67, 3
    s_cbranch_scc1 w7_163
    s_mul_i32 s7, s67, 1
    s_mul_i32 s61, s7, 5120
    s_add_u32 s61, s61, 2048
    s_mul_i32 s68, s7, 40960
    s_mul_i32 s7, s5, 160
    s_add_u32 s68, s68, s7
    s_add_u32 s68, s68, 409600
    s_mov_b32 m0, s61
    s_add_u32 s61, s61, 5120
    s_sub_u32 s7, s68, 819200
    s_cselect_b32 s68, s68, s7
    buffer_load_dwordx4 v18, s[12:15], s68 offen offset:0 lds
    buffer_load_dwordx4 v19, s[12:15], s68 offen offset:1024 lds
    buffer_load_dwordx4 v20, s[12:15], s68 offen offset:2048 lds
    buffer_load_dwordx4 v21, s[12:15], s68 offen offset:3072 lds
    s_add_u32 m0, m0, 4096
    s_nop 0
    buffer_load_dwordx4 v22, s[12:15], s68 offen lds
    s_add_u32 m0, m0, 1024
    s_add_u32 s68, s68, 40960
w7_163:
    s_waitcnt vmcnt(0) lgkmcnt(0)
    s_cmp_lg_u32 s67, 0
    s_cbranch_scc1 f8_164
    s_lshl_b32 s7, s2, 7
    s_lshl_b32 s50, s67, 2
    s_add_u32 s7, s7, s50
    s_add_u32 s7, s7, 65536
    v_mov_b32 v8, s6
    s_mov_b64 exec, 1
    buffer_store_dword v8, off, s[52:55], s7 sc1
    s_mov_b64 exec, -1
f8_164:
    s_barrier
    s_mul_i32 s7, s67, 1
    s_add_u32 s7, s7, 3
    s_mul_i32 s61, s7, 5120
    s_add_u32 s61, s61, 2048
    s_mul_i32 s68, s7, 40960
    s_mul_i32 s7, s5, 160
    s_add_u32 s68, s68, s7
    s_add_u32 s68, s68, 409600
    s_mov_b32 m0, s61
    s_add_u32 s61, s61, 5120
    s_sub_u32 s7, s68, 819200
    s_cselect_b32 s68, s68, s7
    buffer_load_dwordx4 v18, s[12:15], s68 offen offset:0 lds
    buffer_load_dwordx4 v19, s[12:15], s68 offen offset:1024 lds
    buffer_load_dwordx4 v20, s[12:15], s68 offen offset:2048 lds
    buffer_load_dwordx4 v21, s[12:15], s68 offen offset:3072 lds
    s_add_u32 m0, m0, 4096
    s_nop 0
    buffer_load_dwordx4 v22, s[12:15], s68 offen lds
    s_add_u32 m0, m0, 1024
    s_add_u32 s68, s68, 40960
    s_cmp_lg_u32 s67, 3
    s_cbranch_scc1 w8_165
    s_mov_b32 m0, s61
    s_add_u32 s61, s61, 5120
    s_sub_u32 s7, s68, 819200
    s_cselect_b32 s68, s68, s7
    buffer_load_dwordx4 v18, s[12:15], s68 offen offset:0 lds
    buffer_load_dwordx4 v19, s[12:15], s68 offen offset:1024 lds
    buffer_load_dwordx4 v20, s[12:15], s68 offen offset:2048 lds
    buffer_load_dwordx4 v21, s[12:15], s68 offen offset:3072 lds
    s_add_u32 m0, m0, 4096
    s_nop 0
    buffer_load_dwordx4 v22, s[12:15], s68 offen lds
    s_add_u32 m0, m0, 1024
    s_add_u32 s68, s68, 40960
w8_165:
    s_waitcnt vmcnt(0)
    v_mov_b32 v12, 104448
    v_mov_b32 v13, 1
    s_mov_b64 exec, 1
    ds_add_u32 v12, v13 offset:0
    s_mov_b64 exec, -1
    s_add_u32 s7, s2, s67
    s_cmp_lg_u32 s7, 0
    s_cbranch_scc1 notag_166
    v_lshlrev_b32 v12, 7, v1
    s_mov_b32 s69, 65536
    s_mov_b32 s64, 200000
    s_branch poll0_169
poll_167:
    s_sleep 4
poll0_169:
    buffer_load_dword v8, v12, s[52:55], s69 offen sc1
    s_sub_u32 s64, s64, 1
    s_cbranch_scc1 pdone_168
    s_waitcnt vmcnt(0)
    v_cmp_ne_u32 vcc, s6, v8
    s_cbranch_vccnz poll_167
pdone_168:
    s_mov_b32 s69, 73728
    s_mov_b32 s64, 200000
    s_branch poll0_172
poll_170:
    s_sleep 4
poll0_172:
    buffer_load_dword v8, v12, s[52:55], s69 offen sc1
    s_sub_u32 s64, s64, 1
    s_cbranch_scc1 pdone_171
    s_waitcnt vmcnt(0)
    v_cmp_ne_u32 vcc, s6, v8
    s_cbranch_vccnz poll_170
pdone_171:
    s_mov_b32 s69, 81920
    s_mov_b32 s64, 200000
    s_branch poll0_175
poll_173:
    s_sleep 4
poll0_175:
    buffer_load_dword v8, v12, s[52:55], s69 offen sc1
    s_sub_u32 s64, s64, 1
    s_cbranch_scc1 pdone_174
    s_waitcnt vmcnt(0)
    v_cmp_ne_u32 vcc, s6, v8
    s_cbranch_vccnz poll_173
pdone_174:
    s_mov_b32 s69, 90112
    s_mov_b32 s64, 200000
    s_branch poll0_178
poll_176:
    s_sleep 4
poll0_178:
    buffer_load_dword v8, v12, s[52:55], s69 offen sc1
    s_sub_u32 s64, s64, 1
    s_cbranch_scc1 pdone_177
    s_waitcnt vmcnt(0)
    v_cmp_ne_u32 vcc, s6, v8
    s_cbranch_vccnz poll_176
pdone_177:
    v_mov_b32 v8, s6
    s_mov_b64 exec, 1
    buffer_store_dword v8, off, s[52:55], 0 offset:0 sc1
    s_mov_b64 exec, -1
notag_166:
L_h_end:
L_end:
    s_endpgm
L_code_end:
.section .rodata,"a"
.p2align 6
.amdhsa_kernel concat_heads__grouped_kv_mqa__ssm_conv_s4__prompt_kernel
  .amdhsa_next_free_vgpr 252
  .amdhsa_next_free_sgpr 102
  .amdhsa_accum_offset 252
  .amdhsa_group_segment_fixed_size 0
  .amdhsa_kernarg_size 136
  .amdhsa_user_sgpr_count 2
  .amdhsa_user_sgpr_kernarg_segment_ptr 1
  .amdhsa_system_sgpr_workgroup_id_x 1
.end_amdhsa_kernel
```
